```python
import torch

def _softmax(x, axis=-1):
    return torch.softmax(x, dim=axis)
def _gelu(x):
    return torch.nn.functional.gelu(x, approximate="tanh")
def _silu(x):
    return torch.nn.functional.silu(x)
def _sigmoid(x):
    return torch.sigmoid(x)
def _layernorm(x, axis=-1, eps=1e-5):
    m = x.mean(dim=axis, keepdim=True)
    v = x.var(dim=axis, keepdim=True, unbiased=False)
    return (x - m) / torch.sqrt(v + eps)
def _scatter_add(tgt, idx, src, axis=0):
    return tgt.clone().index_add_(axis, idx, src)
def _segment_sum(src, seg, n):
    out = torch.zeros((n,) + src.shape[1:], dtype=src.dtype)
    return out.index_add_(0, seg, src)
def _pad(x, pw):
    flat = tuple(v for pair in reversed(pw) for v in pair)
    return torch.nn.functional.pad(x, flat)

kernel_name = 'parallel_sum__compressed_kv_cla__dense_activation_squared_relu__prompt'

def setup_inputs():

    _w = (lambda a: (lambda t: t.to(torch.bfloat16) if t.is_floating_point() else t)(torch.as_tensor(a)))
    def _A_setup():
        B, H, Sq, Sk, D, M = 1, 32, 2048, 2048, 128, 512
        Dc = 4 * D
        return {
            "x": _w((lambda *s: torch.randn(*s, dtype=torch.bfloat16) * 0.05)(B, Sq, M)),
            "c_kv": _w((lambda *s: torch.randn(*s, dtype=torch.bfloat16) * 1.6)(B, Sk, Dc)),
            "w_q": _w((lambda *s: torch.randn(*s, dtype=torch.bfloat16) * 1.6)(M, H, D) * (M ** -0.5)),
            "w_uk": _w((lambda *s: torch.randn(*s, dtype=torch.bfloat16) * 1.6)(Dc, H, D) * (Dc ** -0.5)),
            "w_uv": _w((lambda *s: torch.randn(*s, dtype=torch.bfloat16) * 1.6)(Dc, H, D) * (Dc ** -0.5)),
            "w_o": _w((lambda *s: torch.randn(*s, dtype=torch.bfloat16) * 1.6)(H, D, M) * ((H * D) ** -0.5)),
        }
    _A_in = _A_setup()

    def _B_setup():
        B, S, D, F = 1, 2048, 512, 1792
        return {
            "x": _w((lambda *s: torch.randn(*s, dtype=torch.bfloat16) * 0.05)(B, S, D)),
            "w1": _w((lambda *s: torch.randn(*s, dtype=torch.bfloat16) * 0.05)(D, F)),
            "b1": _w((lambda *s: torch.randn(*s, dtype=torch.bfloat16) * 0.4)(F)),
            "w2": _w((lambda *s: torch.randn(*s, dtype=torch.bfloat16) * 0.05)(F, D)),
            "b2": _w((lambda *s: torch.randn(*s, dtype=torch.bfloat16) * 1.6)(D)),
        }
    _B_in = _B_setup()

    return {
        "A_x": _A_in["x"],
        "A_c_kv": _A_in["c_kv"],
        "A_w_q": _A_in["w_q"],
        "A_w_uk": _A_in["w_uk"],
        "A_w_uv": _A_in["w_uv"],
        "A_w_o": _A_in["w_o"],
        "B_x": _B_in["x"],
        "B_w1": _B_in["w1"],
        "B_b1": _B_in["b1"],
        "B_w2": _B_in["w2"],
        "B_b2": _B_in["b2"],
    }

def reference(A_x, A_c_kv, A_w_q, A_w_uk, A_w_uv, A_w_o, B_x, B_w1, B_b1, B_w2, B_b2):
    def _A_ref(x, c_kv, w_q, w_uk, w_uv, w_o):
        B, Sq, M = x.shape[0], x.shape[1], x.shape[2]
        Sk = c_kv.shape[1]
        H, D = w_q.shape[1], w_q.shape[2]
        q = torch.einsum("bqm,mhd->bhqd", x, w_q)
        k = torch.einsum("bkc,chd->bhkd", c_kv, w_uk)
        v = torch.einsum("bkc,chd->bhkd", c_kv, w_uv)
        scores = torch.einsum("bhqd,bhkd->bhqk", q, k) * (D ** -0.5)
        off = Sk - Sq
        qi = torch.arange(Sq)[:, None]
        kj = torch.arange(Sk)[None, :]
        cmask = kj <= (qi + off)
        scores = torch.where(cmask[None, None], scores, -1e9)
        p = _softmax(scores, axis=-1)
        ctx = torch.einsum("bhqk,bhkd->bhqd", p, v)
        return torch.einsum("bhqd,hdm->bqm", ctx, w_o)

    def _B_ref(x, w1, b1, w2, b2):
        h = torch.einsum("bsd,df->bsf", x, w1) + b1
        zero = torch.zeros_like(h)
        r = torch.where(h > zero, h, zero)
        h = r * r
        out = torch.einsum("bsf,fd->bsd", h, w2) + b2
        return out

    x = A_x
    xn = _layernorm(x, axis=-1)
    return x + _A_ref(xn, A_c_kv, A_w_q, A_w_uk, A_w_uv, A_w_o) + _B_ref(xn, B_w1, B_b1, B_w2, B_b2)
```

```asm
; @launch kernel=k1_kv_kernel grid=(256,1,1) block=(512,1,1) lds=163840
; @launch kernel=k3_attn_kernel grid=(256,1,1) block=(512,1,1) lds=163840
; @launch kernel=k4_out_kernel grid=(256,1,1) block=(512,1,1) lds=163840
; @launch kernel=k5_red_kernel grid=(512,1,1) block=(256,1,1) lds=0
.amdgcn_target "amdgcn-amd-amdhsa--gfx950"
.text
.globl k1_kv_kernel
.p2align 8
.type k1_kv_kernel,@function
k1_kv_kernel:
    s_cmp_ge_u32 s2, 256
    s_cbranch_scc1 K1_END
    s_load_dwordx16 s[16:31], s[0:1], 0
    s_load_dwordx8 s[32:39], s[0:1], 64
    s_load_dwordx4 s[40:43], s[0:1], 96
    s_and_b32 s3, s2, 7
    s_lshr_b32 s4, s2, 3
    s_and_b32 s5, s4, 3
    s_lshl_b32 s3, s3, 2
    s_add_u32 s3, s3, s5
    s_lshr_b32 s4, s4, 2
    s_mov_b32 s67, 8192
    v_and_b32 v1, 63, v0
    v_lshrrev_b32 v14, 6, v0
    s_nop 0
    v_readfirstlane_b32 s64, v14
    s_and_b32 s69, s64, 3
    s_lshr_b32 s70, s64, 2
    v_lshrrev_b32 v14, 2, v1
    s_lshl_b32 s72, s64, 5
    v_add_u32 v14, s72, v14
    s_mov_b32 s73, 1024
    v_mul_lo_u32 v14, v14, s73
    v_lshrrev_b32 v15, 4, v1
    v_and_b32 v16, 3, v1
    v_xor_b32 v15, v15, v16
    v_lshl_add_u32 v2, v15, 4, v14
    v_add_u32 v3, 16384, v2
    v_lshrrev_b32 v14, 5, v1
    s_lshl_b32 s72, s64, 2
    v_add_u32 v15, s72, v14
    v_mul_lo_u32 v15, v15, s67
    v_bfe_u32 v16, v1, 2, 3
    v_and_b32 v17, 3, v1
    v_xor_b32 v18, v16, v14
    v_lshlrev_b32 v18, 6, v18
    v_lshl_add_u32 v18, v17, 4, v18
    v_add_u32 v4, v15, v18
    v_xor_b32 v18, 2, v14
    v_xor_b32 v18, v16, v18
    v_lshlrev_b32 v18, 6, v18
    v_lshl_add_u32 v18, v17, 4, v18
    v_add_u32 v5, v15, v18
    s_lshl_b32 s72, s67, 1
    v_add_u32 v5, s72, v5
    s_lshl_b32 s71, s64, 11
    s_lshl_b32 s74, s64, 11
    s_waitcnt lgkmcnt(0)
    s_mov_b32 s44, s18
    s_and_b32 s45, s19, 0xffff
    s_mov_b32 s46, 0x200000
    s_mov_b32 s47, 0x20000
    s_cmp_lt_u32 s3, 16
    s_cselect_b32 s48, s22, s24
    s_cselect_b32 s49, s23, s25
    s_mov_b32 s101, 0x3000000
    s_cselect_b32 s5, 0x2000000, s101
    s_and_b32 s49, s49, 0xffff
    s_mov_b32 s50, 0x400000
    s_mov_b32 s51, 0x20000
    s_add_u32 s52, s42, s5
    s_addc_u32 s53, s43, 0
    s_and_b32 s53, s53, 0xffff
    s_mov_b32 s54, 0x1000000
    s_mov_b32 s55, 0x20000
    s_and_b32 s3, s3, 15
    s_lshl_b32 s65, s4, 18
    s_lshl_b32 s66, s3, 9
    s_add_u32 s80, s65, 131072
    s_mov_b32 s81, s66
    s_mov_b32 s68, 262144
    s_mov_b32 s56, s16
    s_and_b32 s57, s17, 0xffff
    s_mov_b32 s58, 0x200000
    s_mov_b32 s59, 0x20000
    s_mov_b32 s60, s42
    s_and_b32 s61, s43, 0xffff
    s_mov_b32 s62, 0x200000
    s_mov_b32 s63, 0x20000
    s_cmp_ge_u32 s64, 4
    s_cselect_b32 vcc_lo, -1, 0
    s_mov_b32 vcc_hi, 0
    s_cbranch_vccnz RL82
    s_add_u32 s79, s65, 131072
    s_add_u32 m0, s71, 0
    s_nop 0
    buffer_load_dwordx4 v2, s[44:47], s65 offen lds
    s_add_u32 m0, s71, 1024
    s_nop 0
    buffer_load_dwordx4 v3, s[44:47], s65 offen lds
    s_add_u32 m0, s71, 8192
    s_nop 0
    buffer_load_dwordx4 v2, s[44:47], s79 offen lds
    s_add_u32 m0, s71, 9216
    s_nop 0
    buffer_load_dwordx4 v3, s[44:47], s79 offen lds
    s_add_u32 s65, s65, 64
RL82:
    s_cbranch_vccnz RL94
    s_add_u32 s79, s66, 131072
    s_add_u32 m0, s74, 16384
    s_nop 0
    buffer_load_dwordx4 v4, s[48:51], s66 offen lds
    s_add_u32 m0, s74, 17408
    s_nop 0
    buffer_load_dwordx4 v5, s[48:51], s66 offen lds
    s_add_u32 m0, s74, 24576
    s_nop 0
    buffer_load_dwordx4 v4, s[48:51], s79 offen lds
    s_add_u32 m0, s74, 25600
    s_nop 0
    buffer_load_dwordx4 v5, s[48:51], s79 offen lds
    s_add_u32 s66, s66, s68
RL94:
    s_cbranch_vccnz RL106
    s_add_u32 s79, s65, 131072
    s_add_u32 m0, s71, 32768
    s_nop 0
    buffer_load_dwordx4 v2, s[44:47], s65 offen lds
    s_add_u32 m0, s71, 33792
    s_nop 0
    buffer_load_dwordx4 v3, s[44:47], s65 offen lds
    s_add_u32 m0, s71, 40960
    s_nop 0
    buffer_load_dwordx4 v2, s[44:47], s79 offen lds
    s_add_u32 m0, s71, 41984
    s_nop 0
    buffer_load_dwordx4 v3, s[44:47], s79 offen lds
    s_add_u32 s65, s65, 64
RL106:
    s_cbranch_vccnz RL118
    s_add_u32 s79, s66, 131072
    s_add_u32 m0, s74, 49152
    s_nop 0
    buffer_load_dwordx4 v4, s[48:51], s66 offen lds
    s_add_u32 m0, s74, 50176
    s_nop 0
    buffer_load_dwordx4 v5, s[48:51], s66 offen lds
    s_add_u32 m0, s74, 57344
    s_nop 0
    buffer_load_dwordx4 v4, s[48:51], s79 offen lds
    s_add_u32 m0, s74, 58368
    s_nop 0
    buffer_load_dwordx4 v5, s[48:51], s79 offen lds
    s_add_u32 s66, s66, s68
RL118:
    v_and_b32 v14, 31, v1
    s_mul_i32 s72, s70, 8192
    v_lshlrev_b32 v14, 6, v14
    v_add_u32 v14, s72, v14
    v_lshrrev_b32 v15, 5, v1
    v_bfe_u32 v16, v1, 2, 2
    v_xor_b32 v15, v15, v16
    v_lshl_add_u32 v6, v15, 4, v14
    v_xor_b32 v7, 32, v6
    v_add_u32 v8, 65536, v6
    v_add_u32 v9, 65536, v7
    v_add_u32 v28, 131072, v6
    v_add_u32 v29, 131072, v7
    v_lshrrev_b32 v14, 5, v1
    v_lshlrev_b32 v14, 3, v14
    v_bfe_u32 v15, v1, 2, 2
    v_add_u32 v14, v14, v15
    v_mul_u32_u24 v14, 512, v14
    s_lshl_b32 s72, s69, 1
    v_xor_b32 v15, s72, v15
    v_lshl_add_u32 v14, v15, 6, v14
    v_bfe_u32 v15, v1, 4, 1
    v_lshl_add_u32 v14, v15, 5, v14
    v_and_b32 v15, 3, v1
    v_lshl_add_u32 v14, v15, 3, v14
    v_add_u32 v10, 16384, v14
    v_xor_b32 v11, 64, v10
    v_add_u32 v12, 65536, v10
    v_add_u32 v13, 65536, v11
    v_add_u32 v30, 131072, v10
    v_add_u32 v31, 131072, v11
    s_lshl_b32 s72, s2, 3
    s_add_u32 s72, s72, s64
    s_lshl_b32 s72, s72, 10
    v_lshlrev_b32 v19, 4, v1
    v_add_u32 v19, s72, v19
    buffer_load_dwordx4 v[80:83], v19, s[56:59], 0 offen
    s_lshr_b32 s72, s72, 4
    v_lshrrev_b32 v19, 2, v1
    v_lshlrev_b32 v19, 17, v19
    v_and_b32 v18, 3, v1
    v_lshl_add_u32 v19, v18, 4, v19
    v_add_u32 v19, s72, v19
    s_cmp_eq_u32 s64, 6
    s_cselect_b32 s8, s48, s44
    s_cselect_b32 s9, s49, s45
    s_cselect_b32 s10, s50, s46
    s_cselect_b32 s11, s51, s47
    s_mov_b32 s101, 128
    s_cselect_b32 s13, 524288, s101
    s_lshl_b32 s72, s4, 16
    s_lshl_b32 s73, s3, 9
    s_add_u32 s72, s72, s73
    s_lshr_b32 s73, s2, 3
    s_lshl_b32 s73, s73, 16
    s_and_b32 s12, s64, 1
    s_lshl_b32 s12, s12, 15
    s_add_u32 s73, s73, s12
    s_cmp_eq_u32 s64, 6
    s_cselect_b32 s12, s72, s73
    v_lshrrev_b32 v18, 1, v1
    v_lshlrev_b32 v18, 10, v18
    v_and_b32 v17, 1, v1
    v_lshl_add_u32 v18, v17, 6, v18
    v_lshrrev_b32 v16, 3, v1
    v_lshlrev_b32 v16, 13, v16
    v_and_b32 v17, 7, v1
    v_lshl_add_u32 v16, v17, 6, v16
    s_cselect_b64 s[14:15], -1, 0
    v_cndmask_b32 v16, v18, v16, s[14:15]
    s_cmp_eq_u32 s64, 7
    s_cselect_b32 s10, 0, s10
    s_lshl_b32 s72, s13, 1
    s_add_u32 s12, s12, s72
    s_cbranch_vccz RL204
    buffer_load_dword v27, v16, s[8:11], s12 offen
    s_add_u32 s12, s12, s13
RL204:
    s_cbranch_vccnz RL208
    s_waitcnt vmcnt(9)
RL208:
    s_barrier
    ds_read_b64_tr_b16 v[32:33], v10 offset:0
    ds_read_b64_tr_b16 v[34:35], v10 offset:2048
    ds_read_b64_tr_b16 v[36:37], v11 offset:0
    ds_read_b64_tr_b16 v[38:39], v11 offset:2048
    ds_read_b128 v[48:51], v6 offset:0
    ds_read_b128 v[52:55], v6 offset:2048
    ds_read_b128 v[56:59], v6 offset:4096
    ds_read_b128 v[60:63], v6 offset:6144
    s_waitcnt lgkmcnt(0)
    v_mfma_f32_32x32x16_bf16 v[128:143], v[32:35], v[48:51], 0
    s_cbranch_vccnz RL222
    s_add_u32 s79, s65, 131072
    s_add_u32 m0, s71, 65536
    s_nop 0
    buffer_load_dwordx4 v2, s[44:47], s65 offen lds
    s_add_u32 m0, s71, 66560
    s_nop 0
    buffer_load_dwordx4 v3, s[44:47], s65 offen lds
    s_add_u32 m0, s71, 73728
    s_nop 0
    buffer_load_dwordx4 v2, s[44:47], s79 offen lds
    s_add_u32 m0, s71, 74752
    s_nop 0
    buffer_load_dwordx4 v3, s[44:47], s79 offen lds
    s_add_u32 s65, s65, 64
RL222:
    s_cbranch_vccnz RL234
    s_add_u32 s79, s66, 131072
    s_add_u32 m0, s74, 81920
    s_nop 0
    buffer_load_dwordx4 v4, s[48:51], s66 offen lds
    s_add_u32 m0, s74, 82944
    s_nop 0
    buffer_load_dwordx4 v5, s[48:51], s66 offen lds
    s_add_u32 m0, s74, 90112
    s_nop 0
    buffer_load_dwordx4 v4, s[48:51], s79 offen lds
    s_add_u32 m0, s74, 91136
    s_nop 0
    buffer_load_dwordx4 v5, s[48:51], s79 offen lds
    s_add_u32 s66, s66, s68
RL234:
    v_mfma_f32_32x32x16_bf16 v[144:159], v[32:35], v[52:55], 0
    ds_read_b64_tr_b16 v[40:41], v10 offset:8192
    ds_read_b64_tr_b16 v[42:43], v10 offset:10240
    v_mfma_f32_32x32x16_bf16 v[160:175], v[32:35], v[56:59], 0
    ds_read_b64_tr_b16 v[44:45], v11 offset:8192
    ds_read_b64_tr_b16 v[46:47], v11 offset:10240
    v_mfma_f32_32x32x16_bf16 v[176:191], v[32:35], v[60:63], 0
    ds_read_b128 v[64:67], v7 offset:0
    ds_read_b128 v[68:71], v7 offset:2048
    v_mfma_f32_32x32x16_bf16 v[192:207], v[36:39], v[48:51], 0
    ds_read_b128 v[72:75], v7 offset:4096
    ds_read_b128 v[76:79], v7 offset:6144
    v_mfma_f32_32x32x16_bf16 v[208:223], v[36:39], v[52:55], 0
    s_cbranch_vccz RL259
    buffer_load_dword v27, v16, s[8:11], s12 offen
    s_add_u32 s12, s12, s13
RL259:
    v_mfma_f32_32x32x16_bf16 v[224:239], v[36:39], v[56:59], 0
    v_mfma_f32_32x32x16_bf16 v[240:255], v[36:39], v[60:63], 0
    s_cbranch_vccnz RL265
    s_waitcnt vmcnt(9)
RL265:
    s_barrier
    s_waitcnt lgkmcnt(0)
    v_mfma_f32_32x32x16_bf16 v[128:143], v[40:43], v[64:67], v[128:143]
    ds_read_b64_tr_b16 v[32:33], v10 offset:32768
    ds_read_b64_tr_b16 v[34:35], v10 offset:34816
    v_mfma_f32_32x32x16_bf16 v[144:159], v[40:43], v[68:71], v[144:159]
    ds_read_b64_tr_b16 v[36:37], v11 offset:32768
    ds_read_b64_tr_b16 v[38:39], v11 offset:34816
    v_mfma_f32_32x32x16_bf16 v[160:175], v[40:43], v[72:75], v[160:175]
    ds_read_b128 v[48:51], v6 offset:32768
    ds_read_b128 v[52:55], v6 offset:34816
    v_mfma_f32_32x32x16_bf16 v[176:191], v[40:43], v[76:79], v[176:191]
    ds_read_b128 v[56:59], v6 offset:36864
    ds_read_b128 v[60:63], v6 offset:38912
    v_mfma_f32_32x32x16_bf16 v[192:207], v[44:47], v[64:67], v[192:207]
    s_cbranch_vccnz RL283
    s_add_u32 s79, s65, 131072
    s_add_u32 m0, s71, 98304
    s_nop 0
    buffer_load_dwordx4 v2, s[44:47], s65 offen lds
    s_add_u32 m0, s71, 99328
    s_nop 0
    buffer_load_dwordx4 v3, s[44:47], s65 offen lds
    s_add_u32 m0, s71, 106496
    s_nop 0
    buffer_load_dwordx4 v2, s[44:47], s79 offen lds
    s_add_u32 m0, s71, 107520
    s_nop 0
    buffer_load_dwordx4 v3, s[44:47], s79 offen lds
    s_add_u32 s65, s65, 64
RL283:
    s_cbranch_vccnz RL295
    s_add_u32 s79, s66, 131072
    s_add_u32 m0, s74, 114688
    s_nop 0
    buffer_load_dwordx4 v4, s[48:51], s66 offen lds
    s_add_u32 m0, s74, 115712
    s_nop 0
    buffer_load_dwordx4 v5, s[48:51], s66 offen lds
    s_add_u32 m0, s74, 122880
    s_nop 0
    buffer_load_dwordx4 v4, s[48:51], s79 offen lds
    s_add_u32 m0, s74, 123904
    s_nop 0
    buffer_load_dwordx4 v5, s[48:51], s79 offen lds
    s_add_u32 s66, s66, s68
RL295:
    v_mfma_f32_32x32x16_bf16 v[208:223], v[44:47], v[68:71], v[208:223]
    v_mfma_f32_32x32x16_bf16 v[224:239], v[44:47], v[72:75], v[224:239]
    v_mfma_f32_32x32x16_bf16 v[240:255], v[44:47], v[76:79], v[240:255]
    s_waitcnt lgkmcnt(0)
    v_mfma_f32_32x32x16_bf16 v[128:143], v[32:35], v[48:51], v[128:143]
    s_cbranch_vccnz RL312
    s_add_u32 s79, s65, 131072
    s_add_u32 m0, s71, 131072
    s_nop 0
    buffer_load_dwordx4 v2, s[44:47], s65 offen lds
    s_add_u32 m0, s71, 132096
    s_nop 0
    buffer_load_dwordx4 v3, s[44:47], s65 offen lds
    s_add_u32 m0, s71, 139264
    s_nop 0
    buffer_load_dwordx4 v2, s[44:47], s79 offen lds
    s_add_u32 m0, s71, 140288
    s_nop 0
    buffer_load_dwordx4 v3, s[44:47], s79 offen lds
    s_add_u32 s65, s65, 64
RL312:
    s_cbranch_vccnz RL324
    s_add_u32 s79, s66, 131072
    s_add_u32 m0, s74, 147456
    s_nop 0
    buffer_load_dwordx4 v4, s[48:51], s66 offen lds
    s_add_u32 m0, s74, 148480
    s_nop 0
    buffer_load_dwordx4 v5, s[48:51], s66 offen lds
    s_add_u32 m0, s74, 155648
    s_nop 0
    buffer_load_dwordx4 v4, s[48:51], s79 offen lds
    s_add_u32 m0, s74, 156672
    s_nop 0
    buffer_load_dwordx4 v5, s[48:51], s79 offen lds
    s_add_u32 s66, s66, s68
RL324:
    v_mfma_f32_32x32x16_bf16 v[144:159], v[32:35], v[52:55], v[144:159]
    ds_read_b64_tr_b16 v[40:41], v10 offset:40960
    ds_read_b64_tr_b16 v[42:43], v10 offset:43008
    v_mfma_f32_32x32x16_bf16 v[160:175], v[32:35], v[56:59], v[160:175]
    ds_read_b64_tr_b16 v[44:45], v11 offset:40960
    ds_read_b64_tr_b16 v[46:47], v11 offset:43008
    v_mfma_f32_32x32x16_bf16 v[176:191], v[32:35], v[60:63], v[176:191]
    ds_read_b128 v[64:67], v7 offset:32768
    ds_read_b128 v[68:71], v7 offset:34816
    v_mfma_f32_32x32x16_bf16 v[192:207], v[36:39], v[48:51], v[192:207]
    ds_read_b128 v[72:75], v7 offset:36864
    ds_read_b128 v[76:79], v7 offset:38912
    v_mfma_f32_32x32x16_bf16 v[208:223], v[36:39], v[52:55], v[208:223]
    v_mfma_f32_32x32x16_bf16 v[224:239], v[36:39], v[56:59], v[224:239]
    v_mfma_f32_32x32x16_bf16 v[240:255], v[36:39], v[60:63], v[240:255]
    s_cbranch_vccnz RL351
    s_waitcnt vmcnt(16)
RL351:
    s_barrier
    s_waitcnt lgkmcnt(0)
    v_mfma_f32_32x32x16_bf16 v[128:143], v[40:43], v[64:67], v[128:143]
    ds_read_b64_tr_b16 v[32:33], v12 offset:0
    ds_read_b64_tr_b16 v[34:35], v12 offset:2048
    v_mfma_f32_32x32x16_bf16 v[144:159], v[40:43], v[68:71], v[144:159]
    ds_read_b64_tr_b16 v[36:37], v13 offset:0
    ds_read_b64_tr_b16 v[38:39], v13 offset:2048
    v_mfma_f32_32x32x16_bf16 v[160:175], v[40:43], v[72:75], v[160:175]
    ds_read_b128 v[48:51], v8 offset:0
    ds_read_b128 v[52:55], v8 offset:2048
    v_mfma_f32_32x32x16_bf16 v[176:191], v[40:43], v[76:79], v[176:191]
    ds_read_b128 v[56:59], v8 offset:4096
    ds_read_b128 v[60:63], v8 offset:6144
    v_mfma_f32_32x32x16_bf16 v[192:207], v[44:47], v[64:67], v[192:207]
    s_cbranch_vccnz RL369
    s_add_u32 s79, s65, 131072
    s_add_u32 m0, s71, 0
    s_nop 0
    buffer_load_dwordx4 v2, s[44:47], s65 offen lds
    s_add_u32 m0, s71, 1024
    s_nop 0
    buffer_load_dwordx4 v3, s[44:47], s65 offen lds
    s_add_u32 m0, s71, 8192
    s_nop 0
    buffer_load_dwordx4 v2, s[44:47], s79 offen lds
    s_add_u32 m0, s71, 9216
    s_nop 0
    buffer_load_dwordx4 v3, s[44:47], s79 offen lds
    s_add_u32 s65, s65, 64
RL369:
    s_cbranch_vccnz RL381
    s_add_u32 s79, s66, 131072
    s_add_u32 m0, s74, 16384
    s_nop 0
    buffer_load_dwordx4 v4, s[48:51], s66 offen lds
    s_add_u32 m0, s74, 17408
    s_nop 0
    buffer_load_dwordx4 v5, s[48:51], s66 offen lds
    s_add_u32 m0, s74, 24576
    s_nop 0
    buffer_load_dwordx4 v4, s[48:51], s79 offen lds
    s_add_u32 m0, s74, 25600
    s_nop 0
    buffer_load_dwordx4 v5, s[48:51], s79 offen lds
    s_add_u32 s66, s66, s68
RL381:
    v_mfma_f32_32x32x16_bf16 v[208:223], v[44:47], v[68:71], v[208:223]
    v_mfma_f32_32x32x16_bf16 v[224:239], v[44:47], v[72:75], v[224:239]
    v_mfma_f32_32x32x16_bf16 v[240:255], v[44:47], v[76:79], v[240:255]
    s_waitcnt lgkmcnt(0)
    v_mfma_f32_32x32x16_bf16 v[128:143], v[32:35], v[48:51], v[128:143]
    ds_read_b64_tr_b16 v[40:41], v12 offset:8192
    ds_read_b64_tr_b16 v[42:43], v12 offset:10240
    v_mfma_f32_32x32x16_bf16 v[144:159], v[32:35], v[52:55], v[144:159]
    ds_read_b64_tr_b16 v[44:45], v13 offset:8192
    ds_read_b64_tr_b16 v[46:47], v13 offset:10240
    v_mfma_f32_32x32x16_bf16 v[160:175], v[32:35], v[56:59], v[160:175]
    ds_read_b128 v[64:67], v9 offset:0
    ds_read_b128 v[68:71], v9 offset:2048
    v_mfma_f32_32x32x16_bf16 v[176:191], v[32:35], v[60:63], v[176:191]
    ds_read_b128 v[72:75], v9 offset:4096
    ds_read_b128 v[76:79], v9 offset:6144
    v_mfma_f32_32x32x16_bf16 v[192:207], v[36:39], v[48:51], v[192:207]
    s_cbranch_vccz RL410
    buffer_load_dword v27, v16, s[8:11], s12 offen
    s_add_u32 s12, s12, s13
RL410:
    v_mfma_f32_32x32x16_bf16 v[208:223], v[36:39], v[52:55], v[208:223]
    v_mfma_f32_32x32x16_bf16 v[224:239], v[36:39], v[56:59], v[224:239]
    v_mfma_f32_32x32x16_bf16 v[240:255], v[36:39], v[60:63], v[240:255]
    s_cbranch_vccnz RL417
    s_waitcnt vmcnt(16)
RL417:
    s_barrier
    s_waitcnt lgkmcnt(0)
    v_mfma_f32_32x32x16_bf16 v[128:143], v[40:43], v[64:67], v[128:143]
    ds_read_b64_tr_b16 v[32:33], v12 offset:32768
    ds_read_b64_tr_b16 v[34:35], v12 offset:34816
    v_mfma_f32_32x32x16_bf16 v[144:159], v[40:43], v[68:71], v[144:159]
    ds_read_b64_tr_b16 v[36:37], v13 offset:32768
    ds_read_b64_tr_b16 v[38:39], v13 offset:34816
    v_mfma_f32_32x32x16_bf16 v[160:175], v[40:43], v[72:75], v[160:175]
    ds_read_b128 v[48:51], v8 offset:32768
    ds_read_b128 v[52:55], v8 offset:34816
    v_mfma_f32_32x32x16_bf16 v[176:191], v[40:43], v[76:79], v[176:191]
    ds_read_b128 v[56:59], v8 offset:36864
    ds_read_b128 v[60:63], v8 offset:38912
    v_mfma_f32_32x32x16_bf16 v[192:207], v[44:47], v[64:67], v[192:207]
    s_cbranch_vccnz RL435
    s_add_u32 s79, s65, 131072
    s_add_u32 m0, s71, 32768
    s_nop 0
    buffer_load_dwordx4 v2, s[44:47], s65 offen lds
    s_add_u32 m0, s71, 33792
    s_nop 0
    buffer_load_dwordx4 v3, s[44:47], s65 offen lds
    s_add_u32 m0, s71, 40960
    s_nop 0
    buffer_load_dwordx4 v2, s[44:47], s79 offen lds
    s_add_u32 m0, s71, 41984
    s_nop 0
    buffer_load_dwordx4 v3, s[44:47], s79 offen lds
    s_add_u32 s65, s65, 64
RL435:
    s_cbranch_vccnz RL447
    s_add_u32 s79, s66, 131072
    s_add_u32 m0, s74, 49152
    s_nop 0
    buffer_load_dwordx4 v4, s[48:51], s66 offen lds
    s_add_u32 m0, s74, 50176
    s_nop 0
    buffer_load_dwordx4 v5, s[48:51], s66 offen lds
    s_add_u32 m0, s74, 57344
    s_nop 0
    buffer_load_dwordx4 v4, s[48:51], s79 offen lds
    s_add_u32 m0, s74, 58368
    s_nop 0
    buffer_load_dwordx4 v5, s[48:51], s79 offen lds
    s_add_u32 s66, s66, s68
RL447:
    v_mfma_f32_32x32x16_bf16 v[208:223], v[44:47], v[68:71], v[208:223]
    v_mfma_f32_32x32x16_bf16 v[224:239], v[44:47], v[72:75], v[224:239]
    v_mfma_f32_32x32x16_bf16 v[240:255], v[44:47], v[76:79], v[240:255]
    s_waitcnt lgkmcnt(0)
    v_mfma_f32_32x32x16_bf16 v[128:143], v[32:35], v[48:51], v[128:143]
    ds_read_b64_tr_b16 v[40:41], v12 offset:40960
    v_mfma_f32_32x32x16_bf16 v[144:159], v[32:35], v[52:55], v[144:159]
    ds_read_b64_tr_b16 v[42:43], v12 offset:43008
    v_mfma_f32_32x32x16_bf16 v[160:175], v[32:35], v[56:59], v[160:175]
    ds_read_b64_tr_b16 v[44:45], v13 offset:40960
    v_mfma_f32_32x32x16_bf16 v[176:191], v[32:35], v[60:63], v[176:191]
    ds_read_b64_tr_b16 v[46:47], v13 offset:43008
    v_mfma_f32_32x32x16_bf16 v[192:207], v[36:39], v[48:51], v[192:207]
    ds_read_b128 v[64:67], v9 offset:32768
    v_mfma_f32_32x32x16_bf16 v[208:223], v[36:39], v[52:55], v[208:223]
    ds_read_b128 v[68:71], v9 offset:34816
    v_mfma_f32_32x32x16_bf16 v[224:239], v[36:39], v[56:59], v[224:239]
    ds_read_b128 v[72:75], v9 offset:36864
    v_mfma_f32_32x32x16_bf16 v[240:255], v[36:39], v[60:63], v[240:255]
    ds_read_b128 v[76:79], v9 offset:38912
    s_cbranch_vccnz RL479
    s_waitcnt vmcnt(16)
RL479:
    s_barrier
    s_waitcnt lgkmcnt(0)
    v_mfma_f32_32x32x16_bf16 v[128:143], v[40:43], v[64:67], v[128:143]
    ds_read_b64_tr_b16 v[32:33], v30 offset:0
    ds_read_b64_tr_b16 v[34:35], v30 offset:2048
    v_mfma_f32_32x32x16_bf16 v[144:159], v[40:43], v[68:71], v[144:159]
    ds_read_b64_tr_b16 v[36:37], v31 offset:0
    ds_read_b64_tr_b16 v[38:39], v31 offset:2048
    v_mfma_f32_32x32x16_bf16 v[160:175], v[40:43], v[72:75], v[160:175]
    ds_read_b128 v[48:51], v28 offset:0
    ds_read_b128 v[52:55], v28 offset:2048
    v_mfma_f32_32x32x16_bf16 v[176:191], v[40:43], v[76:79], v[176:191]
    ds_read_b128 v[56:59], v28 offset:4096
    ds_read_b128 v[60:63], v28 offset:6144
    v_mfma_f32_32x32x16_bf16 v[192:207], v[44:47], v[64:67], v[192:207]
    s_cbranch_vccnz RL497
    s_add_u32 s79, s65, 131072
    s_add_u32 m0, s71, 65536
    s_nop 0
    buffer_load_dwordx4 v2, s[44:47], s65 offen lds
    s_add_u32 m0, s71, 66560
    s_nop 0
    buffer_load_dwordx4 v3, s[44:47], s65 offen lds
    s_add_u32 m0, s71, 73728
    s_nop 0
    buffer_load_dwordx4 v2, s[44:47], s79 offen lds
    s_add_u32 m0, s71, 74752
    s_nop 0
    buffer_load_dwordx4 v3, s[44:47], s79 offen lds
    s_add_u32 s65, s65, 64
RL497:
    s_cbranch_vccnz RL509
    s_add_u32 s79, s66, 131072
    s_add_u32 m0, s74, 81920
    s_nop 0
    buffer_load_dwordx4 v4, s[48:51], s66 offen lds
    s_add_u32 m0, s74, 82944
    s_nop 0
    buffer_load_dwordx4 v5, s[48:51], s66 offen lds
    s_add_u32 m0, s74, 90112
    s_nop 0
    buffer_load_dwordx4 v4, s[48:51], s79 offen lds
    s_add_u32 m0, s74, 91136
    s_nop 0
    buffer_load_dwordx4 v5, s[48:51], s79 offen lds
    s_add_u32 s66, s66, s68
RL509:
    v_mfma_f32_32x32x16_bf16 v[208:223], v[44:47], v[68:71], v[208:223]
    v_mfma_f32_32x32x16_bf16 v[224:239], v[44:47], v[72:75], v[224:239]
    v_mfma_f32_32x32x16_bf16 v[240:255], v[44:47], v[76:79], v[240:255]
    s_waitcnt lgkmcnt(0)
    v_mfma_f32_32x32x16_bf16 v[128:143], v[32:35], v[48:51], v[128:143]
    ds_read_b64_tr_b16 v[40:41], v30 offset:8192
    ds_read_b64_tr_b16 v[42:43], v30 offset:10240
    v_mfma_f32_32x32x16_bf16 v[144:159], v[32:35], v[52:55], v[144:159]
    ds_read_b64_tr_b16 v[44:45], v31 offset:8192
    ds_read_b64_tr_b16 v[46:47], v31 offset:10240
    v_mfma_f32_32x32x16_bf16 v[160:175], v[32:35], v[56:59], v[160:175]
    ds_read_b128 v[64:67], v29 offset:0
    ds_read_b128 v[68:71], v29 offset:2048
    v_mfma_f32_32x32x16_bf16 v[176:191], v[32:35], v[60:63], v[176:191]
    ds_read_b128 v[72:75], v29 offset:4096
    ds_read_b128 v[76:79], v29 offset:6144
    v_mfma_f32_32x32x16_bf16 v[192:207], v[36:39], v[48:51], v[192:207]
    s_cbranch_vccz RL538
    s_waitcnt vmcnt(3)
RL538:
    v_lshlrev_b32 v84, 16, v80
    v_and_b32 v85, 0xffff0000, v80
    v_lshlrev_b32 v86, 16, v81
    v_and_b32 v87, 0xffff0000, v81
    v_lshlrev_b32 v88, 16, v82
    v_and_b32 v89, 0xffff0000, v82
    v_lshlrev_b32 v90, 16, v83
    v_and_b32 v91, 0xffff0000, v83
    v_add_f32 v92, v84, v85
    v_add_f32 v92, v92, v86
    v_add_f32 v92, v92, v87
    v_add_f32 v92, v92, v88
    v_add_f32 v92, v92, v89
    v_add_f32 v92, v92, v90
    v_add_f32 v92, v92, v91
    v_mfma_f32_32x32x16_bf16 v[208:223], v[36:39], v[52:55], v[208:223]
    s_cbranch_vccz RL557
    buffer_load_dword v27, v16, s[8:11], s12 offen
    s_add_u32 s12, s12, s13
RL557:
    v_mfma_f32_32x32x16_bf16 v[224:239], v[36:39], v[56:59], v[224:239]
    v_mfma_f32_32x32x16_bf16 v[240:255], v[36:39], v[60:63], v[240:255]
    s_cbranch_vccnz RL563
    s_waitcnt vmcnt(16)
RL563:
    s_barrier
    s_waitcnt lgkmcnt(0)
    v_mfma_f32_32x32x16_bf16 v[128:143], v[40:43], v[64:67], v[128:143]
    ds_read_b64_tr_b16 v[32:33], v10 offset:0
    ds_read_b64_tr_b16 v[34:35], v10 offset:2048
    v_mfma_f32_32x32x16_bf16 v[144:159], v[40:43], v[68:71], v[144:159]
    ds_read_b64_tr_b16 v[36:37], v11 offset:0
    ds_read_b64_tr_b16 v[38:39], v11 offset:2048
    v_mfma_f32_32x32x16_bf16 v[160:175], v[40:43], v[72:75], v[160:175]
    ds_read_b128 v[48:51], v6 offset:0
    ds_read_b128 v[52:55], v6 offset:2048
    v_mfma_f32_32x32x16_bf16 v[176:191], v[40:43], v[76:79], v[176:191]
    ds_read_b128 v[56:59], v6 offset:4096
    ds_read_b128 v[60:63], v6 offset:6144
    v_mfma_f32_32x32x16_bf16 v[192:207], v[44:47], v[64:67], v[192:207]
    s_cbranch_vccnz RL581
    s_add_u32 s79, s65, 131072
    s_add_u32 m0, s71, 98304
    s_nop 0
    buffer_load_dwordx4 v2, s[44:47], s65 offen lds
    s_add_u32 m0, s71, 99328
    s_nop 0
    buffer_load_dwordx4 v3, s[44:47], s65 offen lds
    s_add_u32 m0, s71, 106496
    s_nop 0
    buffer_load_dwordx4 v2, s[44:47], s79 offen lds
    s_add_u32 m0, s71, 107520
    s_nop 0
    buffer_load_dwordx4 v3, s[44:47], s79 offen lds
    s_add_u32 s65, s65, 64
RL581:
    s_cbranch_vccnz RL593
    s_add_u32 s79, s66, 131072
    s_add_u32 m0, s74, 114688
    s_nop 0
    buffer_load_dwordx4 v4, s[48:51], s66 offen lds
    s_add_u32 m0, s74, 115712
    s_nop 0
    buffer_load_dwordx4 v5, s[48:51], s66 offen lds
    s_add_u32 m0, s74, 122880
    s_nop 0
    buffer_load_dwordx4 v4, s[48:51], s79 offen lds
    s_add_u32 m0, s74, 123904
    s_nop 0
    buffer_load_dwordx4 v5, s[48:51], s79 offen lds
    s_add_u32 s66, s66, s68
RL593:
    v_mfma_f32_32x32x16_bf16 v[208:223], v[44:47], v[68:71], v[208:223]
    v_mfma_f32_32x32x16_bf16 v[224:239], v[44:47], v[72:75], v[224:239]
    v_mfma_f32_32x32x16_bf16 v[240:255], v[44:47], v[76:79], v[240:255]
    s_waitcnt lgkmcnt(0)
    v_mfma_f32_32x32x16_bf16 v[128:143], v[32:35], v[48:51], v[128:143]
    ds_read_b64_tr_b16 v[40:41], v10 offset:8192
    ds_read_b64_tr_b16 v[42:43], v10 offset:10240
    v_mfma_f32_32x32x16_bf16 v[144:159], v[32:35], v[52:55], v[144:159]
    ds_read_b64_tr_b16 v[44:45], v11 offset:8192
    ds_read_b64_tr_b16 v[46:47], v11 offset:10240
    v_mfma_f32_32x32x16_bf16 v[160:175], v[32:35], v[56:59], v[160:175]
    ds_read_b128 v[64:67], v7 offset:0
    ds_read_b128 v[68:71], v7 offset:2048
    v_mfma_f32_32x32x16_bf16 v[176:191], v[32:35], v[60:63], v[176:191]
    ds_read_b128 v[72:75], v7 offset:4096
    ds_read_b128 v[76:79], v7 offset:6144
    v_mfma_f32_32x32x16_bf16 v[192:207], v[36:39], v[48:51], v[192:207]
    v_add_f32_dpp v92, v92, v92 row_shr:1 row_mask:0xf bank_mask:0xf bound_ctrl:0
    s_nop 1
    v_add_f32_dpp v92, v92, v92 row_shr:2 row_mask:0xf bank_mask:0xf bound_ctrl:0
    s_nop 1
    v_add_f32_dpp v92, v92, v92 row_shr:4 row_mask:0xf bank_mask:0xf bound_ctrl:0
    s_nop 1
    v_add_f32_dpp v92, v92, v92 row_shr:8 row_mask:0xf bank_mask:0xf bound_ctrl:0
    s_nop 1
    v_add_f32_dpp v92, v92, v92 row_bcast:15 row_mask:0xa bank_mask:0xf
    s_nop 1
    v_add_f32_dpp v92, v92, v92 row_bcast:31 row_mask:0xc bank_mask:0xf
    s_nop 0
    v_readlane_b32 s78, v92, 63
    s_nop 1
    v_mov_b32 v92, s78
    v_mul_f32 v92, 0x3b000000, v92
    v_mov_b32 v95, 0
    v_mfma_f32_32x32x16_bf16 v[208:223], v[36:39], v[52:55], v[208:223]
    v_mfma_f32_32x32x16_bf16 v[224:239], v[36:39], v[56:59], v[224:239]
    v_mfma_f32_32x32x16_bf16 v[240:255], v[36:39], v[60:63], v[240:255]
    s_cbranch_vccnz RL635
    s_waitcnt vmcnt(16)
RL635:
    s_barrier
    s_waitcnt lgkmcnt(0)
    v_mfma_f32_32x32x16_bf16 v[128:143], v[40:43], v[64:67], v[128:143]
    ds_read_b64_tr_b16 v[32:33], v10 offset:32768
    ds_read_b64_tr_b16 v[34:35], v10 offset:34816
    v_mfma_f32_32x32x16_bf16 v[144:159], v[40:43], v[68:71], v[144:159]
    ds_read_b64_tr_b16 v[36:37], v11 offset:32768
    ds_read_b64_tr_b16 v[38:39], v11 offset:34816
    v_mfma_f32_32x32x16_bf16 v[160:175], v[40:43], v[72:75], v[160:175]
    ds_read_b128 v[48:51], v6 offset:32768
    ds_read_b128 v[52:55], v6 offset:34816
    v_mfma_f32_32x32x16_bf16 v[176:191], v[40:43], v[76:79], v[176:191]
    ds_read_b128 v[56:59], v6 offset:36864
    ds_read_b128 v[60:63], v6 offset:38912
    v_mfma_f32_32x32x16_bf16 v[192:207], v[44:47], v[64:67], v[192:207]
    s_cbranch_vccnz RL653
    s_add_u32 s79, s65, 131072
    s_add_u32 m0, s71, 131072
    s_nop 0
    buffer_load_dwordx4 v2, s[44:47], s65 offen lds
    s_add_u32 m0, s71, 132096
    s_nop 0
    buffer_load_dwordx4 v3, s[44:47], s65 offen lds
    s_add_u32 m0, s71, 139264
    s_nop 0
    buffer_load_dwordx4 v2, s[44:47], s79 offen lds
    s_add_u32 m0, s71, 140288
    s_nop 0
    buffer_load_dwordx4 v3, s[44:47], s79 offen lds
    s_add_u32 s65, s65, 64
RL653:
    s_cbranch_vccnz RL665
    s_add_u32 s79, s66, 131072
    s_add_u32 m0, s74, 147456
    s_nop 0
    buffer_load_dwordx4 v4, s[48:51], s66 offen lds
    s_add_u32 m0, s74, 148480
    s_nop 0
    buffer_load_dwordx4 v5, s[48:51], s66 offen lds
    s_add_u32 m0, s74, 155648
    s_nop 0
    buffer_load_dwordx4 v4, s[48:51], s79 offen lds
    s_add_u32 m0, s74, 156672
    s_nop 0
    buffer_load_dwordx4 v5, s[48:51], s79 offen lds
    s_add_u32 s66, s66, s68
RL665:
    v_mfma_f32_32x32x16_bf16 v[208:223], v[44:47], v[68:71], v[208:223]
    v_mfma_f32_32x32x16_bf16 v[224:239], v[44:47], v[72:75], v[224:239]
    v_mfma_f32_32x32x16_bf16 v[240:255], v[44:47], v[76:79], v[240:255]
    s_waitcnt lgkmcnt(0)
    v_mfma_f32_32x32x16_bf16 v[128:143], v[32:35], v[48:51], v[128:143]
    ds_read_b64_tr_b16 v[40:41], v10 offset:40960
    ds_read_b64_tr_b16 v[42:43], v10 offset:43008
    v_mfma_f32_32x32x16_bf16 v[144:159], v[32:35], v[52:55], v[144:159]
    ds_read_b64_tr_b16 v[44:45], v11 offset:40960
    ds_read_b64_tr_b16 v[46:47], v11 offset:43008
    v_mfma_f32_32x32x16_bf16 v[160:175], v[32:35], v[56:59], v[160:175]
    ds_read_b128 v[64:67], v7 offset:32768
    ds_read_b128 v[68:71], v7 offset:34816
    v_mfma_f32_32x32x16_bf16 v[176:191], v[32:35], v[60:63], v[176:191]
    ds_read_b128 v[72:75], v7 offset:36864
    ds_read_b128 v[76:79], v7 offset:38912
    v_mfma_f32_32x32x16_bf16 v[192:207], v[36:39], v[48:51], v[192:207]
    v_sub_f32 v93, v84, v92
    v_fmac_f32 v95, v93, v93
    v_sub_f32 v93, v85, v92
    v_fmac_f32 v95, v93, v93
    v_sub_f32 v93, v86, v92
    v_fmac_f32 v95, v93, v93
    v_sub_f32 v93, v87, v92
    v_fmac_f32 v95, v93, v93
    v_sub_f32 v93, v88, v92
    v_fmac_f32 v95, v93, v93
    v_sub_f32 v93, v89, v92
    v_fmac_f32 v95, v93, v93
    v_sub_f32 v93, v90, v92
    v_fmac_f32 v95, v93, v93
    v_sub_f32 v93, v91, v92
    v_fmac_f32 v95, v93, v93
    s_cbranch_vccz RL710
    buffer_load_dword v27, v16, s[8:11], s12 offen
    s_add_u32 s12, s12, s13
RL710:
    v_mfma_f32_32x32x16_bf16 v[208:223], v[36:39], v[52:55], v[208:223]
    v_mfma_f32_32x32x16_bf16 v[224:239], v[36:39], v[56:59], v[224:239]
    v_mfma_f32_32x32x16_bf16 v[240:255], v[36:39], v[60:63], v[240:255]
    s_cbranch_vccnz RL717
    s_waitcnt vmcnt(16)
RL717:
    s_barrier
    s_waitcnt lgkmcnt(0)
    v_mfma_f32_32x32x16_bf16 v[128:143], v[40:43], v[64:67], v[128:143]
    ds_read_b64_tr_b16 v[32:33], v12 offset:0
    ds_read_b64_tr_b16 v[34:35], v12 offset:2048
    v_mfma_f32_32x32x16_bf16 v[144:159], v[40:43], v[68:71], v[144:159]
    ds_read_b64_tr_b16 v[36:37], v13 offset:0
    ds_read_b64_tr_b16 v[38:39], v13 offset:2048
    v_mfma_f32_32x32x16_bf16 v[160:175], v[40:43], v[72:75], v[160:175]
    ds_read_b128 v[48:51], v8 offset:0
    ds_read_b128 v[52:55], v8 offset:2048
    v_mfma_f32_32x32x16_bf16 v[176:191], v[40:43], v[76:79], v[176:191]
    ds_read_b128 v[56:59], v8 offset:4096
    ds_read_b128 v[60:63], v8 offset:6144
    v_mfma_f32_32x32x16_bf16 v[192:207], v[44:47], v[64:67], v[192:207]
    s_cbranch_vccnz RL735
    s_add_u32 s79, s65, 131072
    s_add_u32 m0, s71, 0
    s_nop 0
    buffer_load_dwordx4 v2, s[44:47], s65 offen lds
    s_add_u32 m0, s71, 1024
    s_nop 0
    buffer_load_dwordx4 v3, s[44:47], s65 offen lds
    s_add_u32 m0, s71, 8192
    s_nop 0
    buffer_load_dwordx4 v2, s[44:47], s79 offen lds
    s_add_u32 m0, s71, 9216
    s_nop 0
    buffer_load_dwordx4 v3, s[44:47], s79 offen lds
    s_add_u32 s65, s65, 64
RL735:
    s_cbranch_vccnz RL747
    s_add_u32 s79, s66, 131072
    s_add_u32 m0, s74, 16384
    s_nop 0
    buffer_load_dwordx4 v4, s[48:51], s66 offen lds
    s_add_u32 m0, s74, 17408
    s_nop 0
    buffer_load_dwordx4 v5, s[48:51], s66 offen lds
    s_add_u32 m0, s74, 24576
    s_nop 0
    buffer_load_dwordx4 v4, s[48:51], s79 offen lds
    s_add_u32 m0, s74, 25600
    s_nop 0
    buffer_load_dwordx4 v5, s[48:51], s79 offen lds
    s_add_u32 s66, s66, s68
RL747:
    v_mfma_f32_32x32x16_bf16 v[208:223], v[44:47], v[68:71], v[208:223]
    v_mfma_f32_32x32x16_bf16 v[224:239], v[44:47], v[72:75], v[224:239]
    v_mfma_f32_32x32x16_bf16 v[240:255], v[44:47], v[76:79], v[240:255]
    s_waitcnt lgkmcnt(0)
    v_mfma_f32_32x32x16_bf16 v[128:143], v[32:35], v[48:51], v[128:143]
    ds_read_b64_tr_b16 v[40:41], v12 offset:8192
    ds_read_b64_tr_b16 v[42:43], v12 offset:10240
    v_mfma_f32_32x32x16_bf16 v[144:159], v[32:35], v[52:55], v[144:159]
    ds_read_b64_tr_b16 v[44:45], v13 offset:8192
    ds_read_b64_tr_b16 v[46:47], v13 offset:10240
    v_mfma_f32_32x32x16_bf16 v[160:175], v[32:35], v[56:59], v[160:175]
    ds_read_b128 v[64:67], v9 offset:0
    ds_read_b128 v[68:71], v9 offset:2048
    v_mfma_f32_32x32x16_bf16 v[176:191], v[32:35], v[60:63], v[176:191]
    ds_read_b128 v[72:75], v9 offset:4096
    ds_read_b128 v[76:79], v9 offset:6144
    v_mfma_f32_32x32x16_bf16 v[192:207], v[36:39], v[48:51], v[192:207]
    v_add_f32_dpp v95, v95, v95 row_shr:1 row_mask:0xf bank_mask:0xf bound_ctrl:0
    s_nop 1
    v_add_f32_dpp v95, v95, v95 row_shr:2 row_mask:0xf bank_mask:0xf bound_ctrl:0
    s_nop 1
    v_add_f32_dpp v95, v95, v95 row_shr:4 row_mask:0xf bank_mask:0xf bound_ctrl:0
    s_nop 1
    v_add_f32_dpp v95, v95, v95 row_shr:8 row_mask:0xf bank_mask:0xf bound_ctrl:0
    s_nop 1
    v_add_f32_dpp v95, v95, v95 row_bcast:15 row_mask:0xa bank_mask:0xf
    s_nop 1
    v_add_f32_dpp v95, v95, v95 row_bcast:31 row_mask:0xc bank_mask:0xf
    s_nop 0
    v_readlane_b32 s78, v95, 63
    s_nop 1
    v_mov_b32 v95, s78
    v_mul_f32 v95, 0x3b000000, v95
    v_cvt_pk_bf16_f32 v93, v92, v92
    v_lshlrev_b32 v92, 16, v93
    v_cvt_pk_bf16_f32 v93, v95, v95
    v_lshlrev_b32 v95, 16, v93
    v_add_f32 v95, 0x3727c5ac, v95
    v_cvt_pk_bf16_f32 v93, v95, v95
    v_lshlrev_b32 v95, 16, v93
    v_sqrt_f32 v95, v95
    s_nop 0
    v_cvt_pk_bf16_f32 v93, v95, v95
    v_lshlrev_b32 v95, 16, v93
    v_rcp_f32 v95, v95
    v_mfma_f32_32x32x16_bf16 v[208:223], v[36:39], v[52:55], v[208:223]
    v_mfma_f32_32x32x16_bf16 v[224:239], v[36:39], v[56:59], v[224:239]
    v_mfma_f32_32x32x16_bf16 v[240:255], v[36:39], v[60:63], v[240:255]
    s_cbranch_vccnz RL799
    s_waitcnt vmcnt(16)
RL799:
    s_barrier
    s_waitcnt lgkmcnt(0)
    v_mfma_f32_32x32x16_bf16 v[128:143], v[40:43], v[64:67], v[128:143]
    ds_read_b64_tr_b16 v[32:33], v12 offset:32768
    ds_read_b64_tr_b16 v[34:35], v12 offset:34816
    v_mfma_f32_32x32x16_bf16 v[144:159], v[40:43], v[68:71], v[144:159]
    ds_read_b64_tr_b16 v[36:37], v13 offset:32768
    ds_read_b64_tr_b16 v[38:39], v13 offset:34816
    v_mfma_f32_32x32x16_bf16 v[160:175], v[40:43], v[72:75], v[160:175]
    ds_read_b128 v[48:51], v8 offset:32768
    ds_read_b128 v[52:55], v8 offset:34816
    v_mfma_f32_32x32x16_bf16 v[176:191], v[40:43], v[76:79], v[176:191]
    ds_read_b128 v[56:59], v8 offset:36864
    ds_read_b128 v[60:63], v8 offset:38912
    v_mfma_f32_32x32x16_bf16 v[192:207], v[44:47], v[64:67], v[192:207]
    s_cbranch_vccnz RL817
    s_add_u32 s79, s65, 131072
    s_add_u32 m0, s71, 32768
    s_nop 0
    buffer_load_dwordx4 v2, s[44:47], s65 offen lds
    s_add_u32 m0, s71, 33792
    s_nop 0
    buffer_load_dwordx4 v3, s[44:47], s65 offen lds
    s_add_u32 m0, s71, 40960
    s_nop 0
    buffer_load_dwordx4 v2, s[44:47], s79 offen lds
    s_add_u32 m0, s71, 41984
    s_nop 0
    buffer_load_dwordx4 v3, s[44:47], s79 offen lds
    s_add_u32 s65, s65, 64
RL817:
    s_cbranch_vccnz RL829
    s_add_u32 s79, s66, 131072
    s_add_u32 m0, s74, 49152
    s_nop 0
    buffer_load_dwordx4 v4, s[48:51], s66 offen lds
    s_add_u32 m0, s74, 50176
    s_nop 0
    buffer_load_dwordx4 v5, s[48:51], s66 offen lds
    s_add_u32 m0, s74, 57344
    s_nop 0
    buffer_load_dwordx4 v4, s[48:51], s79 offen lds
    s_add_u32 m0, s74, 58368
    s_nop 0
    buffer_load_dwordx4 v5, s[48:51], s79 offen lds
    s_add_u32 s66, s66, s68
RL829:
    v_mfma_f32_32x32x16_bf16 v[208:223], v[44:47], v[68:71], v[208:223]
    v_mfma_f32_32x32x16_bf16 v[224:239], v[44:47], v[72:75], v[224:239]
    v_mfma_f32_32x32x16_bf16 v[240:255], v[44:47], v[76:79], v[240:255]
    s_waitcnt lgkmcnt(0)
    v_mfma_f32_32x32x16_bf16 v[128:143], v[32:35], v[48:51], v[128:143]
    ds_read_b64_tr_b16 v[40:41], v12 offset:40960
    ds_read_b64_tr_b16 v[42:43], v12 offset:43008
    v_mfma_f32_32x32x16_bf16 v[144:159], v[32:35], v[52:55], v[144:159]
    ds_read_b64_tr_b16 v[44:45], v13 offset:40960
    ds_read_b64_tr_b16 v[46:47], v13 offset:43008
    v_mfma_f32_32x32x16_bf16 v[160:175], v[32:35], v[56:59], v[160:175]
    ds_read_b128 v[64:67], v9 offset:32768
    ds_read_b128 v[68:71], v9 offset:34816
    v_mfma_f32_32x32x16_bf16 v[176:191], v[32:35], v[60:63], v[176:191]
    ds_read_b128 v[72:75], v9 offset:36864
    ds_read_b128 v[76:79], v9 offset:38912
    v_mfma_f32_32x32x16_bf16 v[192:207], v[36:39], v[48:51], v[192:207]
    v_sub_f32 v84, v84, v92
    v_sub_f32 v85, v85, v92
    v_sub_f32 v86, v86, v92
    v_sub_f32 v87, v87, v92
    v_sub_f32 v88, v88, v92
    v_sub_f32 v89, v89, v92
    v_sub_f32 v90, v90, v92
    v_sub_f32 v91, v91, v92
    v_cvt_pk_bf16_f32 v80, v84, v85
    v_cvt_pk_bf16_f32 v81, v86, v87
    v_cvt_pk_bf16_f32 v82, v88, v89
    v_cvt_pk_bf16_f32 v83, v90, v91
    v_lshlrev_b32 v84, 16, v80
    v_and_b32 v85, 0xffff0000, v80
    v_lshlrev_b32 v86, 16, v81
    v_and_b32 v87, 0xffff0000, v81
    v_lshlrev_b32 v88, 16, v82
    v_and_b32 v89, 0xffff0000, v82
    v_lshlrev_b32 v90, 16, v83
    v_and_b32 v91, 0xffff0000, v83
    s_cbranch_vccz RL878
    buffer_load_dword v27, v16, s[8:11], s12 offen
    s_add_u32 s12, s12, s13
RL878:
    v_mfma_f32_32x32x16_bf16 v[208:223], v[36:39], v[52:55], v[208:223]
    v_mfma_f32_32x32x16_bf16 v[224:239], v[36:39], v[56:59], v[224:239]
    v_mfma_f32_32x32x16_bf16 v[240:255], v[36:39], v[60:63], v[240:255]
    s_cbranch_vccnz RL885
    s_waitcnt vmcnt(16)
RL885:
    s_barrier
    s_waitcnt lgkmcnt(0)
    v_mfma_f32_32x32x16_bf16 v[128:143], v[40:43], v[64:67], v[128:143]
    ds_read_b64_tr_b16 v[32:33], v30 offset:0
    ds_read_b64_tr_b16 v[34:35], v30 offset:2048
    v_mfma_f32_32x32x16_bf16 v[144:159], v[40:43], v[68:71], v[144:159]
    ds_read_b64_tr_b16 v[36:37], v31 offset:0
    ds_read_b64_tr_b16 v[38:39], v31 offset:2048
    v_mfma_f32_32x32x16_bf16 v[160:175], v[40:43], v[72:75], v[160:175]
    ds_read_b128 v[48:51], v28 offset:0
    ds_read_b128 v[52:55], v28 offset:2048
    v_mfma_f32_32x32x16_bf16 v[176:191], v[40:43], v[76:79], v[176:191]
    ds_read_b128 v[56:59], v28 offset:4096
    ds_read_b128 v[60:63], v28 offset:6144
    v_mfma_f32_32x32x16_bf16 v[192:207], v[44:47], v[64:67], v[192:207]
    s_cbranch_vccnz RL903
    s_add_u32 s79, s65, 131072
    s_add_u32 m0, s71, 65536
    s_nop 0
    buffer_load_dwordx4 v2, s[44:47], s65 offen lds
    s_add_u32 m0, s71, 66560
    s_nop 0
    buffer_load_dwordx4 v3, s[44:47], s65 offen lds
    s_add_u32 m0, s71, 73728
    s_nop 0
    buffer_load_dwordx4 v2, s[44:47], s79 offen lds
    s_add_u32 m0, s71, 74752
    s_nop 0
    buffer_load_dwordx4 v3, s[44:47], s79 offen lds
    s_add_u32 s65, s65, 64
RL903:
    s_cbranch_vccnz RL915
    s_add_u32 s79, s66, 131072
    s_add_u32 m0, s74, 81920
    s_nop 0
    buffer_load_dwordx4 v4, s[48:51], s66 offen lds
    s_add_u32 m0, s74, 82944
    s_nop 0
    buffer_load_dwordx4 v5, s[48:51], s66 offen lds
    s_add_u32 m0, s74, 90112
    s_nop 0
    buffer_load_dwordx4 v4, s[48:51], s79 offen lds
    s_add_u32 m0, s74, 91136
    s_nop 0
    buffer_load_dwordx4 v5, s[48:51], s79 offen lds
    s_add_u32 s66, s66, s68
RL915:
    v_mfma_f32_32x32x16_bf16 v[208:223], v[44:47], v[68:71], v[208:223]
    v_mfma_f32_32x32x16_bf16 v[224:239], v[44:47], v[72:75], v[224:239]
    v_mfma_f32_32x32x16_bf16 v[240:255], v[44:47], v[76:79], v[240:255]
    s_waitcnt lgkmcnt(0)
    v_mfma_f32_32x32x16_bf16 v[128:143], v[32:35], v[48:51], v[128:143]
    ds_read_b64_tr_b16 v[40:41], v30 offset:8192
    ds_read_b64_tr_b16 v[42:43], v30 offset:10240
    v_mfma_f32_32x32x16_bf16 v[144:159], v[32:35], v[52:55], v[144:159]
    ds_read_b64_tr_b16 v[44:45], v31 offset:8192
    ds_read_b64_tr_b16 v[46:47], v31 offset:10240
    v_mfma_f32_32x32x16_bf16 v[160:175], v[32:35], v[56:59], v[160:175]
    ds_read_b128 v[64:67], v29 offset:0
    ds_read_b128 v[68:71], v29 offset:2048
    v_mfma_f32_32x32x16_bf16 v[176:191], v[32:35], v[60:63], v[176:191]
    ds_read_b128 v[72:75], v29 offset:4096
    ds_read_b128 v[76:79], v29 offset:6144
    v_mfma_f32_32x32x16_bf16 v[192:207], v[36:39], v[48:51], v[192:207]
    v_mul_f32 v84, v84, v95
    v_mul_f32 v85, v85, v95
    v_mul_f32 v86, v86, v95
    v_mul_f32 v87, v87, v95
    v_mul_f32 v88, v88, v95
    v_mul_f32 v89, v89, v95
    v_mul_f32 v90, v90, v95
    v_mul_f32 v91, v91, v95
    v_cvt_pk_bf16_f32 v80, v84, v85
    v_cvt_pk_bf16_f32 v81, v86, v87
    v_cvt_pk_bf16_f32 v82, v88, v89
    v_cvt_pk_bf16_f32 v83, v90, v91
    buffer_store_dwordx4 v[80:83], v19, s[60:63], 0 offen sc1
    v_mfma_f32_32x32x16_bf16 v[208:223], v[36:39], v[52:55], v[208:223]
    v_mfma_f32_32x32x16_bf16 v[224:239], v[36:39], v[56:59], v[224:239]
    v_mfma_f32_32x32x16_bf16 v[240:255], v[36:39], v[60:63], v[240:255]
    s_cbranch_vccnz RL960
    s_waitcnt vmcnt(17)
RL960:
    s_barrier
    s_waitcnt lgkmcnt(0)
    v_mfma_f32_32x32x16_bf16 v[128:143], v[40:43], v[64:67], v[128:143]
    ds_read_b64_tr_b16 v[32:33], v10 offset:0
    ds_read_b64_tr_b16 v[34:35], v10 offset:2048
    v_mfma_f32_32x32x16_bf16 v[144:159], v[40:43], v[68:71], v[144:159]
    ds_read_b64_tr_b16 v[36:37], v11 offset:0
    ds_read_b64_tr_b16 v[38:39], v11 offset:2048
    v_mfma_f32_32x32x16_bf16 v[160:175], v[40:43], v[72:75], v[160:175]
    ds_read_b128 v[48:51], v6 offset:0
    ds_read_b128 v[52:55], v6 offset:2048
    v_mfma_f32_32x32x16_bf16 v[176:191], v[40:43], v[76:79], v[176:191]
    ds_read_b128 v[56:59], v6 offset:4096
    ds_read_b128 v[60:63], v6 offset:6144
    v_mfma_f32_32x32x16_bf16 v[192:207], v[44:47], v[64:67], v[192:207]
    s_cbranch_vccnz RL978
    s_add_u32 s79, s65, 131072
    s_add_u32 m0, s71, 98304
    s_nop 0
    buffer_load_dwordx4 v2, s[44:47], s65 offen lds
    s_add_u32 m0, s71, 99328
    s_nop 0
    buffer_load_dwordx4 v3, s[44:47], s65 offen lds
    s_add_u32 m0, s71, 106496
    s_nop 0
    buffer_load_dwordx4 v2, s[44:47], s79 offen lds
    s_add_u32 m0, s71, 107520
    s_nop 0
    buffer_load_dwordx4 v3, s[44:47], s79 offen lds
    s_add_u32 s65, s65, 64
RL978:
    s_cbranch_vccnz RL990
    s_add_u32 s79, s66, 131072
    s_add_u32 m0, s74, 114688
    s_nop 0
    buffer_load_dwordx4 v4, s[48:51], s66 offen lds
    s_add_u32 m0, s74, 115712
    s_nop 0
    buffer_load_dwordx4 v5, s[48:51], s66 offen lds
    s_add_u32 m0, s74, 122880
    s_nop 0
    buffer_load_dwordx4 v4, s[48:51], s79 offen lds
    s_add_u32 m0, s74, 123904
    s_nop 0
    buffer_load_dwordx4 v5, s[48:51], s79 offen lds
    s_add_u32 s66, s66, s68
RL990:
    v_mfma_f32_32x32x16_bf16 v[208:223], v[44:47], v[68:71], v[208:223]
    v_mfma_f32_32x32x16_bf16 v[224:239], v[44:47], v[72:75], v[224:239]
    v_mfma_f32_32x32x16_bf16 v[240:255], v[44:47], v[76:79], v[240:255]
    s_waitcnt lgkmcnt(0)
    v_mfma_f32_32x32x16_bf16 v[128:143], v[32:35], v[48:51], v[128:143]
    ds_read_b64_tr_b16 v[40:41], v10 offset:8192
    v_mfma_f32_32x32x16_bf16 v[144:159], v[32:35], v[52:55], v[144:159]
    ds_read_b64_tr_b16 v[42:43], v10 offset:10240
    v_mfma_f32_32x32x16_bf16 v[160:175], v[32:35], v[56:59], v[160:175]
    ds_read_b64_tr_b16 v[44:45], v11 offset:8192
    v_mfma_f32_32x32x16_bf16 v[176:191], v[32:35], v[60:63], v[176:191]
    ds_read_b64_tr_b16 v[46:47], v11 offset:10240
    v_mfma_f32_32x32x16_bf16 v[192:207], v[36:39], v[48:51], v[192:207]
    ds_read_b128 v[64:67], v7 offset:0
    v_mfma_f32_32x32x16_bf16 v[208:223], v[36:39], v[52:55], v[208:223]
    ds_read_b128 v[68:71], v7 offset:2048
    v_mfma_f32_32x32x16_bf16 v[224:239], v[36:39], v[56:59], v[224:239]
    ds_read_b128 v[72:75], v7 offset:4096
    v_mfma_f32_32x32x16_bf16 v[240:255], v[36:39], v[60:63], v[240:255]
    ds_read_b128 v[76:79], v7 offset:6144
    s_cbranch_vccnz RL1022
    s_waitcnt vmcnt(17)
RL1022:
    s_barrier
    s_waitcnt lgkmcnt(0)
    v_mfma_f32_32x32x16_bf16 v[128:143], v[40:43], v[64:67], v[128:143]
    ds_read_b64_tr_b16 v[32:33], v10 offset:32768
    ds_read_b64_tr_b16 v[34:35], v10 offset:34816
    v_mfma_f32_32x32x16_bf16 v[144:159], v[40:43], v[68:71], v[144:159]
    ds_read_b64_tr_b16 v[36:37], v11 offset:32768
    ds_read_b64_tr_b16 v[38:39], v11 offset:34816
    v_mfma_f32_32x32x16_bf16 v[160:175], v[40:43], v[72:75], v[160:175]
    ds_read_b128 v[48:51], v6 offset:32768
    ds_read_b128 v[52:55], v6 offset:34816
    v_mfma_f32_32x32x16_bf16 v[176:191], v[40:43], v[76:79], v[176:191]
    ds_read_b128 v[56:59], v6 offset:36864
    ds_read_b128 v[60:63], v6 offset:38912
    v_mfma_f32_32x32x16_bf16 v[192:207], v[44:47], v[64:67], v[192:207]
    s_cbranch_vccnz RL1040
    s_add_u32 s79, s65, 131072
    s_add_u32 m0, s71, 131072
    s_nop 0
    buffer_load_dwordx4 v2, s[44:47], s65 offen lds
    s_add_u32 m0, s71, 132096
    s_nop 0
    buffer_load_dwordx4 v3, s[44:47], s65 offen lds
    s_add_u32 m0, s71, 139264
    s_nop 0
    buffer_load_dwordx4 v2, s[44:47], s79 offen lds
    s_add_u32 m0, s71, 140288
    s_nop 0
    buffer_load_dwordx4 v3, s[44:47], s79 offen lds
    s_add_u32 s65, s65, 64
RL1040:
    s_cbranch_vccnz RL1052
    s_add_u32 s79, s66, 131072
    s_add_u32 m0, s74, 147456
    s_nop 0
    buffer_load_dwordx4 v4, s[48:51], s66 offen lds
    s_add_u32 m0, s74, 148480
    s_nop 0
    buffer_load_dwordx4 v5, s[48:51], s66 offen lds
    s_add_u32 m0, s74, 155648
    s_nop 0
    buffer_load_dwordx4 v4, s[48:51], s79 offen lds
    s_add_u32 m0, s74, 156672
    s_nop 0
    buffer_load_dwordx4 v5, s[48:51], s79 offen lds
    s_add_u32 s66, s66, s68
RL1052:
    v_mfma_f32_32x32x16_bf16 v[208:223], v[44:47], v[68:71], v[208:223]
    v_mfma_f32_32x32x16_bf16 v[224:239], v[44:47], v[72:75], v[224:239]
    v_mfma_f32_32x32x16_bf16 v[240:255], v[44:47], v[76:79], v[240:255]
    s_waitcnt lgkmcnt(0)
    v_mfma_f32_32x32x16_bf16 v[128:143], v[32:35], v[48:51], v[128:143]
    ds_read_b64_tr_b16 v[40:41], v10 offset:40960
    v_mfma_f32_32x32x16_bf16 v[144:159], v[32:35], v[52:55], v[144:159]
    ds_read_b64_tr_b16 v[42:43], v10 offset:43008
    v_mfma_f32_32x32x16_bf16 v[160:175], v[32:35], v[56:59], v[160:175]
    ds_read_b64_tr_b16 v[44:45], v11 offset:40960
    v_mfma_f32_32x32x16_bf16 v[176:191], v[32:35], v[60:63], v[176:191]
    ds_read_b64_tr_b16 v[46:47], v11 offset:43008
    v_mfma_f32_32x32x16_bf16 v[192:207], v[36:39], v[48:51], v[192:207]
    ds_read_b128 v[64:67], v7 offset:32768
    v_mfma_f32_32x32x16_bf16 v[208:223], v[36:39], v[52:55], v[208:223]
    ds_read_b128 v[68:71], v7 offset:34816
    v_mfma_f32_32x32x16_bf16 v[224:239], v[36:39], v[56:59], v[224:239]
    ds_read_b128 v[72:75], v7 offset:36864
    v_mfma_f32_32x32x16_bf16 v[240:255], v[36:39], v[60:63], v[240:255]
    ds_read_b128 v[76:79], v7 offset:38912
    s_cbranch_vccnz RL1084
    s_waitcnt vmcnt(17)
RL1084:
    s_barrier
    s_waitcnt lgkmcnt(0)
    v_mfma_f32_32x32x16_bf16 v[128:143], v[40:43], v[64:67], v[128:143]
    ds_read_b64_tr_b16 v[32:33], v12 offset:0
    ds_read_b64_tr_b16 v[34:35], v12 offset:2048
    v_mfma_f32_32x32x16_bf16 v[144:159], v[40:43], v[68:71], v[144:159]
    ds_read_b64_tr_b16 v[36:37], v13 offset:0
    ds_read_b64_tr_b16 v[38:39], v13 offset:2048
    v_mfma_f32_32x32x16_bf16 v[160:175], v[40:43], v[72:75], v[160:175]
    ds_read_b128 v[48:51], v8 offset:0
    ds_read_b128 v[52:55], v8 offset:2048
    v_mfma_f32_32x32x16_bf16 v[176:191], v[40:43], v[76:79], v[176:191]
    ds_read_b128 v[56:59], v8 offset:4096
    ds_read_b128 v[60:63], v8 offset:6144
    v_mfma_f32_32x32x16_bf16 v[192:207], v[44:47], v[64:67], v[192:207]
    s_cbranch_vccnz RL1102
    s_add_u32 s79, s65, 131072
    s_add_u32 m0, s71, 0
    s_nop 0
    buffer_load_dwordx4 v2, s[44:47], s65 offen lds
    s_add_u32 m0, s71, 1024
    s_nop 0
    buffer_load_dwordx4 v3, s[44:47], s65 offen lds
    s_add_u32 m0, s71, 8192
    s_nop 0
    buffer_load_dwordx4 v2, s[44:47], s79 offen lds
    s_add_u32 m0, s71, 9216
    s_nop 0
    buffer_load_dwordx4 v3, s[44:47], s79 offen lds
    s_add_u32 s65, s65, 64
RL1102:
    s_cbranch_vccnz RL1114
    s_add_u32 s79, s66, 131072
    s_add_u32 m0, s74, 16384
    s_nop 0
    buffer_load_dwordx4 v4, s[48:51], s66 offen lds
    s_add_u32 m0, s74, 17408
    s_nop 0
    buffer_load_dwordx4 v5, s[48:51], s66 offen lds
    s_add_u32 m0, s74, 24576
    s_nop 0
    buffer_load_dwordx4 v4, s[48:51], s79 offen lds
    s_add_u32 m0, s74, 25600
    s_nop 0
    buffer_load_dwordx4 v5, s[48:51], s79 offen lds
    s_add_u32 s66, s66, s68
RL1114:
    v_mfma_f32_32x32x16_bf16 v[208:223], v[44:47], v[68:71], v[208:223]
    v_mfma_f32_32x32x16_bf16 v[224:239], v[44:47], v[72:75], v[224:239]
    v_mfma_f32_32x32x16_bf16 v[240:255], v[44:47], v[76:79], v[240:255]
    s_waitcnt lgkmcnt(0)
    v_mfma_f32_32x32x16_bf16 v[128:143], v[32:35], v[48:51], v[128:143]
    ds_read_b64_tr_b16 v[40:41], v12 offset:8192
    ds_read_b64_tr_b16 v[42:43], v12 offset:10240
    v_mfma_f32_32x32x16_bf16 v[144:159], v[32:35], v[52:55], v[144:159]
    ds_read_b64_tr_b16 v[44:45], v13 offset:8192
    ds_read_b64_tr_b16 v[46:47], v13 offset:10240
    v_mfma_f32_32x32x16_bf16 v[160:175], v[32:35], v[56:59], v[160:175]
    ds_read_b128 v[64:67], v9 offset:0
    ds_read_b128 v[68:71], v9 offset:2048
    v_mfma_f32_32x32x16_bf16 v[176:191], v[32:35], v[60:63], v[176:191]
    ds_read_b128 v[72:75], v9 offset:4096
    ds_read_b128 v[76:79], v9 offset:6144
    v_mfma_f32_32x32x16_bf16 v[192:207], v[36:39], v[48:51], v[192:207]
    s_lshl_b32 s72, s2, 9
    v_add_u32 v20, s72, v0
    v_lshlrev_b32 v20, 6, v20
    s_mov_b32 s56, s20
    s_and_b32 s57, s21, 0xffff
    s_mov_b32 s58, 0x400000
    s_mov_b32 s59, 0x20000
    v_subrev_u32 v21, 0x0, v20
    buffer_load_dword v27, v21, s[56:59], 0 offen
    v_mfma_f32_32x32x16_bf16 v[208:223], v[36:39], v[52:55], v[208:223]
    s_mov_b32 s56, s30
    s_and_b32 s57, s31, 0xffff
    s_mov_b32 s58, 0x1c0000
    s_mov_b32 s59, 0x20000
    v_subrev_u32 v21, 0x400000, v20
    buffer_load_dword v27, v21, s[56:59], 0 offen
    v_mfma_f32_32x32x16_bf16 v[224:239], v[36:39], v[56:59], v[224:239]
    v_mfma_f32_32x32x16_bf16 v[240:255], v[36:39], v[60:63], v[240:255]
    s_cbranch_vccnz RL1161
    s_waitcnt vmcnt(18)
RL1161:
    s_barrier
    s_waitcnt lgkmcnt(0)
    v_mfma_f32_32x32x16_bf16 v[128:143], v[40:43], v[64:67], v[128:143]
    ds_read_b64_tr_b16 v[32:33], v12 offset:32768
    v_mfma_f32_32x32x16_bf16 v[144:159], v[40:43], v[68:71], v[144:159]
    ds_read_b64_tr_b16 v[34:35], v12 offset:34816
    v_mfma_f32_32x32x16_bf16 v[160:175], v[40:43], v[72:75], v[160:175]
    ds_read_b64_tr_b16 v[36:37], v13 offset:32768
    v_mfma_f32_32x32x16_bf16 v[176:191], v[40:43], v[76:79], v[176:191]
    ds_read_b64_tr_b16 v[38:39], v13 offset:34816
    v_mfma_f32_32x32x16_bf16 v[192:207], v[44:47], v[64:67], v[192:207]
    ds_read_b128 v[48:51], v8 offset:32768
    v_mfma_f32_32x32x16_bf16 v[208:223], v[44:47], v[68:71], v[208:223]
    ds_read_b128 v[52:55], v8 offset:34816
    v_mfma_f32_32x32x16_bf16 v[224:239], v[44:47], v[72:75], v[224:239]
    ds_read_b128 v[56:59], v8 offset:36864
    v_mfma_f32_32x32x16_bf16 v[240:255], v[44:47], v[76:79], v[240:255]
    ds_read_b128 v[60:63], v8 offset:38912
    s_waitcnt lgkmcnt(0)
    v_mfma_f32_32x32x16_bf16 v[128:143], v[32:35], v[48:51], v[128:143]
    ds_read_b64_tr_b16 v[40:41], v12 offset:40960
    v_mfma_f32_32x32x16_bf16 v[144:159], v[32:35], v[52:55], v[144:159]
    ds_read_b64_tr_b16 v[42:43], v12 offset:43008
    v_mfma_f32_32x32x16_bf16 v[160:175], v[32:35], v[56:59], v[160:175]
    ds_read_b64_tr_b16 v[44:45], v13 offset:40960
    v_mfma_f32_32x32x16_bf16 v[176:191], v[32:35], v[60:63], v[176:191]
    ds_read_b64_tr_b16 v[46:47], v13 offset:43008
    v_mfma_f32_32x32x16_bf16 v[192:207], v[36:39], v[48:51], v[192:207]
    ds_read_b128 v[64:67], v9 offset:32768
    v_mfma_f32_32x32x16_bf16 v[208:223], v[36:39], v[52:55], v[208:223]
    ds_read_b128 v[68:71], v9 offset:34816
    v_mfma_f32_32x32x16_bf16 v[224:239], v[36:39], v[56:59], v[224:239]
    ds_read_b128 v[72:75], v9 offset:36864
    v_mfma_f32_32x32x16_bf16 v[240:255], v[36:39], v[60:63], v[240:255]
    ds_read_b128 v[76:79], v9 offset:38912
    s_cbranch_vccnz RL1199
    s_waitcnt vmcnt(10)
RL1199:
    s_barrier
    s_waitcnt lgkmcnt(0)
    v_mfma_f32_32x32x16_bf16 v[128:143], v[40:43], v[64:67], v[128:143]
    ds_read_b64_tr_b16 v[32:33], v30 offset:0
    v_mfma_f32_32x32x16_bf16 v[144:159], v[40:43], v[68:71], v[144:159]
    ds_read_b64_tr_b16 v[34:35], v30 offset:2048
    v_mfma_f32_32x32x16_bf16 v[160:175], v[40:43], v[72:75], v[160:175]
    ds_read_b64_tr_b16 v[36:37], v31 offset:0
    v_mfma_f32_32x32x16_bf16 v[176:191], v[40:43], v[76:79], v[176:191]
    ds_read_b64_tr_b16 v[38:39], v31 offset:2048
    v_mfma_f32_32x32x16_bf16 v[192:207], v[44:47], v[64:67], v[192:207]
    ds_read_b128 v[48:51], v28 offset:0
    v_mfma_f32_32x32x16_bf16 v[208:223], v[44:47], v[68:71], v[208:223]
    ds_read_b128 v[52:55], v28 offset:2048
    v_mfma_f32_32x32x16_bf16 v[224:239], v[44:47], v[72:75], v[224:239]
    ds_read_b128 v[56:59], v28 offset:4096
    v_mfma_f32_32x32x16_bf16 v[240:255], v[44:47], v[76:79], v[240:255]
    ds_read_b128 v[60:63], v28 offset:6144
    s_waitcnt lgkmcnt(0)
    v_mfma_f32_32x32x16_bf16 v[128:143], v[32:35], v[48:51], v[128:143]
    ds_read_b64_tr_b16 v[40:41], v30 offset:8192
    v_mfma_f32_32x32x16_bf16 v[144:159], v[32:35], v[52:55], v[144:159]
    ds_read_b64_tr_b16 v[42:43], v30 offset:10240
    v_mfma_f32_32x32x16_bf16 v[160:175], v[32:35], v[56:59], v[160:175]
    ds_read_b64_tr_b16 v[44:45], v31 offset:8192
    v_mfma_f32_32x32x16_bf16 v[176:191], v[32:35], v[60:63], v[176:191]
    ds_read_b64_tr_b16 v[46:47], v31 offset:10240
    v_mfma_f32_32x32x16_bf16 v[192:207], v[36:39], v[48:51], v[192:207]
    ds_read_b128 v[64:67], v29 offset:0
    v_mfma_f32_32x32x16_bf16 v[208:223], v[36:39], v[52:55], v[208:223]
    ds_read_b128 v[68:71], v29 offset:2048
    v_mfma_f32_32x32x16_bf16 v[224:239], v[36:39], v[56:59], v[224:239]
    ds_read_b128 v[72:75], v29 offset:4096
    v_mfma_f32_32x32x16_bf16 v[240:255], v[36:39], v[60:63], v[240:255]
    ds_read_b128 v[76:79], v29 offset:6144
    s_cbranch_vccnz RL1237
    s_waitcnt vmcnt(2)
RL1237:
    s_barrier
    s_waitcnt lgkmcnt(0)
    v_mfma_f32_32x32x16_bf16 v[128:143], v[40:43], v[64:67], v[128:143]
    ds_read_b64_tr_b16 v[32:33], v10 offset:0
    v_mfma_f32_32x32x16_bf16 v[144:159], v[40:43], v[68:71], v[144:159]
    ds_read_b64_tr_b16 v[34:35], v10 offset:2048
    v_mfma_f32_32x32x16_bf16 v[160:175], v[40:43], v[72:75], v[160:175]
    ds_read_b64_tr_b16 v[36:37], v11 offset:0
    v_mfma_f32_32x32x16_bf16 v[176:191], v[40:43], v[76:79], v[176:191]
    ds_read_b64_tr_b16 v[38:39], v11 offset:2048
    v_mfma_f32_32x32x16_bf16 v[192:207], v[44:47], v[64:67], v[192:207]
    ds_read_b128 v[48:51], v6 offset:0
    v_mfma_f32_32x32x16_bf16 v[208:223], v[44:47], v[68:71], v[208:223]
    ds_read_b128 v[52:55], v6 offset:2048
    v_mfma_f32_32x32x16_bf16 v[224:239], v[44:47], v[72:75], v[224:239]
    ds_read_b128 v[56:59], v6 offset:4096
    v_mfma_f32_32x32x16_bf16 v[240:255], v[44:47], v[76:79], v[240:255]
    ds_read_b128 v[60:63], v6 offset:6144
    s_waitcnt lgkmcnt(0)
    v_mfma_f32_32x32x16_bf16 v[128:143], v[32:35], v[48:51], v[128:143]
    ds_read_b64_tr_b16 v[40:41], v10 offset:8192
    v_mfma_f32_32x32x16_bf16 v[144:159], v[32:35], v[52:55], v[144:159]
    ds_read_b64_tr_b16 v[42:43], v10 offset:10240
    v_mfma_f32_32x32x16_bf16 v[160:175], v[32:35], v[56:59], v[160:175]
    ds_read_b64_tr_b16 v[44:45], v11 offset:8192
    v_mfma_f32_32x32x16_bf16 v[176:191], v[32:35], v[60:63], v[176:191]
    ds_read_b64_tr_b16 v[46:47], v11 offset:10240
    v_mfma_f32_32x32x16_bf16 v[192:207], v[36:39], v[48:51], v[192:207]
    ds_read_b128 v[64:67], v7 offset:0
    v_mfma_f32_32x32x16_bf16 v[208:223], v[36:39], v[52:55], v[208:223]
    ds_read_b128 v[68:71], v7 offset:2048
    v_mfma_f32_32x32x16_bf16 v[224:239], v[36:39], v[56:59], v[224:239]
    ds_read_b128 v[72:75], v7 offset:4096
    v_mfma_f32_32x32x16_bf16 v[240:255], v[36:39], v[60:63], v[240:255]
    ds_read_b128 v[76:79], v7 offset:6144
    s_waitcnt lgkmcnt(0)
    v_mfma_f32_32x32x16_bf16 v[128:143], v[40:43], v[64:67], v[128:143]
    v_mfma_f32_32x32x16_bf16 v[144:159], v[40:43], v[68:71], v[144:159]
    v_mfma_f32_32x32x16_bf16 v[160:175], v[40:43], v[72:75], v[160:175]
    v_mfma_f32_32x32x16_bf16 v[176:191], v[40:43], v[76:79], v[176:191]
    v_mfma_f32_32x32x16_bf16 v[192:207], v[44:47], v[64:67], v[192:207]
    v_mfma_f32_32x32x16_bf16 v[208:223], v[44:47], v[68:71], v[208:223]
    v_mfma_f32_32x32x16_bf16 v[224:239], v[44:47], v[72:75], v[224:239]
    v_mfma_f32_32x32x16_bf16 v[240:255], v[44:47], v[76:79], v[240:255]
    s_lshl_b32 s72, s3, 8
    s_lshl_b32 s73, s69, 6
    s_add_u32 s72, s72, s73
    s_lshr_b32 s73, s72, 7
    s_lshl_b32 s75, s73, 19
    s_and_b32 s73, s72, 127
    s_lshl_b32 s73, s73, 1
    s_add_u32 s75, s75, s73
    s_lshl_b32 s73, s4, 16
    s_add_u32 s75, s75, s73
    s_lshl_b32 s73, s70, 15
    s_add_u32 s75, s75, s73
    s_lshl_b32 s72, s64, 12
    s_add_u32 s72, s72, 98304
    v_and_b32 v15, 31, v1
    v_lshrrev_b32 v16, 5, v1
    v_and_b32 v17, 7, v1
    v_xor_b32 v16, v16, v17
    v_lshlrev_b32 v15, 7, v15
    v_lshl_add_u32 v22, v16, 4, v15
    v_add_u32 v22, s72, v22
    v_xor_b32 v23, 32, v22
    v_xor_b32 v24, 64, v22
    v_xor_b32 v25, 96, v22
    v_lshrrev_b32 v15, 3, v1
    v_xor_b32 v16, v15, v17
    v_lshlrev_b32 v18, 7, v15
    v_lshl_add_u32 v26, v16, 4, v18
    v_add_u32 v26, s72, v26
    s_mov_b32 s72, 256
    v_mul_lo_u32 v14, v15, s72
    v_lshl_add_u32 v14, v17, 4, v14
    v_cvt_pk_bf16_f32 v128, v128, v129
    v_cvt_pk_bf16_f32 v129, v130, v131
    v_cvt_pk_bf16_f32 v130, v132, v133
    v_cvt_pk_bf16_f32 v131, v134, v135
    v_cvt_pk_bf16_f32 v132, v136, v137
    v_cvt_pk_bf16_f32 v133, v138, v139
    v_cvt_pk_bf16_f32 v134, v140, v141
    v_cvt_pk_bf16_f32 v135, v142, v143
    v_permlane32_swap_b32 v128, v130
    v_permlane32_swap_b32 v129, v131
    ds_write_b128 v22, v[128:131]
    v_permlane32_swap_b32 v132, v134
    v_permlane32_swap_b32 v133, v135
    ds_write_b128 v23, v[132:135]
    v_cvt_pk_bf16_f32 v192, v192, v193
    v_cvt_pk_bf16_f32 v193, v194, v195
    v_cvt_pk_bf16_f32 v194, v196, v197
    v_cvt_pk_bf16_f32 v195, v198, v199
    v_cvt_pk_bf16_f32 v196, v200, v201
    v_cvt_pk_bf16_f32 v197, v202, v203
    v_cvt_pk_bf16_f32 v198, v204, v205
    v_cvt_pk_bf16_f32 v199, v206, v207
    v_permlane32_swap_b32 v192, v194
    v_permlane32_swap_b32 v193, v195
    ds_write_b128 v24, v[192:195]
    v_permlane32_swap_b32 v196, v198
    v_permlane32_swap_b32 v197, v199
    ds_write_b128 v25, v[196:199]
    ds_read_b128 v[136:139], v26 offset:0
    ds_read_b128 v[140:143], v26 offset:1024
    ds_read_b128 v[200:203], v26 offset:2048
    ds_read_b128 v[204:207], v26 offset:3072
    v_cvt_pk_bf16_f32 v144, v144, v145
    v_cvt_pk_bf16_f32 v145, v146, v147
    v_cvt_pk_bf16_f32 v146, v148, v149
    v_cvt_pk_bf16_f32 v147, v150, v151
    v_cvt_pk_bf16_f32 v148, v152, v153
    v_cvt_pk_bf16_f32 v149, v154, v155
    v_cvt_pk_bf16_f32 v150, v156, v157
    v_cvt_pk_bf16_f32 v151, v158, v159
    v_permlane32_swap_b32 v144, v146
    v_permlane32_swap_b32 v145, v147
    ds_write_b128 v22, v[144:147]
    v_permlane32_swap_b32 v148, v150
    v_permlane32_swap_b32 v149, v151
    ds_write_b128 v23, v[148:151]
    v_cvt_pk_bf16_f32 v208, v208, v209
    v_cvt_pk_bf16_f32 v209, v210, v211
    v_cvt_pk_bf16_f32 v210, v212, v213
    v_cvt_pk_bf16_f32 v211, v214, v215
    v_cvt_pk_bf16_f32 v212, v216, v217
    v_cvt_pk_bf16_f32 v213, v218, v219
    v_cvt_pk_bf16_f32 v214, v220, v221
    v_cvt_pk_bf16_f32 v215, v222, v223
    v_permlane32_swap_b32 v208, v210
    v_permlane32_swap_b32 v209, v211
    ds_write_b128 v24, v[208:211]
    v_permlane32_swap_b32 v212, v214
    v_permlane32_swap_b32 v213, v215
    ds_write_b128 v25, v[212:215]
    ds_read_b128 v[80:83], v26 offset:0
    ds_read_b128 v[84:87], v26 offset:1024
    ds_read_b128 v[88:91], v26 offset:2048
    ds_read_b128 v[92:95], v26 offset:3072
    s_waitcnt lgkmcnt(8)
    s_add_u32 s76, s75, 0
    buffer_store_dwordx4 v[136:139], v14, s[52:55], s76 offen sc1
    s_add_u32 s76, s75, 2048
    buffer_store_dwordx4 v[140:143], v14, s[52:55], s76 offen sc1
    s_add_u32 s76, s75, 4096
    buffer_store_dwordx4 v[200:203], v14, s[52:55], s76 offen sc1
    s_add_u32 s76, s75, 6144
    buffer_store_dwordx4 v[204:207], v14, s[52:55], s76 offen sc1
    v_cvt_pk_bf16_f32 v160, v160, v161
    v_cvt_pk_bf16_f32 v161, v162, v163
    v_cvt_pk_bf16_f32 v162, v164, v165
    v_cvt_pk_bf16_f32 v163, v166, v167
    v_cvt_pk_bf16_f32 v164, v168, v169
    v_cvt_pk_bf16_f32 v165, v170, v171
    v_cvt_pk_bf16_f32 v166, v172, v173
    v_cvt_pk_bf16_f32 v167, v174, v175
    v_permlane32_swap_b32 v160, v162
    v_permlane32_swap_b32 v161, v163
    ds_write_b128 v22, v[160:163]
    v_permlane32_swap_b32 v164, v166
    v_permlane32_swap_b32 v165, v167
    ds_write_b128 v23, v[164:167]
    v_cvt_pk_bf16_f32 v224, v224, v225
    v_cvt_pk_bf16_f32 v225, v226, v227
    v_cvt_pk_bf16_f32 v226, v228, v229
    v_cvt_pk_bf16_f32 v227, v230, v231
    v_cvt_pk_bf16_f32 v228, v232, v233
    v_cvt_pk_bf16_f32 v229, v234, v235
    v_cvt_pk_bf16_f32 v230, v236, v237
    v_cvt_pk_bf16_f32 v231, v238, v239
    v_permlane32_swap_b32 v224, v226
    v_permlane32_swap_b32 v225, v227
    ds_write_b128 v24, v[224:227]
    v_permlane32_swap_b32 v228, v230
    v_permlane32_swap_b32 v229, v231
    ds_write_b128 v25, v[228:231]
    ds_read_b128 v[96:99], v26 offset:0
    ds_read_b128 v[100:103], v26 offset:1024
    ds_read_b128 v[104:107], v26 offset:2048
    ds_read_b128 v[108:111], v26 offset:3072
    s_waitcnt lgkmcnt(8)
    s_add_u32 s76, s75, 8192
    buffer_store_dwordx4 v[80:83], v14, s[52:55], s76 offen sc1
    s_add_u32 s76, s75, 10240
    buffer_store_dwordx4 v[84:87], v14, s[52:55], s76 offen sc1
    s_add_u32 s76, s75, 12288
    buffer_store_dwordx4 v[88:91], v14, s[52:55], s76 offen sc1
    s_add_u32 s76, s75, 14336
    buffer_store_dwordx4 v[92:95], v14, s[52:55], s76 offen sc1
    v_cvt_pk_bf16_f32 v176, v176, v177
    v_cvt_pk_bf16_f32 v177, v178, v179
    v_cvt_pk_bf16_f32 v178, v180, v181
    v_cvt_pk_bf16_f32 v179, v182, v183
    v_cvt_pk_bf16_f32 v180, v184, v185
    v_cvt_pk_bf16_f32 v181, v186, v187
    v_cvt_pk_bf16_f32 v182, v188, v189
    v_cvt_pk_bf16_f32 v183, v190, v191
    v_permlane32_swap_b32 v176, v178
    v_permlane32_swap_b32 v177, v179
    ds_write_b128 v22, v[176:179]
    v_permlane32_swap_b32 v180, v182
    v_permlane32_swap_b32 v181, v183
    ds_write_b128 v23, v[180:183]
    v_cvt_pk_bf16_f32 v240, v240, v241
    v_cvt_pk_bf16_f32 v241, v242, v243
    v_cvt_pk_bf16_f32 v242, v244, v245
    v_cvt_pk_bf16_f32 v243, v246, v247
    v_cvt_pk_bf16_f32 v244, v248, v249
    v_cvt_pk_bf16_f32 v245, v250, v251
    v_cvt_pk_bf16_f32 v246, v252, v253
    v_cvt_pk_bf16_f32 v247, v254, v255
    v_permlane32_swap_b32 v240, v242
    v_permlane32_swap_b32 v241, v243
    ds_write_b128 v24, v[240:243]
    v_permlane32_swap_b32 v244, v246
    v_permlane32_swap_b32 v245, v247
    ds_write_b128 v25, v[244:247]
    ds_read_b128 v[112:115], v26 offset:0
    ds_read_b128 v[116:119], v26 offset:1024
    ds_read_b128 v[120:123], v26 offset:2048
    ds_read_b128 v[124:127], v26 offset:3072
    s_waitcnt lgkmcnt(8)
    s_add_u32 s76, s75, 16384
    buffer_store_dwordx4 v[96:99], v14, s[52:55], s76 offen sc1
    s_add_u32 s76, s75, 18432
    buffer_store_dwordx4 v[100:103], v14, s[52:55], s76 offen sc1
    s_add_u32 s76, s75, 20480
    buffer_store_dwordx4 v[104:107], v14, s[52:55], s76 offen sc1
    s_add_u32 s76, s75, 22528
    buffer_store_dwordx4 v[108:111], v14, s[52:55], s76 offen sc1
    s_waitcnt lgkmcnt(0)
    s_add_u32 s76, s75, 24576
    buffer_store_dwordx4 v[112:115], v14, s[52:55], s76 offen sc1
    s_add_u32 s76, s75, 26624
    buffer_store_dwordx4 v[116:119], v14, s[52:55], s76 offen sc1
    s_add_u32 s76, s75, 28672
    buffer_store_dwordx4 v[120:123], v14, s[52:55], s76 offen sc1
    s_add_u32 s76, s75, 30720
    buffer_store_dwordx4 v[124:127], v14, s[52:55], s76 offen sc1
K1_END:
    s_endpgm
.text
.globl k3_attn_kernel
.p2align 8
.type k3_attn_kernel,@function
k3_attn_kernel:
    s_cmp_ge_u32 s2, 256
    s_cbranch_scc1 K3_END
    s_load_dwordx16 s[16:31], s[0:1], 0
    s_load_dwordx8 s[32:39], s[0:1], 64
    s_load_dwordx4 s[40:43], s[0:1], 96
    s_and_b32 s3, s2, 7
    s_lshr_b32 s4, s2, 3
    s_and_b32 s5, s4, 3
    s_lshl_b32 s6, s3, 2
    s_add_u32 s6, s6, s5
    s_lshr_b32 s7, s4, 2
    s_lshr_b32 s60, s6, 3
    s_sub_u32 s60, s6, s60
    s_and_b32 s62, s6, 7
    s_cmp_lg_u32 s62, 7
    s_cselect_b32 s62, 1, 0
    s_sub_u32 s5, 15, s7
    s_sub_u32 s72, s60, 14
    s_cmp_lt_u32 s60, 14
    s_cselect_b32 s61, s5, s7
    s_cselect_b32 s79, s7, s5
    s_cselect_b32 s78, 2, 0
    s_cselect_b32 s60, s60, s72
    s_lshl_b32 s66, s6, 8
    s_mov_b32 s67, 8192
    s_mov_b32 s68, 262144
    s_lshl_b32 s81, s60, 8
    s_mov_b32 s80, 3584
    s_mov_b32 s63, 114688
    v_and_b32 v1, 63, v0
    v_lshrrev_b32 v14, 6, v0
    s_nop 0
    v_readfirstlane_b32 s64, v14
    s_and_b32 s69, s64, 1
    s_lshr_b32 s70, s64, 1
    v_lshrrev_b32 v14, 2, v1
    s_lshl_b32 s72, s64, 4
    v_add_u32 v14, s72, v14
    s_mov_b32 s73, 64
    v_mul_lo_u32 v14, v14, s73
    v_lshrrev_b32 v15, 4, v1
    v_and_b32 v16, 3, v1
    v_xor_b32 v15, v15, v16
    v_lshl_add_u32 v2, v15, 4, v14
    v_add_u32 v3, 1024, v2
    v_lshrrev_b32 v14, 4, v1
    s_lshl_b32 s72, s64, 2
    v_add_u32 v15, s72, v14
    v_mul_lo_u32 v15, v15, s67
    v_bfe_u32 v16, v1, 2, 2
    v_and_b32 v17, 3, v1
    v_xor_b32 v18, v16, v14
    v_lshlrev_b32 v18, 6, v18
    v_lshl_add_u32 v18, v17, 4, v18
    v_add_u32 v4, v15, v18
    v_mov_b32 v5, v4
    s_lshl_b32 s71, s64, 10
    s_lshl_b32 s74, s64, 10
    v_lshrrev_b32 v14, 4, v1
    s_lshl_b32 s72, s64, 2
    v_add_u32 v15, s72, v14
    v_mul_lo_u32 v15, v15, s80
    v_bfe_u32 v16, v1, 2, 2
    v_and_b32 v17, 3, v1
    v_xor_b32 v18, v16, v14
    v_lshlrev_b32 v18, 6, v18
    v_lshl_add_u32 v18, v17, 4, v18
    v_add_u32 v20, v15, v18
    v_mov_b32 v21, v20
    s_lshl_b32 s74, s64, 11
    s_cmp_lt_u32 s64, 4
    s_cselect_b32 s65, s79, s61
    s_lshl_b32 s65, s65, 13
    s_and_b32 s72, s64, 3
    s_lshl_b32 s72, s72, 11
    s_add_u32 s65, s65, s72
    v_subrev_u32 v3, s71, v2
    v_and_b32 v14, 31, v1
    s_mul_i32 s72, s70, 2048
    v_lshlrev_b32 v14, 6, v14
    v_add_u32 v14, s72, v14
    v_lshrrev_b32 v15, 5, v1
    v_bfe_u32 v16, v1, 2, 2
    v_xor_b32 v15, v15, v16
    v_lshl_add_u32 v6, v15, 4, v14
    v_xor_b32 v7, 32, v6
    v_add_u32 v8, 65536, v6
    v_add_u32 v9, 65536, v7
    v_add_u32 v28, 131072, v6
    v_add_u32 v29, 131072, v7
    v_lshrrev_b32 v14, 5, v1
    v_lshlrev_b32 v14, 3, v14
    v_bfe_u32 v15, v1, 2, 2
    v_add_u32 v14, v14, v15
    v_mul_u32_u24 v14, 256, v14
    s_lshl_b32 s72, s69, 1
    v_xor_b32 v15, s72, v15
    v_lshl_add_u32 v14, v15, 6, v14
    v_bfe_u32 v15, v1, 4, 1
    v_lshl_add_u32 v14, v15, 5, v14
    v_and_b32 v15, 3, v1
    v_lshl_add_u32 v14, v15, 3, v14
    v_add_u32 v10, 8192, v14
    v_xor_b32 v11, 64, v10
    v_add_u32 v12, 65536, v10
    v_add_u32 v13, 65536, v11
    v_add_u32 v30, 131072, v10
    v_add_u32 v31, 131072, v11
    s_waitcnt lgkmcnt(0)
    s_mov_b32 s44, s42
    s_and_b32 s45, s43, 0xffff
    s_mov_b32 s46, 0x200000
    s_mov_b32 s47, 0x20000
    s_mov_b32 s48, s20
    s_and_b32 s49, s21, 0xffff
    s_mov_b32 s50, 0x400000
    s_mov_b32 s51, 0x20000
    s_mov_b32 s12, s30
    s_and_b32 s13, s31, 0xffff
    s_mov_b32 s14, 0x1c0000
    s_mov_b32 s15, 0x20000
    s_cmp_eq_u32 s62, 1
    s_cselect_b32 s14, s14, 0
    s_add_u32 m0, s74, 49152
    s_nop 0
    buffer_load_dwordx4 v3, s[44:47], s65 offen lds
    s_add_u32 m0, s74, 49152
    s_nop 0
    buffer_load_dwordx4 v3, s[44:47], s65 offen offset:1024 lds
    s_add_u32 s65, s65, 131072
    s_add_u32 m0, s71, 81920
    s_nop 0
    buffer_load_dwordx4 v4, s[48:51], s66 offen lds
    s_add_u32 s66, s66, s68
    s_add_u32 m0, s71, 90112
    s_nop 0
    buffer_load_dwordx4 v20, s[12:15], s81 offen lds
    s_add_u32 s81, s81, s63
    s_add_u32 m0, s74, 98304
    s_nop 0
    buffer_load_dwordx4 v3, s[44:47], s65 offen lds
    s_add_u32 m0, s74, 98304
    s_nop 0
    buffer_load_dwordx4 v3, s[44:47], s65 offen offset:1024 lds
    s_add_u32 s65, s65, 131072
    s_add_u32 m0, s71, 114688
    s_nop 0
    buffer_load_dwordx4 v4, s[48:51], s66 offen lds
    s_add_u32 s66, s66, s68
    s_add_u32 m0, s71, 122880
    s_nop 0
    buffer_load_dwordx4 v20, s[12:15], s81 offen lds
    s_add_u32 s81, s81, s63
    v_subrev_u32 v10, 0x2000, v10
    v_subrev_u32 v11, 0x2000, v11
    v_subrev_u32 v12, 0x2000, v12
    v_subrev_u32 v13, 0x2000, v13
    v_subrev_u32 v30, 0x2000, v30
    v_subrev_u32 v31, 0x2000, v31
    s_lshl_b32 s72, s70, 11
    v_add_u32 v6, s72, v6
    v_add_u32 v7, s72, v7
    v_add_u32 v8, s72, v8
    v_add_u32 v9, s72, v9
    v_add_u32 v28, s72, v28
    v_add_u32 v29, s72, v29
    s_lshl_b32 s72, s64, 12
    s_add_u32 s72, s72, 131072
    v_and_b32 v15, 31, v1
    v_lshrrev_b32 v16, 5, v1
    v_and_b32 v17, 7, v1
    v_xor_b32 v16, v16, v17
    v_lshlrev_b32 v15, 7, v15
    v_lshl_add_u32 v22, v16, 4, v15
    v_add_u32 v22, s72, v22
    v_xor_b32 v23, 32, v22
    v_xor_b32 v24, 64, v22
    v_xor_b32 v25, 96, v22
    v_lshrrev_b32 v15, 3, v1
    v_xor_b32 v16, v15, v17
    v_lshlrev_b32 v18, 7, v15
    v_lshl_add_u32 v26, v16, 4, v18
    v_add_u32 v26, s72, v26
    v_lshlrev_b32 v14, 6, v15
    v_bfe_u32 v16, v1, 2, 1
    v_lshl_add_u32 v14, v16, 17, v14
    v_and_b32 v16, 3, v1
    v_lshl_add_u32 v14, v16, 4, v14
    s_xor_b32 s72, s70, s78
    s_lshl_b32 s72, s72, 14
    s_lshl_b32 s73, s70, 13
    s_sub_u32 s72, s72, s73
    s_sub_u32 s72, s72, 32768
    v_add_u32 v252, s72, v22
    v_add_u32 v253, s72, v23
    v_add_u32 v254, s72, v24
    v_add_u32 v255, s72, v25
    s_and_b32 s72, s64, 3
    s_lshl_b32 s72, s72, 12
    v_lshrrev_b32 v15, 4, v1
    v_and_b32 v16, 15, v1
    v_lshlrev_b32 v17, 8, v15
    v_add_u32 v17, s72, v17
    v_add_u32 v18, 0, v15
    v_xor_b32 v18, v16, v18
    v_lshl_add_u32 v244, v18, 4, v17
    v_add_u32 v18, 4, v15
    v_xor_b32 v18, v16, v18
    v_lshl_add_u32 v245, v18, 4, v17
    v_add_u32 v18, 8, v15
    v_xor_b32 v18, v16, v18
    v_lshl_add_u32 v246, v18, 4, v17
    v_add_u32 v18, 12, v15
    v_xor_b32 v18, v16, v18
    v_lshl_add_u32 v247, v18, 4, v17
    s_and_b32 s72, s64, 3
    s_lshl_b32 s72, s72, 13
    s_add_u32 s72, s72, 98304
    v_and_b32 v15, 31, v1
    v_lshrrev_b32 v16, 5, v1
    v_and_b32 v17, 7, v1
    v_xor_b32 v16, v16, v17
    v_lshlrev_b32 v15, 7, v15
    v_lshl_add_u32 v248, v16, 4, v15
    v_add_u32 v248, s72, v248
    v_xor_b32 v249, 32, v248
    v_xor_b32 v250, 64, v248
    v_xor_b32 v251, 96, v248
    s_mov_b32 s8, s32
    s_and_b32 s9, s33, 0xffff
    s_mov_b32 s10, 0xe00
    s_mov_b32 s11, 0x20000
    s_add_u32 s56, s42, 0x2000000
    s_addc_u32 s57, s43, 0
    s_and_b32 s57, s57, 0xffff
    s_mov_b32 s58, 0x1000000
    s_mov_b32 s59, 0x20000
    s_lshl_b32 s72, s60, 7
    s_lshl_b32 s73, s69, 6
    s_add_u32 s72, s72, s73
    s_lshl_b32 s77, s72, 1
    v_lshrrev_b32 v232, 5, v1
    v_lshlrev_b32 v232, 3, v232
    s_lshl_b32 s73, s61, 7
    s_and_b32 s82, s70, 1
    s_lshl_b32 s82, s82, 6
    s_add_u32 s73, s73, s82
    s_lshl_b32 s61, s73, 6
    s_add_u32 s72, s72, 4096
    s_lshl_b32 s72, s72, 12
    s_add_u32 s61, s61, s72
    s_lshr_b32 s72, s64, 2
    s_and_b32 s73, s64, 3
    s_lshl_b32 s75, s72, 16
    s_lshl_b32 s76, s73, 12
    s_add_u32 s82, s75, s76
    s_lshl_b32 s75, s6, 19
    s_lshl_b32 s76, s72, 14
    s_add_u32 s83, s76, s75
    s_lshr_b32 s84, s64, 2
    s_and_b32 s85, s64, 3
    v_lshrrev_b32 v23, 4, v1
    v_and_b32 v24, 15, v1
    s_lshl_b32 s72, s85, 12
    v_lshlrev_b32 v25, 8, v23
    v_add_u32 v25, s72, v25
    v_add_u32 v26, 0, v23
    v_xor_b32 v26, v24, v26
    v_add_u32 v26, 4, v23
    v_xor_b32 v26, v24, v26
    v_add_u32 v26, 8, v23
    v_xor_b32 v26, v24, v26
    v_add_u32 v26, 12, v23
    v_xor_b32 v26, v24, v26
    v_lshrrev_b32 v26, 2, v24
    v_xor_b32 v26, v26, v23
    v_lshl_add_u32 v233, v26, 6, v25
    v_and_b32 v26, 3, v1
    v_lshl_add_u32 v233, v26, 4, v233
    s_lshl_b32 s72, s84, 16
    v_and_b32 v23, 31, v1
    v_lshlrev_b32 v23, 8, v23
    v_add_u32 v23, s72, v23
    v_lshrrev_b32 v24, 5, v1
    v_and_b32 v25, 15, v1
    v_xor_b32 v25, v24, v25
    v_lshl_add_u32 v27, v25, 4, v23
    v_bfe_u32 v25, v1, 2, 2
    v_lshl_add_u32 v23, v24, 2, v25
    v_lshlrev_b32 v23, 8, v23
    s_add_u32 s72, s72, 32768
    v_add_u32 v23, s72, v23
    v_lshl_add_u32 v23, v25, 6, v23
    v_bfe_u32 v25, v1, 4, 1
    v_lshl_add_u32 v23, v25, 5, v23
    v_and_b32 v25, 3, v1
    v_lshl_add_u32 v234, v25, 3, v23
    v_and_b32 v22, 31, v1
    s_lshl_b32 s72, s85, 5
    s_lshl_b32 s73, s84, 6
    s_sub_i32 s72, s72, s73
    v_add_u32 v22, s72, v22
    v_lshlrev_b32 v23, 2, v24
    v_sub_u32 v22, v22, v23
    s_lshl_b32 s72, s84, 16
    s_lshl_b32 s73, s85, 13
    s_add_u32 s72, s72, s73
    s_add_u32 s72, s72, 32768
    v_lshlrev_b32 v235, 4, v1
    v_add_u32 v235, s72, v235
    v_lshrrev_b32 v25, 3, v1
    v_and_b32 v26, 7, v1
    v_lshlrev_b32 v237, 6, v25
    v_bfe_u32 v23, v1, 2, 1
    v_lshl_add_u32 v237, v23, 17, v237
    v_and_b32 v23, 3, v1
    v_lshl_add_u32 v237, v23, 4, v237
    s_xor_b32 s72, s84, 1
    s_lshl_b32 s72, s72, 16
    s_lshl_b32 s73, s85, 13
    s_add_u32 s72, s72, s73
    s_add_u32 s72, s72, 32768
    v_xor_b32 v23, v25, v26
    v_lshlrev_b32 v25, 7, v25
    v_lshl_add_u32 v236, v23, 4, v25
    v_add_u32 v236, s72, v236
    v_and_b32 v23, 31, v1
    v_xor_b32 v26, v24, v26
    v_lshlrev_b32 v25, 7, v23
    v_lshl_add_u32 v242, v26, 4, v25
    v_add_u32 v242, s72, v242
    v_xor_b32 v243, 32, v242
    v_xor_b32 v14, 192, v27
    v_xor_b32 v15, 224, v27
    v_xor_b32 v16, 0, v234
    v_xor_b32 v17, 64, v234
    v_xor_b32 v18, 128, v234
    v_xor_b32 v19, 192, v234
    s_cmp_ge_u32 s64, 4
    s_cbranch_scc1 QH_HW
    s_waitcnt vmcnt(4)
    s_barrier
    ds_read_b64_tr_b16 v[32:33], v12 offset:16384
    ds_read_b64_tr_b16 v[34:35], v12 offset:17408
    ds_read_b64_tr_b16 v[36:37], v13 offset:16384
    ds_read_b64_tr_b16 v[38:39], v13 offset:17408
    ds_read_b128 v[40:43], v6 offset:49152
    ds_read_b128 v[44:47], v6 offset:51200
    ds_read_b64_tr_b16 v[56:57], v12 offset:20480
    ds_read_b64_tr_b16 v[58:59], v12 offset:21504
    ds_read_b64_tr_b16 v[60:61], v13 offset:20480
    ds_read_b64_tr_b16 v[62:63], v13 offset:21504
    ds_read_b128 v[64:67], v7 offset:49152
    ds_read_b128 v[68:71], v7 offset:51200
    s_waitcnt vmcnt(0)
    s_barrier
    s_waitcnt lgkmcnt(6)
    v_mfma_f32_32x32x16_bf16 v[80:95], v[32:35], v[40:43], 0
    s_add_u32 m0, s74, 131072
    s_nop 0
    buffer_load_dwordx4 v3, s[44:47], s65 offen lds
    s_add_u32 m0, s74, 131072
    s_nop 0
    buffer_load_dwordx4 v3, s[44:47], s65 offen offset:1024 lds
    s_add_u32 s65, s65, 131072
    s_add_u32 m0, s71, 147456
    s_nop 0
    buffer_load_dwordx4 v4, s[48:51], s66 offen lds
    s_add_u32 s66, s66, s68
    v_mfma_f32_32x32x16_bf16 v[96:111], v[32:35], v[44:47], 0
    s_add_u32 m0, s71, 155648
    s_nop 0
    buffer_load_dwordx4 v20, s[12:15], s81 offen lds
    s_add_u32 s81, s81, s63
    ds_read_b64_tr_b16 v[208:209], v12 offset:49152
    ds_read_b64_tr_b16 v[210:211], v12 offset:50176
    v_mfma_f32_32x32x16_bf16 v[112:127], v[36:39], v[40:43], 0
    ds_read_b64_tr_b16 v[212:213], v13 offset:49152
    ds_read_b64_tr_b16 v[214:215], v13 offset:50176
    ds_read_b128 v[216:219], v8 offset:32768
    v_mfma_f32_32x32x16_bf16 v[128:143], v[36:39], v[44:47], 0
    ds_read_b128 v[220:223], v8 offset:34816
    s_waitcnt lgkmcnt(6)
    v_mfma_f32_32x32x16_bf16 v[80:95], v[56:59], v[64:67], v[80:95]
    s_add_u32 m0, s74, 0
    s_nop 0
    buffer_load_dwordx4 v3, s[44:47], s65 offen lds
    s_add_u32 m0, s74, 0
    s_nop 0
    buffer_load_dwordx4 v3, s[44:47], s65 offen offset:1024 lds
    s_add_u32 s65, s65, 131072
    s_add_u32 m0, s71, 65536
    s_nop 0
    buffer_load_dwordx4 v4, s[48:51], s66 offen lds
    s_add_u32 s66, s66, s68
    v_mfma_f32_32x32x16_bf16 v[96:111], v[56:59], v[68:71], v[96:111]
    s_add_u32 m0, s71, 73728
    s_nop 0
    buffer_load_dwordx4 v20, s[12:15], s81 offen lds
    s_add_u32 s81, s81, s63
    ds_read_b64_tr_b16 v[32:33], v12 offset:53248
    ds_read_b64_tr_b16 v[34:35], v12 offset:54272
    v_mfma_f32_32x32x16_bf16 v[112:127], v[60:63], v[64:67], v[112:127]
    ds_read_b64_tr_b16 v[36:37], v13 offset:53248
    ds_read_b64_tr_b16 v[38:39], v13 offset:54272
    ds_read_b128 v[40:43], v9 offset:32768
    v_mfma_f32_32x32x16_bf16 v[128:143], v[60:63], v[68:71], v[128:143]
    ds_read_b128 v[44:47], v9 offset:34816
    s_waitcnt vmcnt(4)
    s_barrier
    s_waitcnt lgkmcnt(6)
    v_mfma_f32_32x32x16_bf16 v[80:95], v[208:211], v[216:219], v[80:95]
    s_add_u32 m0, s74, 16384
    s_nop 0
    buffer_load_dwordx4 v3, s[44:47], s65 offen lds
    s_add_u32 m0, s74, 16384
    s_nop 0
    buffer_load_dwordx4 v3, s[44:47], s65 offen offset:1024 lds
    s_add_u32 s65, s65, 131072
    s_add_u32 m0, s71, 32768
    s_nop 0
    buffer_load_dwordx4 v4, s[48:51], s66 offen lds
    s_add_u32 s66, s66, s68
    v_mfma_f32_32x32x16_bf16 v[96:111], v[208:211], v[220:223], v[96:111]
    s_add_u32 m0, s71, 40960
    s_nop 0
    buffer_load_dwordx4 v20, s[12:15], s81 offen lds
    s_add_u32 s81, s81, s63
    ds_read_b64_tr_b16 v[56:57], v30 offset:16384
    ds_read_b64_tr_b16 v[58:59], v30 offset:17408
    v_mfma_f32_32x32x16_bf16 v[112:127], v[212:215], v[216:219], v[112:127]
    ds_read_b64_tr_b16 v[60:61], v31 offset:16384
    ds_read_b64_tr_b16 v[62:63], v31 offset:17408
    ds_read_b128 v[64:67], v28 offset:0
    v_mfma_f32_32x32x16_bf16 v[128:143], v[212:215], v[220:223], v[128:143]
    ds_read_b128 v[68:71], v28 offset:2048
    s_waitcnt lgkmcnt(6)
    v_mfma_f32_32x32x16_bf16 v[80:95], v[32:35], v[40:43], v[80:95]
    s_add_u32 m0, s74, 49152
    s_nop 0
    buffer_load_dwordx4 v3, s[44:47], s65 offen lds
    s_add_u32 m0, s74, 49152
    s_nop 0
    buffer_load_dwordx4 v3, s[44:47], s65 offen offset:1024 lds
    s_add_u32 s65, s65, 131072
    s_add_u32 m0, s71, 81920
    s_nop 0
    buffer_load_dwordx4 v4, s[48:51], s66 offen lds
    s_add_u32 s66, s66, s68
    v_mfma_f32_32x32x16_bf16 v[96:111], v[32:35], v[44:47], v[96:111]
    s_add_u32 m0, s71, 90112
    s_nop 0
    buffer_load_dwordx4 v20, s[12:15], s81 offen lds
    s_add_u32 s81, s81, s63
    ds_read_b64_tr_b16 v[208:209], v30 offset:20480
    ds_read_b64_tr_b16 v[210:211], v30 offset:21504
    v_mfma_f32_32x32x16_bf16 v[112:127], v[36:39], v[40:43], v[112:127]
    ds_read_b64_tr_b16 v[212:213], v31 offset:20480
    ds_read_b64_tr_b16 v[214:215], v31 offset:21504
    ds_read_b128 v[216:219], v29 offset:0
    v_mfma_f32_32x32x16_bf16 v[128:143], v[36:39], v[44:47], v[128:143]
    ds_read_b128 v[220:223], v29 offset:2048
    s_waitcnt vmcnt(8)
    s_barrier
    s_waitcnt lgkmcnt(6)
    v_mfma_f32_32x32x16_bf16 v[80:95], v[56:59], v[64:67], v[80:95]
    ds_read_b64_tr_b16 v[32:33], v12 offset:0
    ds_read_b64_tr_b16 v[34:35], v12 offset:1024
    v_mfma_f32_32x32x16_bf16 v[96:111], v[56:59], v[68:71], v[96:111]
    ds_read_b64_tr_b16 v[36:37], v13 offset:0
    ds_read_b64_tr_b16 v[38:39], v13 offset:1024
    v_mfma_f32_32x32x16_bf16 v[112:127], v[60:63], v[64:67], v[112:127]
    ds_read_b128 v[40:43], v6 offset:0
    ds_read_b128 v[44:47], v6 offset:2048
    v_mfma_f32_32x32x16_bf16 v[128:143], v[60:63], v[68:71], v[128:143]
    s_add_u32 m0, s74, 98304
    s_nop 0
    buffer_load_dwordx4 v3, s[44:47], s65 offen lds
    s_add_u32 m0, s74, 98304
    s_nop 0
    buffer_load_dwordx4 v3, s[44:47], s65 offen offset:1024 lds
    s_add_u32 s65, s65, 131072
    s_waitcnt lgkmcnt(6)
    v_mfma_f32_32x32x16_bf16 v[80:95], v[208:211], v[216:219], v[80:95]
    ds_read_b64_tr_b16 v[56:57], v12 offset:4096
    ds_read_b64_tr_b16 v[58:59], v12 offset:5120
    v_mfma_f32_32x32x16_bf16 v[96:111], v[208:211], v[220:223], v[96:111]
    ds_read_b64_tr_b16 v[60:61], v13 offset:4096
    ds_read_b64_tr_b16 v[62:63], v13 offset:5120
    v_mfma_f32_32x32x16_bf16 v[112:127], v[212:215], v[216:219], v[112:127]
    ds_read_b128 v[64:67], v7 offset:0
    ds_read_b128 v[68:71], v7 offset:2048
    v_mfma_f32_32x32x16_bf16 v[128:143], v[212:215], v[220:223], v[128:143]
    s_add_u32 m0, s71, 114688
    s_nop 0
    buffer_load_dwordx4 v4, s[48:51], s66 offen lds
    s_add_u32 s66, s66, s68
    s_add_u32 m0, s71, 122880
    s_nop 0
    buffer_load_dwordx4 v20, s[12:15], s81 offen lds
    s_add_u32 s81, s81, s63
    s_waitcnt vmcnt(8)
    s_barrier
    s_waitcnt lgkmcnt(6)
    v_mfma_f32_32x32x16_bf16 v[80:95], v[32:35], v[40:43], v[80:95]
    ds_read_b64_tr_b16 v[208:209], v10 offset:32768
    ds_read_b64_tr_b16 v[210:211], v10 offset:33792
    v_mfma_f32_32x32x16_bf16 v[96:111], v[32:35], v[44:47], v[96:111]
    ds_read_b64_tr_b16 v[212:213], v11 offset:32768
    ds_read_b64_tr_b16 v[214:215], v11 offset:33792
    v_mfma_f32_32x32x16_bf16 v[112:127], v[36:39], v[40:43], v[112:127]
    ds_read_b128 v[216:219], v6 offset:16384
    ds_read_b128 v[220:223], v6 offset:18432
    v_mfma_f32_32x32x16_bf16 v[128:143], v[36:39], v[44:47], v[128:143]
    s_add_u32 m0, s74, 131072
    s_nop 0
    buffer_load_dwordx4 v3, s[44:47], s65 offen lds
    s_add_u32 m0, s74, 131072
    s_nop 0
    buffer_load_dwordx4 v3, s[44:47], s65 offen offset:1024 lds
    s_add_u32 s65, s65, 131072
    s_waitcnt lgkmcnt(6)
    v_mfma_f32_32x32x16_bf16 v[80:95], v[56:59], v[64:67], v[80:95]
    ds_read_b64_tr_b16 v[32:33], v10 offset:36864
    ds_read_b64_tr_b16 v[34:35], v10 offset:37888
    v_mfma_f32_32x32x16_bf16 v[96:111], v[56:59], v[68:71], v[96:111]
    ds_read_b64_tr_b16 v[36:37], v11 offset:36864
    ds_read_b64_tr_b16 v[38:39], v11 offset:37888
    v_mfma_f32_32x32x16_bf16 v[112:127], v[60:63], v[64:67], v[112:127]
    ds_read_b128 v[40:43], v7 offset:16384
    ds_read_b128 v[44:47], v7 offset:18432
    v_mfma_f32_32x32x16_bf16 v[128:143], v[60:63], v[68:71], v[128:143]
    s_add_u32 m0, s71, 147456
    s_nop 0
    buffer_load_dwordx4 v4, s[48:51], s66 offen lds
    s_add_u32 s66, s66, s68
    s_add_u32 m0, s71, 155648
    s_nop 0
    buffer_load_dwordx4 v20, s[12:15], s81 offen lds
    s_add_u32 s81, s81, s63
    s_waitcnt vmcnt(8)
    s_barrier
    s_waitcnt lgkmcnt(6)
    v_mfma_f32_32x32x16_bf16 v[80:95], v[208:211], v[216:219], v[80:95]
    ds_read_b64_tr_b16 v[56:57], v12 offset:16384
    ds_read_b64_tr_b16 v[58:59], v12 offset:17408
    v_mfma_f32_32x32x16_bf16 v[96:111], v[208:211], v[220:223], v[96:111]
    ds_read_b64_tr_b16 v[60:61], v13 offset:16384
    ds_read_b64_tr_b16 v[62:63], v13 offset:17408
    v_mfma_f32_32x32x16_bf16 v[112:127], v[212:215], v[216:219], v[112:127]
    ds_read_b128 v[64:67], v6 offset:49152
    ds_read_b128 v[68:71], v6 offset:51200
    v_mfma_f32_32x32x16_bf16 v[128:143], v[212:215], v[220:223], v[128:143]
    s_add_u32 m0, s74, 0
    s_nop 0
    buffer_load_dwordx4 v3, s[44:47], s65 offen lds
    s_add_u32 m0, s74, 0
    s_nop 0
    buffer_load_dwordx4 v3, s[44:47], s65 offen offset:1024 lds
    s_add_u32 s65, s65, 131072
    s_waitcnt lgkmcnt(6)
    v_mfma_f32_32x32x16_bf16 v[80:95], v[32:35], v[40:43], v[80:95]
    ds_read_b64_tr_b16 v[208:209], v12 offset:20480
    ds_read_b64_tr_b16 v[210:211], v12 offset:21504
    v_mfma_f32_32x32x16_bf16 v[96:111], v[32:35], v[44:47], v[96:111]
    ds_read_b64_tr_b16 v[212:213], v13 offset:20480
    ds_read_b64_tr_b16 v[214:215], v13 offset:21504
    v_mfma_f32_32x32x16_bf16 v[112:127], v[36:39], v[40:43], v[112:127]
    ds_read_b128 v[216:219], v7 offset:49152
    ds_read_b128 v[220:223], v7 offset:51200
    v_mfma_f32_32x32x16_bf16 v[128:143], v[36:39], v[44:47], v[128:143]
    s_add_u32 m0, s71, 65536
    s_nop 0
    buffer_load_dwordx4 v4, s[48:51], s66 offen lds
    s_add_u32 s66, s66, s68
    s_add_u32 m0, s71, 73728
    s_nop 0
    buffer_load_dwordx4 v20, s[12:15], s81 offen lds
    s_add_u32 s81, s81, s63
    s_waitcnt vmcnt(8)
    s_barrier
    s_waitcnt lgkmcnt(6)
    v_mfma_f32_32x32x16_bf16 v[80:95], v[56:59], v[64:67], v[80:95]
    ds_read_b64_tr_b16 v[32:33], v12 offset:49152
    ds_read_b64_tr_b16 v[34:35], v12 offset:50176
    v_mfma_f32_32x32x16_bf16 v[96:111], v[56:59], v[68:71], v[96:111]
    ds_read_b64_tr_b16 v[36:37], v13 offset:49152
    ds_read_b64_tr_b16 v[38:39], v13 offset:50176
    v_mfma_f32_32x32x16_bf16 v[112:127], v[60:63], v[64:67], v[112:127]
    ds_read_b128 v[40:43], v8 offset:32768
    ds_read_b128 v[44:47], v8 offset:34816
    v_mfma_f32_32x32x16_bf16 v[128:143], v[60:63], v[68:71], v[128:143]
    s_add_u32 m0, s74, 16384
    s_nop 0
    buffer_load_dwordx4 v3, s[44:47], s65 offen lds
    s_add_u32 m0, s74, 16384
    s_nop 0
    buffer_load_dwordx4 v3, s[44:47], s65 offen offset:1024 lds
    s_add_u32 s65, s65, 131072
    s_waitcnt lgkmcnt(6)
    v_mfma_f32_32x32x16_bf16 v[80:95], v[208:211], v[216:219], v[80:95]
    ds_read_b64_tr_b16 v[56:57], v12 offset:53248
    ds_read_b64_tr_b16 v[58:59], v12 offset:54272
    v_mfma_f32_32x32x16_bf16 v[96:111], v[208:211], v[220:223], v[96:111]
    ds_read_b64_tr_b16 v[60:61], v13 offset:53248
    ds_read_b64_tr_b16 v[62:63], v13 offset:54272
    v_mfma_f32_32x32x16_bf16 v[112:127], v[212:215], v[216:219], v[112:127]
    ds_read_b128 v[64:67], v9 offset:32768
    ds_read_b128 v[68:71], v9 offset:34816
    v_mfma_f32_32x32x16_bf16 v[128:143], v[212:215], v[220:223], v[128:143]
    s_add_u32 m0, s71, 32768
    s_nop 0
    buffer_load_dwordx4 v4, s[48:51], s66 offen lds
    s_add_u32 s66, s66, s68
    s_add_u32 m0, s71, 40960
    s_nop 0
    buffer_load_dwordx4 v20, s[12:15], s81 offen lds
    s_add_u32 s81, s81, s63
    s_waitcnt vmcnt(8)
    s_barrier
    s_waitcnt lgkmcnt(6)
    v_mfma_f32_32x32x16_bf16 v[80:95], v[32:35], v[40:43], v[80:95]
    ds_read_b64_tr_b16 v[208:209], v30 offset:16384
    ds_read_b64_tr_b16 v[210:211], v30 offset:17408
    v_mfma_f32_32x32x16_bf16 v[96:111], v[32:35], v[44:47], v[96:111]
    ds_read_b64_tr_b16 v[212:213], v31 offset:16384
    ds_read_b64_tr_b16 v[214:215], v31 offset:17408
    v_mfma_f32_32x32x16_bf16 v[112:127], v[36:39], v[40:43], v[112:127]
    ds_read_b128 v[216:219], v28 offset:0
    ds_read_b128 v[220:223], v28 offset:2048
    v_mfma_f32_32x32x16_bf16 v[128:143], v[36:39], v[44:47], v[128:143]
    s_add_u32 m0, s74, 49152
    s_nop 0
    buffer_load_dwordx4 v3, s[44:47], s65 offen lds
    s_add_u32 m0, s74, 49152
    s_nop 0
    buffer_load_dwordx4 v3, s[44:47], s65 offen offset:1024 lds
    s_add_u32 s65, s65, 131072
    s_waitcnt lgkmcnt(6)
    v_mfma_f32_32x32x16_bf16 v[80:95], v[56:59], v[64:67], v[80:95]
    ds_read_b64_tr_b16 v[32:33], v30 offset:20480
    ds_read_b64_tr_b16 v[34:35], v30 offset:21504
    v_mfma_f32_32x32x16_bf16 v[96:111], v[56:59], v[68:71], v[96:111]
    ds_read_b64_tr_b16 v[36:37], v31 offset:20480
    ds_read_b64_tr_b16 v[38:39], v31 offset:21504
    v_mfma_f32_32x32x16_bf16 v[112:127], v[60:63], v[64:67], v[112:127]
    ds_read_b128 v[40:43], v29 offset:0
    ds_read_b128 v[44:47], v29 offset:2048
    v_mfma_f32_32x32x16_bf16 v[128:143], v[60:63], v[68:71], v[128:143]
    s_add_u32 m0, s71, 81920
    s_nop 0
    buffer_load_dwordx4 v4, s[48:51], s66 offen lds
    s_add_u32 s66, s66, s68
    s_add_u32 m0, s71, 90112
    s_nop 0
    buffer_load_dwordx4 v20, s[12:15], s81 offen lds
    s_add_u32 s81, s81, s63
    s_waitcnt vmcnt(8)
    s_barrier
    s_waitcnt lgkmcnt(6)
    v_mfma_f32_32x32x16_bf16 v[80:95], v[208:211], v[216:219], v[80:95]
    ds_read_b64_tr_b16 v[56:57], v12 offset:0
    ds_read_b64_tr_b16 v[58:59], v12 offset:1024
    v_mfma_f32_32x32x16_bf16 v[96:111], v[208:211], v[220:223], v[96:111]
    ds_read_b64_tr_b16 v[60:61], v13 offset:0
    ds_read_b64_tr_b16 v[62:63], v13 offset:1024
    v_mfma_f32_32x32x16_bf16 v[112:127], v[212:215], v[216:219], v[112:127]
    ds_read_b128 v[64:67], v6 offset:0
    ds_read_b128 v[68:71], v6 offset:2048
    v_mfma_f32_32x32x16_bf16 v[128:143], v[212:215], v[220:223], v[128:143]
    s_add_u32 m0, s74, 98304
    s_nop 0
    buffer_load_dwordx4 v3, s[44:47], s65 offen lds
    s_add_u32 m0, s74, 98304
    s_nop 0
    buffer_load_dwordx4 v3, s[44:47], s65 offen offset:1024 lds
    s_add_u32 s65, s65, 131072
    s_waitcnt lgkmcnt(6)
    v_mfma_f32_32x32x16_bf16 v[80:95], v[32:35], v[40:43], v[80:95]
    ds_read_b64_tr_b16 v[208:209], v12 offset:4096
    ds_read_b64_tr_b16 v[210:211], v12 offset:5120
    v_mfma_f32_32x32x16_bf16 v[96:111], v[32:35], v[44:47], v[96:111]
    ds_read_b64_tr_b16 v[212:213], v13 offset:4096
    ds_read_b64_tr_b16 v[214:215], v13 offset:5120
    v_mfma_f32_32x32x16_bf16 v[112:127], v[36:39], v[40:43], v[112:127]
    ds_read_b128 v[216:219], v7 offset:0
    ds_read_b128 v[220:223], v7 offset:2048
    v_mfma_f32_32x32x16_bf16 v[128:143], v[36:39], v[44:47], v[128:143]
    s_add_u32 m0, s71, 114688
    s_nop 0
    buffer_load_dwordx4 v4, s[48:51], s66 offen lds
    s_add_u32 s66, s66, s68
    s_add_u32 m0, s71, 122880
    s_nop 0
    buffer_load_dwordx4 v20, s[12:15], s81 offen lds
    s_add_u32 s81, s81, s63
    s_waitcnt vmcnt(8)
    s_barrier
    s_waitcnt lgkmcnt(6)
    v_mfma_f32_32x32x16_bf16 v[80:95], v[56:59], v[64:67], v[80:95]
    ds_read_b64_tr_b16 v[32:33], v10 offset:32768
    ds_read_b64_tr_b16 v[34:35], v10 offset:33792
    v_mfma_f32_32x32x16_bf16 v[96:111], v[56:59], v[68:71], v[96:111]
    ds_read_b64_tr_b16 v[36:37], v11 offset:32768
    ds_read_b64_tr_b16 v[38:39], v11 offset:33792
    v_mfma_f32_32x32x16_bf16 v[112:127], v[60:63], v[64:67], v[112:127]
    ds_read_b128 v[40:43], v6 offset:16384
    ds_read_b128 v[44:47], v6 offset:18432
    v_mfma_f32_32x32x16_bf16 v[128:143], v[60:63], v[68:71], v[128:143]
    s_add_u32 m0, s74, 131072
    s_nop 0
    buffer_load_dwordx4 v3, s[44:47], s65 offen lds
    s_add_u32 m0, s74, 131072
    s_nop 0
    buffer_load_dwordx4 v3, s[44:47], s65 offen offset:1024 lds
    s_add_u32 s65, s65, 131072
    s_waitcnt lgkmcnt(6)
    v_mfma_f32_32x32x16_bf16 v[80:95], v[208:211], v[216:219], v[80:95]
    ds_read_b64_tr_b16 v[56:57], v10 offset:36864
    ds_read_b64_tr_b16 v[58:59], v10 offset:37888
    v_mfma_f32_32x32x16_bf16 v[96:111], v[208:211], v[220:223], v[96:111]
    ds_read_b64_tr_b16 v[60:61], v11 offset:36864
    ds_read_b64_tr_b16 v[62:63], v11 offset:37888
    v_mfma_f32_32x32x16_bf16 v[112:127], v[212:215], v[216:219], v[112:127]
    ds_read_b128 v[64:67], v7 offset:16384
    ds_read_b128 v[68:71], v7 offset:18432
    v_mfma_f32_32x32x16_bf16 v[128:143], v[212:215], v[220:223], v[128:143]
    s_add_u32 m0, s71, 147456
    s_nop 0
    buffer_load_dwordx4 v4, s[48:51], s66 offen lds
    s_add_u32 s66, s66, s68
    s_add_u32 m0, s71, 155648
    s_nop 0
    buffer_load_dwordx4 v20, s[12:15], s81 offen lds
    s_add_u32 s81, s81, s63
    s_waitcnt vmcnt(8)
    s_barrier
    s_waitcnt lgkmcnt(6)
    v_mfma_f32_32x32x16_bf16 v[80:95], v[32:35], v[40:43], v[80:95]
    ds_read_b64_tr_b16 v[208:209], v12 offset:16384
    ds_read_b64_tr_b16 v[210:211], v12 offset:17408
    v_mfma_f32_32x32x16_bf16 v[96:111], v[32:35], v[44:47], v[96:111]
    ds_read_b64_tr_b16 v[212:213], v13 offset:16384
    ds_read_b64_tr_b16 v[214:215], v13 offset:17408
    v_mfma_f32_32x32x16_bf16 v[112:127], v[36:39], v[40:43], v[112:127]
    ds_read_b128 v[216:219], v6 offset:49152
    ds_read_b128 v[220:223], v6 offset:51200
    v_mfma_f32_32x32x16_bf16 v[128:143], v[36:39], v[44:47], v[128:143]
    s_add_u32 m0, s74, 0
    s_nop 0
    buffer_load_dwordx4 v3, s[44:47], s65 offen lds
    s_add_u32 m0, s74, 0
    s_nop 0
    buffer_load_dwordx4 v3, s[44:47], s65 offen offset:1024 lds
    s_add_u32 s65, s65, 131072
    s_waitcnt lgkmcnt(6)
    v_mfma_f32_32x32x16_bf16 v[80:95], v[56:59], v[64:67], v[80:95]
    ds_read_b64_tr_b16 v[32:33], v12 offset:20480
    ds_read_b64_tr_b16 v[34:35], v12 offset:21504
    v_mfma_f32_32x32x16_bf16 v[96:111], v[56:59], v[68:71], v[96:111]
    ds_read_b64_tr_b16 v[36:37], v13 offset:20480
    ds_read_b64_tr_b16 v[38:39], v13 offset:21504
    v_mfma_f32_32x32x16_bf16 v[112:127], v[60:63], v[64:67], v[112:127]
    ds_read_b128 v[40:43], v7 offset:49152
    ds_read_b128 v[44:47], v7 offset:51200
    v_mfma_f32_32x32x16_bf16 v[128:143], v[60:63], v[68:71], v[128:143]
    s_add_u32 m0, s71, 65536
    s_nop 0
    buffer_load_dwordx4 v4, s[48:51], s66 offen lds
    s_add_u32 s66, s66, s68
    s_add_u32 m0, s71, 73728
    s_nop 0
    buffer_load_dwordx4 v20, s[12:15], s81 offen lds
    s_add_u32 s81, s81, s63
    s_waitcnt vmcnt(8)
    s_barrier
    s_waitcnt lgkmcnt(6)
    v_mfma_f32_32x32x16_bf16 v[80:95], v[208:211], v[216:219], v[80:95]
    ds_read_b64_tr_b16 v[56:57], v12 offset:49152
    ds_read_b64_tr_b16 v[58:59], v12 offset:50176
    v_mfma_f32_32x32x16_bf16 v[96:111], v[208:211], v[220:223], v[96:111]
    ds_read_b64_tr_b16 v[60:61], v13 offset:49152
    ds_read_b64_tr_b16 v[62:63], v13 offset:50176
    v_mfma_f32_32x32x16_bf16 v[112:127], v[212:215], v[216:219], v[112:127]
    ds_read_b128 v[64:67], v8 offset:32768
    ds_read_b128 v[68:71], v8 offset:34816
    v_mfma_f32_32x32x16_bf16 v[128:143], v[212:215], v[220:223], v[128:143]
    s_add_u32 m0, s74, 16384
    s_nop 0
    buffer_load_dwordx4 v3, s[44:47], s65 offen lds
    s_add_u32 m0, s74, 16384
    s_nop 0
    buffer_load_dwordx4 v3, s[44:47], s65 offen offset:1024 lds
    s_add_u32 s65, s65, 131072
    s_waitcnt lgkmcnt(6)
    v_mfma_f32_32x32x16_bf16 v[80:95], v[32:35], v[40:43], v[80:95]
    ds_read_b64_tr_b16 v[208:209], v12 offset:53248
    ds_read_b64_tr_b16 v[210:211], v12 offset:54272
    v_mfma_f32_32x32x16_bf16 v[96:111], v[32:35], v[44:47], v[96:111]
    ds_read_b64_tr_b16 v[212:213], v13 offset:53248
    ds_read_b64_tr_b16 v[214:215], v13 offset:54272
    v_mfma_f32_32x32x16_bf16 v[112:127], v[36:39], v[40:43], v[112:127]
    ds_read_b128 v[216:219], v9 offset:32768
    ds_read_b128 v[220:223], v9 offset:34816
    v_mfma_f32_32x32x16_bf16 v[128:143], v[36:39], v[44:47], v[128:143]
    s_add_u32 m0, s71, 32768
    s_nop 0
    buffer_load_dwordx4 v4, s[48:51], s66 offen lds
    s_add_u32 s66, s66, s68
    s_add_u32 m0, s71, 40960
    s_nop 0
    buffer_load_dwordx4 v20, s[12:15], s81 offen lds
    s_add_u32 s81, s81, s63
    s_waitcnt vmcnt(8)
    s_barrier
    s_waitcnt lgkmcnt(6)
    v_mfma_f32_32x32x16_bf16 v[80:95], v[56:59], v[64:67], v[80:95]
    ds_read_b64_tr_b16 v[32:33], v30 offset:16384
    ds_read_b64_tr_b16 v[34:35], v30 offset:17408
    v_mfma_f32_32x32x16_bf16 v[96:111], v[56:59], v[68:71], v[96:111]
    ds_read_b64_tr_b16 v[36:37], v31 offset:16384
    ds_read_b64_tr_b16 v[38:39], v31 offset:17408
    v_mfma_f32_32x32x16_bf16 v[112:127], v[60:63], v[64:67], v[112:127]
    ds_read_b128 v[40:43], v28 offset:0
    ds_read_b128 v[44:47], v28 offset:2048
    v_mfma_f32_32x32x16_bf16 v[128:143], v[60:63], v[68:71], v[128:143]
    s_add_u32 m0, s74, 49152
    s_nop 0
    buffer_load_dwordx4 v3, s[44:47], s65 offen lds
    s_add_u32 m0, s74, 49152
    s_nop 0
    buffer_load_dwordx4 v3, s[44:47], s65 offen offset:1024 lds
    s_add_u32 s65, s65, 131072
    s_waitcnt lgkmcnt(6)
    v_mfma_f32_32x32x16_bf16 v[80:95], v[208:211], v[216:219], v[80:95]
    ds_read_b64_tr_b16 v[56:57], v30 offset:20480
    ds_read_b64_tr_b16 v[58:59], v30 offset:21504
    v_mfma_f32_32x32x16_bf16 v[96:111], v[208:211], v[220:223], v[96:111]
    ds_read_b64_tr_b16 v[60:61], v31 offset:20480
    ds_read_b64_tr_b16 v[62:63], v31 offset:21504
    v_mfma_f32_32x32x16_bf16 v[112:127], v[212:215], v[216:219], v[112:127]
    ds_read_b128 v[64:67], v29 offset:0
    ds_read_b128 v[68:71], v29 offset:2048
    v_mfma_f32_32x32x16_bf16 v[128:143], v[212:215], v[220:223], v[128:143]
    s_add_u32 m0, s71, 81920
    s_nop 0
    buffer_load_dwordx4 v4, s[48:51], s66 offen lds
    s_add_u32 s66, s66, s68
    s_add_u32 m0, s71, 90112
    s_nop 0
    buffer_load_dwordx4 v20, s[12:15], s81 offen lds
    s_add_u32 s81, s81, s63
    s_waitcnt vmcnt(8)
    s_barrier
    s_waitcnt lgkmcnt(6)
    v_mfma_f32_32x32x16_bf16 v[80:95], v[32:35], v[40:43], v[80:95]
    ds_read_b64_tr_b16 v[208:209], v12 offset:0
    ds_read_b64_tr_b16 v[210:211], v12 offset:1024
    v_mfma_f32_32x32x16_bf16 v[96:111], v[32:35], v[44:47], v[96:111]
    ds_read_b64_tr_b16 v[212:213], v13 offset:0
    ds_read_b64_tr_b16 v[214:215], v13 offset:1024
    v_mfma_f32_32x32x16_bf16 v[112:127], v[36:39], v[40:43], v[112:127]
    ds_read_b128 v[216:219], v6 offset:0
    ds_read_b128 v[220:223], v6 offset:2048
    v_mfma_f32_32x32x16_bf16 v[128:143], v[36:39], v[44:47], v[128:143]
    s_waitcnt lgkmcnt(6)
    v_mfma_f32_32x32x16_bf16 v[80:95], v[56:59], v[64:67], v[80:95]
    ds_read_b64_tr_b16 v[32:33], v12 offset:4096
    ds_read_b64_tr_b16 v[34:35], v12 offset:5120
    v_mfma_f32_32x32x16_bf16 v[96:111], v[56:59], v[68:71], v[96:111]
    ds_read_b64_tr_b16 v[36:37], v13 offset:4096
    ds_read_b64_tr_b16 v[38:39], v13 offset:5120
    v_mfma_f32_32x32x16_bf16 v[112:127], v[60:63], v[64:67], v[112:127]
    ds_read_b128 v[40:43], v7 offset:0
    ds_read_b128 v[44:47], v7 offset:2048
    v_mfma_f32_32x32x16_bf16 v[128:143], v[60:63], v[68:71], v[128:143]
    s_waitcnt vmcnt(4)
    s_barrier
    s_waitcnt lgkmcnt(6)
    v_mfma_f32_32x32x16_bf16 v[80:95], v[208:211], v[216:219], v[80:95]
    ds_read_b64_tr_b16 v[56:57], v10 offset:32768
    ds_read_b64_tr_b16 v[58:59], v10 offset:33792
    v_mfma_f32_32x32x16_bf16 v[96:111], v[208:211], v[220:223], v[96:111]
    ds_read_b64_tr_b16 v[60:61], v11 offset:32768
    ds_read_b64_tr_b16 v[62:63], v11 offset:33792
    v_mfma_f32_32x32x16_bf16 v[112:127], v[212:215], v[216:219], v[112:127]
    ds_read_b128 v[64:67], v6 offset:16384
    ds_read_b128 v[68:71], v6 offset:18432
    v_mfma_f32_32x32x16_bf16 v[128:143], v[212:215], v[220:223], v[128:143]
    s_waitcnt lgkmcnt(6)
    v_mfma_f32_32x32x16_bf16 v[80:95], v[32:35], v[40:43], v[80:95]
    ds_read_b64_tr_b16 v[208:209], v10 offset:36864
    ds_read_b64_tr_b16 v[210:211], v10 offset:37888
    v_mfma_f32_32x32x16_bf16 v[96:111], v[32:35], v[44:47], v[96:111]
    ds_read_b64_tr_b16 v[212:213], v11 offset:36864
    ds_read_b64_tr_b16 v[214:215], v11 offset:37888
    v_mfma_f32_32x32x16_bf16 v[112:127], v[36:39], v[40:43], v[112:127]
    ds_read_b128 v[216:219], v7 offset:16384
    ds_read_b128 v[220:223], v7 offset:18432
    v_mfma_f32_32x32x16_bf16 v[128:143], v[36:39], v[44:47], v[128:143]
    s_waitcnt vmcnt(0)
    s_barrier
    s_waitcnt lgkmcnt(6)
    v_mfma_f32_32x32x16_bf16 v[80:95], v[56:59], v[64:67], v[80:95]
    ds_read_b64_tr_b16 v[32:33], v12 offset:16384
    ds_read_b64_tr_b16 v[34:35], v12 offset:17408
    v_mfma_f32_32x32x16_bf16 v[96:111], v[56:59], v[68:71], v[96:111]
    ds_read_b64_tr_b16 v[36:37], v13 offset:16384
    ds_read_b64_tr_b16 v[38:39], v13 offset:17408
    v_mfma_f32_32x32x16_bf16 v[112:127], v[60:63], v[64:67], v[112:127]
    ds_read_b128 v[40:43], v6 offset:49152
    ds_read_b128 v[44:47], v6 offset:51200
    v_mfma_f32_32x32x16_bf16 v[128:143], v[60:63], v[68:71], v[128:143]
    s_mov_b32 m0, s82
    s_nop 0
    buffer_load_dwordx4 v244, s[56:59], s83 offen offset:0 lds
    buffer_load_dwordx4 v245, s[56:59], s83 offen offset:1024 lds
    buffer_load_dwordx4 v246, s[56:59], s83 offen offset:2048 lds
    buffer_load_dwordx4 v247, s[56:59], s83 offen offset:3072 lds
    s_waitcnt lgkmcnt(6)
    v_mfma_f32_32x32x16_bf16 v[80:95], v[208:211], v[216:219], v[80:95]
    ds_read_b64_tr_b16 v[56:57], v12 offset:20480
    ds_read_b64_tr_b16 v[58:59], v12 offset:21504
    v_mfma_f32_32x32x16_bf16 v[96:111], v[208:211], v[220:223], v[96:111]
    ds_read_b64_tr_b16 v[60:61], v13 offset:20480
    ds_read_b64_tr_b16 v[62:63], v13 offset:21504
    v_mfma_f32_32x32x16_bf16 v[112:127], v[212:215], v[216:219], v[112:127]
    ds_read_b128 v[64:67], v7 offset:49152
    ds_read_b128 v[68:71], v7 offset:51200
    v_mfma_f32_32x32x16_bf16 v[128:143], v[212:215], v[220:223], v[128:143]
    s_waitcnt lgkmcnt(6)
    v_mfma_f32_32x32x16_bf16 v[80:95], v[32:35], v[40:43], v[80:95]
    v_mfma_f32_32x32x16_bf16 v[96:111], v[32:35], v[44:47], v[96:111]
    v_mfma_f32_32x32x16_bf16 v[112:127], v[36:39], v[40:43], v[112:127]
    v_mfma_f32_32x32x16_bf16 v[128:143], v[36:39], v[44:47], v[128:143]
    s_waitcnt lgkmcnt(0)
    v_mfma_f32_32x32x16_bf16 v[80:95], v[56:59], v[64:67], v[80:95]
    v_mfma_f32_32x32x16_bf16 v[96:111], v[56:59], v[68:71], v[96:111]
    v_mfma_f32_32x32x16_bf16 v[112:127], v[60:63], v[64:67], v[112:127]
    v_mfma_f32_32x32x16_bf16 v[128:143], v[60:63], v[68:71], v[128:143]
    s_branch QH_JOIN
QH_HW:
    s_setprio 1
    s_waitcnt vmcnt(4)
    s_barrier
    ds_read_b64_tr_b16 v[32:33], v12 offset:16384
    ds_read_b64_tr_b16 v[34:35], v12 offset:17408
    ds_read_b64_tr_b16 v[36:37], v13 offset:16384
    ds_read_b64_tr_b16 v[38:39], v13 offset:17408
    ds_read_b128 v[40:43], v6 offset:49152
    ds_read_b128 v[44:47], v6 offset:51200
    ds_read_b64_tr_b16 v[48:49], v12 offset:24576
    ds_read_b64_tr_b16 v[50:51], v12 offset:25600
    ds_read_b64_tr_b16 v[52:53], v13 offset:24576
    ds_read_b64_tr_b16 v[54:55], v13 offset:25600
    ds_read_b64_tr_b16 v[56:57], v12 offset:20480
    ds_read_b64_tr_b16 v[58:59], v12 offset:21504
    ds_read_b64_tr_b16 v[60:61], v13 offset:20480
    ds_read_b64_tr_b16 v[62:63], v13 offset:21504
    ds_read_b128 v[64:67], v7 offset:49152
    ds_read_b128 v[68:71], v7 offset:51200
    ds_read_b64_tr_b16 v[72:73], v12 offset:28672
    ds_read_b64_tr_b16 v[74:75], v12 offset:29696
    ds_read_b64_tr_b16 v[76:77], v13 offset:28672
    ds_read_b64_tr_b16 v[78:79], v13 offset:29696
    s_waitcnt vmcnt(0)
    s_barrier
    s_waitcnt lgkmcnt(10)
    v_mfma_f32_32x32x16_bf16 v[80:95], v[32:35], v[40:43], 0
    s_add_u32 m0, s74, 131072
    s_nop 0
    buffer_load_dwordx4 v3, s[44:47], s65 offen lds
    s_add_u32 m0, s74, 131072
    s_nop 0
    buffer_load_dwordx4 v3, s[44:47], s65 offen offset:1024 lds
    s_add_u32 s65, s65, 131072
    v_mfma_f32_32x32x16_bf16 v[96:111], v[32:35], v[44:47], 0
    s_add_u32 m0, s71, 147456
    s_nop 0
    buffer_load_dwordx4 v4, s[48:51], s66 offen lds
    s_add_u32 s66, s66, s68
    s_add_u32 m0, s71, 155648
    s_nop 0
    buffer_load_dwordx4 v20, s[12:15], s81 offen lds
    s_add_u32 s81, s81, s63
    v_mfma_f32_32x32x16_bf16 v[112:127], v[36:39], v[40:43], 0
    ds_read_b64_tr_b16 v[208:209], v12 offset:49152
    ds_read_b64_tr_b16 v[210:211], v12 offset:50176
    v_mfma_f32_32x32x16_bf16 v[128:143], v[36:39], v[44:47], 0
    ds_read_b64_tr_b16 v[212:213], v13 offset:49152
    ds_read_b64_tr_b16 v[214:215], v13 offset:50176
    v_mfma_f32_32x32x16_bf16 v[144:159], v[48:51], v[40:43], 0
    ds_read_b128 v[216:219], v8 offset:32768
    ds_read_b128 v[220:223], v8 offset:34816
    v_mfma_f32_32x32x16_bf16 v[160:175], v[48:51], v[44:47], 0
    ds_read_b64_tr_b16 v[224:225], v12 offset:57344
    ds_read_b64_tr_b16 v[226:227], v12 offset:58368
    v_mfma_f32_32x32x16_bf16 v[176:191], v[52:55], v[40:43], 0
    ds_read_b64_tr_b16 v[228:229], v13 offset:57344
    ds_read_b64_tr_b16 v[230:231], v13 offset:58368
    v_mfma_f32_32x32x16_bf16 v[192:207], v[52:55], v[44:47], 0
    s_waitcnt lgkmcnt(10)
    v_mfma_f32_32x32x16_bf16 v[80:95], v[56:59], v[64:67], v[80:95]
    s_add_u32 m0, s74, 0
    s_nop 0
    buffer_load_dwordx4 v3, s[44:47], s65 offen lds
    s_add_u32 m0, s74, 0
    s_nop 0
    buffer_load_dwordx4 v3, s[44:47], s65 offen offset:1024 lds
    s_add_u32 s65, s65, 131072
    v_mfma_f32_32x32x16_bf16 v[96:111], v[56:59], v[68:71], v[96:111]
    s_add_u32 m0, s71, 65536
    s_nop 0
    buffer_load_dwordx4 v4, s[48:51], s66 offen lds
    s_add_u32 s66, s66, s68
    s_add_u32 m0, s71, 73728
    s_nop 0
    buffer_load_dwordx4 v20, s[12:15], s81 offen lds
    s_add_u32 s81, s81, s63
    v_mfma_f32_32x32x16_bf16 v[112:127], v[60:63], v[64:67], v[112:127]
    ds_read_b64_tr_b16 v[32:33], v12 offset:53248
    ds_read_b64_tr_b16 v[34:35], v12 offset:54272
    v_mfma_f32_32x32x16_bf16 v[128:143], v[60:63], v[68:71], v[128:143]
    ds_read_b64_tr_b16 v[36:37], v13 offset:53248
    ds_read_b64_tr_b16 v[38:39], v13 offset:54272
    v_mfma_f32_32x32x16_bf16 v[144:159], v[72:75], v[64:67], v[144:159]
    ds_read_b128 v[40:43], v9 offset:32768
    ds_read_b128 v[44:47], v9 offset:34816
    v_mfma_f32_32x32x16_bf16 v[160:175], v[72:75], v[68:71], v[160:175]
    ds_read_b64_tr_b16 v[48:49], v12 offset:61440
    ds_read_b64_tr_b16 v[50:51], v12 offset:62464
    v_mfma_f32_32x32x16_bf16 v[176:191], v[76:79], v[64:67], v[176:191]
    ds_read_b64_tr_b16 v[52:53], v13 offset:61440
    ds_read_b64_tr_b16 v[54:55], v13 offset:62464
    v_mfma_f32_32x32x16_bf16 v[192:207], v[76:79], v[68:71], v[192:207]
    s_waitcnt vmcnt(4)
    s_barrier
    s_waitcnt lgkmcnt(10)
    v_mfma_f32_32x32x16_bf16 v[80:95], v[208:211], v[216:219], v[80:95]
    s_add_u32 m0, s74, 16384
    s_nop 0
    buffer_load_dwordx4 v3, s[44:47], s65 offen lds
    s_add_u32 m0, s74, 16384
    s_nop 0
    buffer_load_dwordx4 v3, s[44:47], s65 offen offset:1024 lds
    s_add_u32 s65, s65, 131072
    v_mfma_f32_32x32x16_bf16 v[96:111], v[208:211], v[220:223], v[96:111]
    s_add_u32 m0, s71, 32768
    s_nop 0
    buffer_load_dwordx4 v4, s[48:51], s66 offen lds
    s_add_u32 s66, s66, s68
    s_add_u32 m0, s71, 40960
    s_nop 0
    buffer_load_dwordx4 v20, s[12:15], s81 offen lds
    s_add_u32 s81, s81, s63
    v_mfma_f32_32x32x16_bf16 v[112:127], v[212:215], v[216:219], v[112:127]
    ds_read_b64_tr_b16 v[56:57], v30 offset:16384
    ds_read_b64_tr_b16 v[58:59], v30 offset:17408
    v_mfma_f32_32x32x16_bf16 v[128:143], v[212:215], v[220:223], v[128:143]
    ds_read_b64_tr_b16 v[60:61], v31 offset:16384
    ds_read_b64_tr_b16 v[62:63], v31 offset:17408
    v_mfma_f32_32x32x16_bf16 v[144:159], v[224:227], v[216:219], v[144:159]
    ds_read_b128 v[64:67], v28 offset:0
    ds_read_b128 v[68:71], v28 offset:2048
    v_mfma_f32_32x32x16_bf16 v[160:175], v[224:227], v[220:223], v[160:175]
    ds_read_b64_tr_b16 v[72:73], v30 offset:24576
    ds_read_b64_tr_b16 v[74:75], v30 offset:25600
    v_mfma_f32_32x32x16_bf16 v[176:191], v[228:231], v[216:219], v[176:191]
    ds_read_b64_tr_b16 v[76:77], v31 offset:24576
    ds_read_b64_tr_b16 v[78:79], v31 offset:25600
    v_mfma_f32_32x32x16_bf16 v[192:207], v[228:231], v[220:223], v[192:207]
    s_waitcnt lgkmcnt(10)
    v_mfma_f32_32x32x16_bf16 v[80:95], v[32:35], v[40:43], v[80:95]
    s_add_u32 m0, s74, 49152
    s_nop 0
    buffer_load_dwordx4 v3, s[44:47], s65 offen lds
    s_add_u32 m0, s74, 49152
    s_nop 0
    buffer_load_dwordx4 v3, s[44:47], s65 offen offset:1024 lds
    s_add_u32 s65, s65, 131072
    v_mfma_f32_32x32x16_bf16 v[96:111], v[32:35], v[44:47], v[96:111]
    s_add_u32 m0, s71, 81920
    s_nop 0
    buffer_load_dwordx4 v4, s[48:51], s66 offen lds
    s_add_u32 s66, s66, s68
    s_add_u32 m0, s71, 90112
    s_nop 0
    buffer_load_dwordx4 v20, s[12:15], s81 offen lds
    s_add_u32 s81, s81, s63
    v_mfma_f32_32x32x16_bf16 v[112:127], v[36:39], v[40:43], v[112:127]
    ds_read_b64_tr_b16 v[208:209], v30 offset:20480
    ds_read_b64_tr_b16 v[210:211], v30 offset:21504
    v_mfma_f32_32x32x16_bf16 v[128:143], v[36:39], v[44:47], v[128:143]
    ds_read_b64_tr_b16 v[212:213], v31 offset:20480
    ds_read_b64_tr_b16 v[214:215], v31 offset:21504
    v_mfma_f32_32x32x16_bf16 v[144:159], v[48:51], v[40:43], v[144:159]
    ds_read_b128 v[216:219], v29 offset:0
    ds_read_b128 v[220:223], v29 offset:2048
    v_mfma_f32_32x32x16_bf16 v[160:175], v[48:51], v[44:47], v[160:175]
    ds_read_b64_tr_b16 v[224:225], v30 offset:28672
    ds_read_b64_tr_b16 v[226:227], v30 offset:29696
    v_mfma_f32_32x32x16_bf16 v[176:191], v[52:55], v[40:43], v[176:191]
    ds_read_b64_tr_b16 v[228:229], v31 offset:28672
    ds_read_b64_tr_b16 v[230:231], v31 offset:29696
    v_mfma_f32_32x32x16_bf16 v[192:207], v[52:55], v[44:47], v[192:207]
    s_waitcnt vmcnt(8)
    s_barrier
    s_waitcnt lgkmcnt(10)
    v_mfma_f32_32x32x16_bf16 v[80:95], v[56:59], v[64:67], v[80:95]
    ds_read_b64_tr_b16 v[32:33], v12 offset:0
    ds_read_b64_tr_b16 v[34:35], v12 offset:1024
    v_mfma_f32_32x32x16_bf16 v[96:111], v[56:59], v[68:71], v[96:111]
    ds_read_b64_tr_b16 v[36:37], v13 offset:0
    ds_read_b64_tr_b16 v[38:39], v13 offset:1024
    v_mfma_f32_32x32x16_bf16 v[112:127], v[60:63], v[64:67], v[112:127]
    ds_read_b128 v[40:43], v6 offset:0
    ds_read_b128 v[44:47], v6 offset:2048
    v_mfma_f32_32x32x16_bf16 v[128:143], v[60:63], v[68:71], v[128:143]
    ds_read_b64_tr_b16 v[48:49], v12 offset:8192
    ds_read_b64_tr_b16 v[50:51], v12 offset:9216
    v_mfma_f32_32x32x16_bf16 v[144:159], v[72:75], v[64:67], v[144:159]
    ds_read_b64_tr_b16 v[52:53], v13 offset:8192
    ds_read_b64_tr_b16 v[54:55], v13 offset:9216
    v_mfma_f32_32x32x16_bf16 v[160:175], v[72:75], v[68:71], v[160:175]
    s_add_u32 m0, s74, 98304
    s_nop 0
    buffer_load_dwordx4 v3, s[44:47], s65 offen lds
    s_add_u32 m0, s74, 98304
    s_nop 0
    buffer_load_dwordx4 v3, s[44:47], s65 offen offset:1024 lds
    s_add_u32 s65, s65, 131072
    v_mfma_f32_32x32x16_bf16 v[176:191], v[76:79], v[64:67], v[176:191]
    v_mfma_f32_32x32x16_bf16 v[192:207], v[76:79], v[68:71], v[192:207]
    s_waitcnt lgkmcnt(10)
    v_mfma_f32_32x32x16_bf16 v[80:95], v[208:211], v[216:219], v[80:95]
    ds_read_b64_tr_b16 v[56:57], v12 offset:4096
    ds_read_b64_tr_b16 v[58:59], v12 offset:5120
    v_mfma_f32_32x32x16_bf16 v[96:111], v[208:211], v[220:223], v[96:111]
    ds_read_b64_tr_b16 v[60:61], v13 offset:4096
    ds_read_b64_tr_b16 v[62:63], v13 offset:5120
    v_mfma_f32_32x32x16_bf16 v[112:127], v[212:215], v[216:219], v[112:127]
    ds_read_b128 v[64:67], v7 offset:0
    ds_read_b128 v[68:71], v7 offset:2048
    v_mfma_f32_32x32x16_bf16 v[128:143], v[212:215], v[220:223], v[128:143]
    ds_read_b64_tr_b16 v[72:73], v12 offset:12288
    ds_read_b64_tr_b16 v[74:75], v12 offset:13312
    v_mfma_f32_32x32x16_bf16 v[144:159], v[224:227], v[216:219], v[144:159]
    ds_read_b64_tr_b16 v[76:77], v13 offset:12288
    ds_read_b64_tr_b16 v[78:79], v13 offset:13312
    v_mfma_f32_32x32x16_bf16 v[160:175], v[224:227], v[220:223], v[160:175]
    s_add_u32 m0, s71, 114688
    s_nop 0
    buffer_load_dwordx4 v4, s[48:51], s66 offen lds
    s_add_u32 s66, s66, s68
    s_add_u32 m0, s71, 122880
    s_nop 0
    buffer_load_dwordx4 v20, s[12:15], s81 offen lds
    s_add_u32 s81, s81, s63
    v_mfma_f32_32x32x16_bf16 v[176:191], v[228:231], v[216:219], v[176:191]
    v_mfma_f32_32x32x16_bf16 v[192:207], v[228:231], v[220:223], v[192:207]
    s_waitcnt vmcnt(8)
    s_barrier
    s_waitcnt lgkmcnt(10)
    v_mfma_f32_32x32x16_bf16 v[80:95], v[32:35], v[40:43], v[80:95]
    ds_read_b64_tr_b16 v[208:209], v10 offset:32768
    ds_read_b64_tr_b16 v[210:211], v10 offset:33792
    v_mfma_f32_32x32x16_bf16 v[96:111], v[32:35], v[44:47], v[96:111]
    ds_read_b64_tr_b16 v[212:213], v11 offset:32768
    ds_read_b64_tr_b16 v[214:215], v11 offset:33792
    v_mfma_f32_32x32x16_bf16 v[112:127], v[36:39], v[40:43], v[112:127]
    ds_read_b128 v[216:219], v6 offset:16384
    ds_read_b128 v[220:223], v6 offset:18432
    v_mfma_f32_32x32x16_bf16 v[128:143], v[36:39], v[44:47], v[128:143]
    ds_read_b64_tr_b16 v[224:225], v10 offset:40960
    ds_read_b64_tr_b16 v[226:227], v10 offset:41984
    v_mfma_f32_32x32x16_bf16 v[144:159], v[48:51], v[40:43], v[144:159]
    ds_read_b64_tr_b16 v[228:229], v11 offset:40960
    ds_read_b64_tr_b16 v[230:231], v11 offset:41984
    v_mfma_f32_32x32x16_bf16 v[160:175], v[48:51], v[44:47], v[160:175]
    s_add_u32 m0, s74, 131072
    s_nop 0
    buffer_load_dwordx4 v3, s[44:47], s65 offen lds
    s_add_u32 m0, s74, 131072
    s_nop 0
    buffer_load_dwordx4 v3, s[44:47], s65 offen offset:1024 lds
    s_add_u32 s65, s65, 131072
    v_mfma_f32_32x32x16_bf16 v[176:191], v[52:55], v[40:43], v[176:191]
    v_mfma_f32_32x32x16_bf16 v[192:207], v[52:55], v[44:47], v[192:207]
    s_waitcnt lgkmcnt(10)
    v_mfma_f32_32x32x16_bf16 v[80:95], v[56:59], v[64:67], v[80:95]
    ds_read_b64_tr_b16 v[32:33], v10 offset:36864
    ds_read_b64_tr_b16 v[34:35], v10 offset:37888
    v_mfma_f32_32x32x16_bf16 v[96:111], v[56:59], v[68:71], v[96:111]
    ds_read_b64_tr_b16 v[36:37], v11 offset:36864
    ds_read_b64_tr_b16 v[38:39], v11 offset:37888
    v_mfma_f32_32x32x16_bf16 v[112:127], v[60:63], v[64:67], v[112:127]
    ds_read_b128 v[40:43], v7 offset:16384
    ds_read_b128 v[44:47], v7 offset:18432
    v_mfma_f32_32x32x16_bf16 v[128:143], v[60:63], v[68:71], v[128:143]
    ds_read_b64_tr_b16 v[48:49], v10 offset:45056
    ds_read_b64_tr_b16 v[50:51], v10 offset:46080
    v_mfma_f32_32x32x16_bf16 v[144:159], v[72:75], v[64:67], v[144:159]
    ds_read_b64_tr_b16 v[52:53], v11 offset:45056
    ds_read_b64_tr_b16 v[54:55], v11 offset:46080
    v_mfma_f32_32x32x16_bf16 v[160:175], v[72:75], v[68:71], v[160:175]
    s_add_u32 m0, s71, 147456
    s_nop 0
    buffer_load_dwordx4 v4, s[48:51], s66 offen lds
    s_add_u32 s66, s66, s68
    s_add_u32 m0, s71, 155648
    s_nop 0
    buffer_load_dwordx4 v20, s[12:15], s81 offen lds
    s_add_u32 s81, s81, s63
    v_mfma_f32_32x32x16_bf16 v[176:191], v[76:79], v[64:67], v[176:191]
    v_mfma_f32_32x32x16_bf16 v[192:207], v[76:79], v[68:71], v[192:207]
    s_waitcnt vmcnt(8)
    s_barrier
    s_waitcnt lgkmcnt(10)
    v_mfma_f32_32x32x16_bf16 v[80:95], v[208:211], v[216:219], v[80:95]
    ds_read_b64_tr_b16 v[56:57], v12 offset:16384
    ds_read_b64_tr_b16 v[58:59], v12 offset:17408
    v_mfma_f32_32x32x16_bf16 v[96:111], v[208:211], v[220:223], v[96:111]
    ds_read_b64_tr_b16 v[60:61], v13 offset:16384
    ds_read_b64_tr_b16 v[62:63], v13 offset:17408
    v_mfma_f32_32x32x16_bf16 v[112:127], v[212:215], v[216:219], v[112:127]
    ds_read_b128 v[64:67], v6 offset:49152
    ds_read_b128 v[68:71], v6 offset:51200
    v_mfma_f32_32x32x16_bf16 v[128:143], v[212:215], v[220:223], v[128:143]
    ds_read_b64_tr_b16 v[72:73], v12 offset:24576
    ds_read_b64_tr_b16 v[74:75], v12 offset:25600
    v_mfma_f32_32x32x16_bf16 v[144:159], v[224:227], v[216:219], v[144:159]
    ds_read_b64_tr_b16 v[76:77], v13 offset:24576
    ds_read_b64_tr_b16 v[78:79], v13 offset:25600
    v_mfma_f32_32x32x16_bf16 v[160:175], v[224:227], v[220:223], v[160:175]
    s_add_u32 m0, s74, 0
    s_nop 0
    buffer_load_dwordx4 v3, s[44:47], s65 offen lds
    s_add_u32 m0, s74, 0
    s_nop 0
    buffer_load_dwordx4 v3, s[44:47], s65 offen offset:1024 lds
    s_add_u32 s65, s65, 131072
    v_mfma_f32_32x32x16_bf16 v[176:191], v[228:231], v[216:219], v[176:191]
    v_mfma_f32_32x32x16_bf16 v[192:207], v[228:231], v[220:223], v[192:207]
    s_waitcnt lgkmcnt(10)
    v_mfma_f32_32x32x16_bf16 v[80:95], v[32:35], v[40:43], v[80:95]
    ds_read_b64_tr_b16 v[208:209], v12 offset:20480
    ds_read_b64_tr_b16 v[210:211], v12 offset:21504
    v_mfma_f32_32x32x16_bf16 v[96:111], v[32:35], v[44:47], v[96:111]
    ds_read_b64_tr_b16 v[212:213], v13 offset:20480
    ds_read_b64_tr_b16 v[214:215], v13 offset:21504
    v_mfma_f32_32x32x16_bf16 v[112:127], v[36:39], v[40:43], v[112:127]
    ds_read_b128 v[216:219], v7 offset:49152
    ds_read_b128 v[220:223], v7 offset:51200
    v_mfma_f32_32x32x16_bf16 v[128:143], v[36:39], v[44:47], v[128:143]
    ds_read_b64_tr_b16 v[224:225], v12 offset:28672
    ds_read_b64_tr_b16 v[226:227], v12 offset:29696
    v_mfma_f32_32x32x16_bf16 v[144:159], v[48:51], v[40:43], v[144:159]
    ds_read_b64_tr_b16 v[228:229], v13 offset:28672
    ds_read_b64_tr_b16 v[230:231], v13 offset:29696
    v_mfma_f32_32x32x16_bf16 v[160:175], v[48:51], v[44:47], v[160:175]
    s_add_u32 m0, s71, 65536
    s_nop 0
    buffer_load_dwordx4 v4, s[48:51], s66 offen lds
    s_add_u32 s66, s66, s68
    s_add_u32 m0, s71, 73728
    s_nop 0
    buffer_load_dwordx4 v20, s[12:15], s81 offen lds
    s_add_u32 s81, s81, s63
    v_mfma_f32_32x32x16_bf16 v[176:191], v[52:55], v[40:43], v[176:191]
    v_mfma_f32_32x32x16_bf16 v[192:207], v[52:55], v[44:47], v[192:207]
    s_waitcnt vmcnt(8)
    s_barrier
    s_waitcnt lgkmcnt(10)
    v_mfma_f32_32x32x16_bf16 v[80:95], v[56:59], v[64:67], v[80:95]
    ds_read_b64_tr_b16 v[32:33], v12 offset:49152
    ds_read_b64_tr_b16 v[34:35], v12 offset:50176
    v_mfma_f32_32x32x16_bf16 v[96:111], v[56:59], v[68:71], v[96:111]
    ds_read_b64_tr_b16 v[36:37], v13 offset:49152
    ds_read_b64_tr_b16 v[38:39], v13 offset:50176
    v_mfma_f32_32x32x16_bf16 v[112:127], v[60:63], v[64:67], v[112:127]
    ds_read_b128 v[40:43], v8 offset:32768
    ds_read_b128 v[44:47], v8 offset:34816
    v_mfma_f32_32x32x16_bf16 v[128:143], v[60:63], v[68:71], v[128:143]
    ds_read_b64_tr_b16 v[48:49], v12 offset:57344
    ds_read_b64_tr_b16 v[50:51], v12 offset:58368
    v_mfma_f32_32x32x16_bf16 v[144:159], v[72:75], v[64:67], v[144:159]
    ds_read_b64_tr_b16 v[52:53], v13 offset:57344
    ds_read_b64_tr_b16 v[54:55], v13 offset:58368
    v_mfma_f32_32x32x16_bf16 v[160:175], v[72:75], v[68:71], v[160:175]
    s_add_u32 m0, s74, 16384
    s_nop 0
    buffer_load_dwordx4 v3, s[44:47], s65 offen lds
    s_add_u32 m0, s74, 16384
    s_nop 0
    buffer_load_dwordx4 v3, s[44:47], s65 offen offset:1024 lds
    s_add_u32 s65, s65, 131072
    v_mfma_f32_32x32x16_bf16 v[176:191], v[76:79], v[64:67], v[176:191]
    v_mfma_f32_32x32x16_bf16 v[192:207], v[76:79], v[68:71], v[192:207]
    s_waitcnt lgkmcnt(10)
    v_mfma_f32_32x32x16_bf16 v[80:95], v[208:211], v[216:219], v[80:95]
    ds_read_b64_tr_b16 v[56:57], v12 offset:53248
    ds_read_b64_tr_b16 v[58:59], v12 offset:54272
    v_mfma_f32_32x32x16_bf16 v[96:111], v[208:211], v[220:223], v[96:111]
    ds_read_b64_tr_b16 v[60:61], v13 offset:53248
    ds_read_b64_tr_b16 v[62:63], v13 offset:54272
    v_mfma_f32_32x32x16_bf16 v[112:127], v[212:215], v[216:219], v[112:127]
    ds_read_b128 v[64:67], v9 offset:32768
    ds_read_b128 v[68:71], v9 offset:34816
    v_mfma_f32_32x32x16_bf16 v[128:143], v[212:215], v[220:223], v[128:143]
    ds_read_b64_tr_b16 v[72:73], v12 offset:61440
    ds_read_b64_tr_b16 v[74:75], v12 offset:62464
    v_mfma_f32_32x32x16_bf16 v[144:159], v[224:227], v[216:219], v[144:159]
    ds_read_b64_tr_b16 v[76:77], v13 offset:61440
    ds_read_b64_tr_b16 v[78:79], v13 offset:62464
    v_mfma_f32_32x32x16_bf16 v[160:175], v[224:227], v[220:223], v[160:175]
    s_add_u32 m0, s71, 32768
    s_nop 0
    buffer_load_dwordx4 v4, s[48:51], s66 offen lds
    s_add_u32 s66, s66, s68
    s_add_u32 m0, s71, 40960
    s_nop 0
    buffer_load_dwordx4 v20, s[12:15], s81 offen lds
    s_add_u32 s81, s81, s63
    v_mfma_f32_32x32x16_bf16 v[176:191], v[228:231], v[216:219], v[176:191]
    v_mfma_f32_32x32x16_bf16 v[192:207], v[228:231], v[220:223], v[192:207]
    s_waitcnt vmcnt(8)
    s_barrier
    s_waitcnt lgkmcnt(10)
    v_mfma_f32_32x32x16_bf16 v[80:95], v[32:35], v[40:43], v[80:95]
    ds_read_b64_tr_b16 v[208:209], v30 offset:16384
    ds_read_b64_tr_b16 v[210:211], v30 offset:17408
    v_mfma_f32_32x32x16_bf16 v[96:111], v[32:35], v[44:47], v[96:111]
    ds_read_b64_tr_b16 v[212:213], v31 offset:16384
    ds_read_b64_tr_b16 v[214:215], v31 offset:17408
    v_mfma_f32_32x32x16_bf16 v[112:127], v[36:39], v[40:43], v[112:127]
    ds_read_b128 v[216:219], v28 offset:0
    ds_read_b128 v[220:223], v28 offset:2048
    v_mfma_f32_32x32x16_bf16 v[128:143], v[36:39], v[44:47], v[128:143]
    ds_read_b64_tr_b16 v[224:225], v30 offset:24576
    ds_read_b64_tr_b16 v[226:227], v30 offset:25600
    v_mfma_f32_32x32x16_bf16 v[144:159], v[48:51], v[40:43], v[144:159]
    ds_read_b64_tr_b16 v[228:229], v31 offset:24576
    ds_read_b64_tr_b16 v[230:231], v31 offset:25600
    v_mfma_f32_32x32x16_bf16 v[160:175], v[48:51], v[44:47], v[160:175]
    s_add_u32 m0, s74, 49152
    s_nop 0
    buffer_load_dwordx4 v3, s[44:47], s65 offen lds
    s_add_u32 m0, s74, 49152
    s_nop 0
    buffer_load_dwordx4 v3, s[44:47], s65 offen offset:1024 lds
    s_add_u32 s65, s65, 131072
    v_mfma_f32_32x32x16_bf16 v[176:191], v[52:55], v[40:43], v[176:191]
    v_mfma_f32_32x32x16_bf16 v[192:207], v[52:55], v[44:47], v[192:207]
    s_waitcnt lgkmcnt(10)
    v_mfma_f32_32x32x16_bf16 v[80:95], v[56:59], v[64:67], v[80:95]
    ds_read_b64_tr_b16 v[32:33], v30 offset:20480
    ds_read_b64_tr_b16 v[34:35], v30 offset:21504
    v_mfma_f32_32x32x16_bf16 v[96:111], v[56:59], v[68:71], v[96:111]
    ds_read_b64_tr_b16 v[36:37], v31 offset:20480
    ds_read_b64_tr_b16 v[38:39], v31 offset:21504
    v_mfma_f32_32x32x16_bf16 v[112:127], v[60:63], v[64:67], v[112:127]
    ds_read_b128 v[40:43], v29 offset:0
    ds_read_b128 v[44:47], v29 offset:2048
    v_mfma_f32_32x32x16_bf16 v[128:143], v[60:63], v[68:71], v[128:143]
    ds_read_b64_tr_b16 v[48:49], v30 offset:28672
    ds_read_b64_tr_b16 v[50:51], v30 offset:29696
    v_mfma_f32_32x32x16_bf16 v[144:159], v[72:75], v[64:67], v[144:159]
    ds_read_b64_tr_b16 v[52:53], v31 offset:28672
    ds_read_b64_tr_b16 v[54:55], v31 offset:29696
    v_mfma_f32_32x32x16_bf16 v[160:175], v[72:75], v[68:71], v[160:175]
    s_add_u32 m0, s71, 81920
    s_nop 0
    buffer_load_dwordx4 v4, s[48:51], s66 offen lds
    s_add_u32 s66, s66, s68
    s_add_u32 m0, s71, 90112
    s_nop 0
    buffer_load_dwordx4 v20, s[12:15], s81 offen lds
    s_add_u32 s81, s81, s63
    v_mfma_f32_32x32x16_bf16 v[176:191], v[76:79], v[64:67], v[176:191]
    v_mfma_f32_32x32x16_bf16 v[192:207], v[76:79], v[68:71], v[192:207]
    s_waitcnt vmcnt(8)
    s_barrier
    s_waitcnt lgkmcnt(10)
    v_mfma_f32_32x32x16_bf16 v[80:95], v[208:211], v[216:219], v[80:95]
    ds_read_b64_tr_b16 v[56:57], v12 offset:0
    ds_read_b64_tr_b16 v[58:59], v12 offset:1024
    v_mfma_f32_32x32x16_bf16 v[96:111], v[208:211], v[220:223], v[96:111]
    ds_read_b64_tr_b16 v[60:61], v13 offset:0
    ds_read_b64_tr_b16 v[62:63], v13 offset:1024
    v_mfma_f32_32x32x16_bf16 v[112:127], v[212:215], v[216:219], v[112:127]
    ds_read_b128 v[64:67], v6 offset:0
    ds_read_b128 v[68:71], v6 offset:2048
    v_mfma_f32_32x32x16_bf16 v[128:143], v[212:215], v[220:223], v[128:143]
    ds_read_b64_tr_b16 v[72:73], v12 offset:8192
    ds_read_b64_tr_b16 v[74:75], v12 offset:9216
    v_mfma_f32_32x32x16_bf16 v[144:159], v[224:227], v[216:219], v[144:159]
    ds_read_b64_tr_b16 v[76:77], v13 offset:8192
    ds_read_b64_tr_b16 v[78:79], v13 offset:9216
    v_mfma_f32_32x32x16_bf16 v[160:175], v[224:227], v[220:223], v[160:175]
    s_add_u32 m0, s74, 98304
    s_nop 0
    buffer_load_dwordx4 v3, s[44:47], s65 offen lds
    s_add_u32 m0, s74, 98304
    s_nop 0
    buffer_load_dwordx4 v3, s[44:47], s65 offen offset:1024 lds
    s_add_u32 s65, s65, 131072
    v_mfma_f32_32x32x16_bf16 v[176:191], v[228:231], v[216:219], v[176:191]
    v_mfma_f32_32x32x16_bf16 v[192:207], v[228:231], v[220:223], v[192:207]
    s_waitcnt lgkmcnt(10)
    v_mfma_f32_32x32x16_bf16 v[80:95], v[32:35], v[40:43], v[80:95]
    ds_read_b64_tr_b16 v[208:209], v12 offset:4096
    ds_read_b64_tr_b16 v[210:211], v12 offset:5120
    v_mfma_f32_32x32x16_bf16 v[96:111], v[32:35], v[44:47], v[96:111]
    ds_read_b64_tr_b16 v[212:213], v13 offset:4096
    ds_read_b64_tr_b16 v[214:215], v13 offset:5120
    v_mfma_f32_32x32x16_bf16 v[112:127], v[36:39], v[40:43], v[112:127]
    ds_read_b128 v[216:219], v7 offset:0
    ds_read_b128 v[220:223], v7 offset:2048
    v_mfma_f32_32x32x16_bf16 v[128:143], v[36:39], v[44:47], v[128:143]
    ds_read_b64_tr_b16 v[224:225], v12 offset:12288
    ds_read_b64_tr_b16 v[226:227], v12 offset:13312
    v_mfma_f32_32x32x16_bf16 v[144:159], v[48:51], v[40:43], v[144:159]
    ds_read_b64_tr_b16 v[228:229], v13 offset:12288
    ds_read_b64_tr_b16 v[230:231], v13 offset:13312
    v_mfma_f32_32x32x16_bf16 v[160:175], v[48:51], v[44:47], v[160:175]
    s_add_u32 m0, s71, 114688
    s_nop 0
    buffer_load_dwordx4 v4, s[48:51], s66 offen lds
    s_add_u32 s66, s66, s68
    s_add_u32 m0, s71, 122880
    s_nop 0
    buffer_load_dwordx4 v20, s[12:15], s81 offen lds
    s_add_u32 s81, s81, s63
    v_mfma_f32_32x32x16_bf16 v[176:191], v[52:55], v[40:43], v[176:191]
    v_mfma_f32_32x32x16_bf16 v[192:207], v[52:55], v[44:47], v[192:207]
    s_waitcnt vmcnt(8)
    s_barrier
    s_waitcnt lgkmcnt(10)
    v_mfma_f32_32x32x16_bf16 v[80:95], v[56:59], v[64:67], v[80:95]
    ds_read_b64_tr_b16 v[32:33], v10 offset:32768
    ds_read_b64_tr_b16 v[34:35], v10 offset:33792
    v_mfma_f32_32x32x16_bf16 v[96:111], v[56:59], v[68:71], v[96:111]
    ds_read_b64_tr_b16 v[36:37], v11 offset:32768
    ds_read_b64_tr_b16 v[38:39], v11 offset:33792
    v_mfma_f32_32x32x16_bf16 v[112:127], v[60:63], v[64:67], v[112:127]
    ds_read_b128 v[40:43], v6 offset:16384
    ds_read_b128 v[44:47], v6 offset:18432
    v_mfma_f32_32x32x16_bf16 v[128:143], v[60:63], v[68:71], v[128:143]
    ds_read_b64_tr_b16 v[48:49], v10 offset:40960
    ds_read_b64_tr_b16 v[50:51], v10 offset:41984
    v_mfma_f32_32x32x16_bf16 v[144:159], v[72:75], v[64:67], v[144:159]
    ds_read_b64_tr_b16 v[52:53], v11 offset:40960
    ds_read_b64_tr_b16 v[54:55], v11 offset:41984
    v_mfma_f32_32x32x16_bf16 v[160:175], v[72:75], v[68:71], v[160:175]
    s_add_u32 m0, s74, 131072
    s_nop 0
    buffer_load_dwordx4 v3, s[44:47], s65 offen lds
    s_add_u32 m0, s74, 131072
    s_nop 0
    buffer_load_dwordx4 v3, s[44:47], s65 offen offset:1024 lds
    s_add_u32 s65, s65, 131072
    v_mfma_f32_32x32x16_bf16 v[176:191], v[76:79], v[64:67], v[176:191]
    v_mfma_f32_32x32x16_bf16 v[192:207], v[76:79], v[68:71], v[192:207]
    s_waitcnt lgkmcnt(10)
    v_mfma_f32_32x32x16_bf16 v[80:95], v[208:211], v[216:219], v[80:95]
    ds_read_b64_tr_b16 v[56:57], v10 offset:36864
    ds_read_b64_tr_b16 v[58:59], v10 offset:37888
    v_mfma_f32_32x32x16_bf16 v[96:111], v[208:211], v[220:223], v[96:111]
    ds_read_b64_tr_b16 v[60:61], v11 offset:36864
    ds_read_b64_tr_b16 v[62:63], v11 offset:37888
    v_mfma_f32_32x32x16_bf16 v[112:127], v[212:215], v[216:219], v[112:127]
    ds_read_b128 v[64:67], v7 offset:16384
    ds_read_b128 v[68:71], v7 offset:18432
    v_mfma_f32_32x32x16_bf16 v[128:143], v[212:215], v[220:223], v[128:143]
    ds_read_b64_tr_b16 v[72:73], v10 offset:45056
    ds_read_b64_tr_b16 v[74:75], v10 offset:46080
    v_mfma_f32_32x32x16_bf16 v[144:159], v[224:227], v[216:219], v[144:159]
    ds_read_b64_tr_b16 v[76:77], v11 offset:45056
    ds_read_b64_tr_b16 v[78:79], v11 offset:46080
    v_mfma_f32_32x32x16_bf16 v[160:175], v[224:227], v[220:223], v[160:175]
    s_add_u32 m0, s71, 147456
    s_nop 0
    buffer_load_dwordx4 v4, s[48:51], s66 offen lds
    s_add_u32 s66, s66, s68
    s_add_u32 m0, s71, 155648
    s_nop 0
    buffer_load_dwordx4 v20, s[12:15], s81 offen lds
    s_add_u32 s81, s81, s63
    v_mfma_f32_32x32x16_bf16 v[176:191], v[228:231], v[216:219], v[176:191]
    v_mfma_f32_32x32x16_bf16 v[192:207], v[228:231], v[220:223], v[192:207]
    s_waitcnt vmcnt(8)
    s_barrier
    s_waitcnt lgkmcnt(10)
    v_mfma_f32_32x32x16_bf16 v[80:95], v[32:35], v[40:43], v[80:95]
    ds_read_b64_tr_b16 v[208:209], v12 offset:16384
    ds_read_b64_tr_b16 v[210:211], v12 offset:17408
    v_mfma_f32_32x32x16_bf16 v[96:111], v[32:35], v[44:47], v[96:111]
    ds_read_b64_tr_b16 v[212:213], v13 offset:16384
    ds_read_b64_tr_b16 v[214:215], v13 offset:17408
    v_mfma_f32_32x32x16_bf16 v[112:127], v[36:39], v[40:43], v[112:127]
    ds_read_b128 v[216:219], v6 offset:49152
    ds_read_b128 v[220:223], v6 offset:51200
    v_mfma_f32_32x32x16_bf16 v[128:143], v[36:39], v[44:47], v[128:143]
    ds_read_b64_tr_b16 v[224:225], v12 offset:24576
    ds_read_b64_tr_b16 v[226:227], v12 offset:25600
    v_mfma_f32_32x32x16_bf16 v[144:159], v[48:51], v[40:43], v[144:159]
    ds_read_b64_tr_b16 v[228:229], v13 offset:24576
    ds_read_b64_tr_b16 v[230:231], v13 offset:25600
    v_mfma_f32_32x32x16_bf16 v[160:175], v[48:51], v[44:47], v[160:175]
    s_add_u32 m0, s74, 0
    s_nop 0
    buffer_load_dwordx4 v3, s[44:47], s65 offen lds
    s_add_u32 m0, s74, 0
    s_nop 0
    buffer_load_dwordx4 v3, s[44:47], s65 offen offset:1024 lds
    s_add_u32 s65, s65, 131072
    v_mfma_f32_32x32x16_bf16 v[176:191], v[52:55], v[40:43], v[176:191]
    v_mfma_f32_32x32x16_bf16 v[192:207], v[52:55], v[44:47], v[192:207]
    s_waitcnt lgkmcnt(10)
    v_mfma_f32_32x32x16_bf16 v[80:95], v[56:59], v[64:67], v[80:95]
    ds_read_b64_tr_b16 v[32:33], v12 offset:20480
    ds_read_b64_tr_b16 v[34:35], v12 offset:21504
    v_mfma_f32_32x32x16_bf16 v[96:111], v[56:59], v[68:71], v[96:111]
    ds_read_b64_tr_b16 v[36:37], v13 offset:20480
    ds_read_b64_tr_b16 v[38:39], v13 offset:21504
    v_mfma_f32_32x32x16_bf16 v[112:127], v[60:63], v[64:67], v[112:127]
    ds_read_b128 v[40:43], v7 offset:49152
    ds_read_b128 v[44:47], v7 offset:51200
    v_mfma_f32_32x32x16_bf16 v[128:143], v[60:63], v[68:71], v[128:143]
    ds_read_b64_tr_b16 v[48:49], v12 offset:28672
    ds_read_b64_tr_b16 v[50:51], v12 offset:29696
    v_mfma_f32_32x32x16_bf16 v[144:159], v[72:75], v[64:67], v[144:159]
    ds_read_b64_tr_b16 v[52:53], v13 offset:28672
    ds_read_b64_tr_b16 v[54:55], v13 offset:29696
    v_mfma_f32_32x32x16_bf16 v[160:175], v[72:75], v[68:71], v[160:175]
    s_add_u32 m0, s71, 65536
    s_nop 0
    buffer_load_dwordx4 v4, s[48:51], s66 offen lds
    s_add_u32 s66, s66, s68
    s_add_u32 m0, s71, 73728
    s_nop 0
    buffer_load_dwordx4 v20, s[12:15], s81 offen lds
    s_add_u32 s81, s81, s63
    v_mfma_f32_32x32x16_bf16 v[176:191], v[76:79], v[64:67], v[176:191]
    v_mfma_f32_32x32x16_bf16 v[192:207], v[76:79], v[68:71], v[192:207]
    s_waitcnt vmcnt(8)
    s_barrier
    s_waitcnt lgkmcnt(10)
    v_mfma_f32_32x32x16_bf16 v[80:95], v[208:211], v[216:219], v[80:95]
    ds_read_b64_tr_b16 v[56:57], v12 offset:49152
    ds_read_b64_tr_b16 v[58:59], v12 offset:50176
    v_mfma_f32_32x32x16_bf16 v[96:111], v[208:211], v[220:223], v[96:111]
    ds_read_b64_tr_b16 v[60:61], v13 offset:49152
    ds_read_b64_tr_b16 v[62:63], v13 offset:50176
    v_mfma_f32_32x32x16_bf16 v[112:127], v[212:215], v[216:219], v[112:127]
    ds_read_b128 v[64:67], v8 offset:32768
    ds_read_b128 v[68:71], v8 offset:34816
    v_mfma_f32_32x32x16_bf16 v[128:143], v[212:215], v[220:223], v[128:143]
    ds_read_b64_tr_b16 v[72:73], v12 offset:57344
    ds_read_b64_tr_b16 v[74:75], v12 offset:58368
    v_mfma_f32_32x32x16_bf16 v[144:159], v[224:227], v[216:219], v[144:159]
    ds_read_b64_tr_b16 v[76:77], v13 offset:57344
    ds_read_b64_tr_b16 v[78:79], v13 offset:58368
    v_mfma_f32_32x32x16_bf16 v[160:175], v[224:227], v[220:223], v[160:175]
    s_add_u32 m0, s74, 16384
    s_nop 0
    buffer_load_dwordx4 v3, s[44:47], s65 offen lds
    s_add_u32 m0, s74, 16384
    s_nop 0
    buffer_load_dwordx4 v3, s[44:47], s65 offen offset:1024 lds
    s_add_u32 s65, s65, 131072
    v_mfma_f32_32x32x16_bf16 v[176:191], v[228:231], v[216:219], v[176:191]
    v_mfma_f32_32x32x16_bf16 v[192:207], v[228:231], v[220:223], v[192:207]
    s_waitcnt lgkmcnt(10)
    v_mfma_f32_32x32x16_bf16 v[80:95], v[32:35], v[40:43], v[80:95]
    ds_read_b64_tr_b16 v[208:209], v12 offset:53248
    ds_read_b64_tr_b16 v[210:211], v12 offset:54272
    v_mfma_f32_32x32x16_bf16 v[96:111], v[32:35], v[44:47], v[96:111]
    ds_read_b64_tr_b16 v[212:213], v13 offset:53248
    ds_read_b64_tr_b16 v[214:215], v13 offset:54272
    v_mfma_f32_32x32x16_bf16 v[112:127], v[36:39], v[40:43], v[112:127]
    ds_read_b128 v[216:219], v9 offset:32768
    ds_read_b128 v[220:223], v9 offset:34816
    v_mfma_f32_32x32x16_bf16 v[128:143], v[36:39], v[44:47], v[128:143]
    ds_read_b64_tr_b16 v[224:225], v12 offset:61440
    ds_read_b64_tr_b16 v[226:227], v12 offset:62464
    v_mfma_f32_32x32x16_bf16 v[144:159], v[48:51], v[40:43], v[144:159]
    ds_read_b64_tr_b16 v[228:229], v13 offset:61440
    ds_read_b64_tr_b16 v[230:231], v13 offset:62464
    v_mfma_f32_32x32x16_bf16 v[160:175], v[48:51], v[44:47], v[160:175]
    s_add_u32 m0, s71, 32768
    s_nop 0
    buffer_load_dwordx4 v4, s[48:51], s66 offen lds
    s_add_u32 s66, s66, s68
    s_add_u32 m0, s71, 40960
    s_nop 0
    buffer_load_dwordx4 v20, s[12:15], s81 offen lds
    s_add_u32 s81, s81, s63
    v_mfma_f32_32x32x16_bf16 v[176:191], v[52:55], v[40:43], v[176:191]
    v_mfma_f32_32x32x16_bf16 v[192:207], v[52:55], v[44:47], v[192:207]
    s_waitcnt vmcnt(8)
    s_barrier
    s_waitcnt lgkmcnt(10)
    v_mfma_f32_32x32x16_bf16 v[80:95], v[56:59], v[64:67], v[80:95]
    ds_read_b64_tr_b16 v[32:33], v30 offset:16384
    ds_read_b64_tr_b16 v[34:35], v30 offset:17408
    v_mfma_f32_32x32x16_bf16 v[96:111], v[56:59], v[68:71], v[96:111]
    ds_read_b64_tr_b16 v[36:37], v31 offset:16384
    ds_read_b64_tr_b16 v[38:39], v31 offset:17408
    v_mfma_f32_32x32x16_bf16 v[112:127], v[60:63], v[64:67], v[112:127]
    ds_read_b128 v[40:43], v28 offset:0
    ds_read_b128 v[44:47], v28 offset:2048
    v_mfma_f32_32x32x16_bf16 v[128:143], v[60:63], v[68:71], v[128:143]
    ds_read_b64_tr_b16 v[48:49], v30 offset:24576
    ds_read_b64_tr_b16 v[50:51], v30 offset:25600
    v_mfma_f32_32x32x16_bf16 v[144:159], v[72:75], v[64:67], v[144:159]
    ds_read_b64_tr_b16 v[52:53], v31 offset:24576
    ds_read_b64_tr_b16 v[54:55], v31 offset:25600
    v_mfma_f32_32x32x16_bf16 v[160:175], v[72:75], v[68:71], v[160:175]
    s_add_u32 m0, s74, 49152
    s_nop 0
    buffer_load_dwordx4 v3, s[44:47], s65 offen lds
    s_add_u32 m0, s74, 49152
    s_nop 0
    buffer_load_dwordx4 v3, s[44:47], s65 offen offset:1024 lds
    s_add_u32 s65, s65, 131072
    v_mfma_f32_32x32x16_bf16 v[176:191], v[76:79], v[64:67], v[176:191]
    v_mfma_f32_32x32x16_bf16 v[192:207], v[76:79], v[68:71], v[192:207]
    s_waitcnt lgkmcnt(10)
    v_mfma_f32_32x32x16_bf16 v[80:95], v[208:211], v[216:219], v[80:95]
    ds_read_b64_tr_b16 v[56:57], v30 offset:20480
    ds_read_b64_tr_b16 v[58:59], v30 offset:21504
    v_mfma_f32_32x32x16_bf16 v[96:111], v[208:211], v[220:223], v[96:111]
    ds_read_b64_tr_b16 v[60:61], v31 offset:20480
    ds_read_b64_tr_b16 v[62:63], v31 offset:21504
    v_mfma_f32_32x32x16_bf16 v[112:127], v[212:215], v[216:219], v[112:127]
    ds_read_b128 v[64:67], v29 offset:0
    ds_read_b128 v[68:71], v29 offset:2048
    v_mfma_f32_32x32x16_bf16 v[128:143], v[212:215], v[220:223], v[128:143]
    ds_read_b64_tr_b16 v[72:73], v30 offset:28672
    ds_read_b64_tr_b16 v[74:75], v30 offset:29696
    v_mfma_f32_32x32x16_bf16 v[144:159], v[224:227], v[216:219], v[144:159]
    ds_read_b64_tr_b16 v[76:77], v31 offset:28672
    ds_read_b64_tr_b16 v[78:79], v31 offset:29696
    v_mfma_f32_32x32x16_bf16 v[160:175], v[224:227], v[220:223], v[160:175]
    s_add_u32 m0, s71, 81920
    s_nop 0
    buffer_load_dwordx4 v4, s[48:51], s66 offen lds
    s_add_u32 s66, s66, s68
    s_add_u32 m0, s71, 90112
    s_nop 0
    buffer_load_dwordx4 v20, s[12:15], s81 offen lds
    s_add_u32 s81, s81, s63
    v_mfma_f32_32x32x16_bf16 v[176:191], v[228:231], v[216:219], v[176:191]
    v_mfma_f32_32x32x16_bf16 v[192:207], v[228:231], v[220:223], v[192:207]
    s_waitcnt vmcnt(8)
    s_barrier
    s_waitcnt lgkmcnt(10)
    v_mfma_f32_32x32x16_bf16 v[80:95], v[32:35], v[40:43], v[80:95]
    ds_read_b64_tr_b16 v[208:209], v12 offset:0
    ds_read_b64_tr_b16 v[210:211], v12 offset:1024
    v_mfma_f32_32x32x16_bf16 v[96:111], v[32:35], v[44:47], v[96:111]
    ds_read_b64_tr_b16 v[212:213], v13 offset:0
    ds_read_b64_tr_b16 v[214:215], v13 offset:1024
    v_mfma_f32_32x32x16_bf16 v[112:127], v[36:39], v[40:43], v[112:127]
    ds_read_b128 v[216:219], v6 offset:0
    ds_read_b128 v[220:223], v6 offset:2048
    v_mfma_f32_32x32x16_bf16 v[128:143], v[36:39], v[44:47], v[128:143]
    ds_read_b64_tr_b16 v[224:225], v12 offset:8192
    ds_read_b64_tr_b16 v[226:227], v12 offset:9216
    v_mfma_f32_32x32x16_bf16 v[144:159], v[48:51], v[40:43], v[144:159]
    ds_read_b64_tr_b16 v[228:229], v13 offset:8192
    ds_read_b64_tr_b16 v[230:231], v13 offset:9216
    v_mfma_f32_32x32x16_bf16 v[160:175], v[48:51], v[44:47], v[160:175]
    v_mfma_f32_32x32x16_bf16 v[176:191], v[52:55], v[40:43], v[176:191]
    v_mfma_f32_32x32x16_bf16 v[192:207], v[52:55], v[44:47], v[192:207]
    s_waitcnt lgkmcnt(10)
    v_mfma_f32_32x32x16_bf16 v[80:95], v[56:59], v[64:67], v[80:95]
    ds_read_b64_tr_b16 v[32:33], v12 offset:4096
    ds_read_b64_tr_b16 v[34:35], v12 offset:5120
    v_mfma_f32_32x32x16_bf16 v[96:111], v[56:59], v[68:71], v[96:111]
    ds_read_b64_tr_b16 v[36:37], v13 offset:4096
    ds_read_b64_tr_b16 v[38:39], v13 offset:5120
    v_mfma_f32_32x32x16_bf16 v[112:127], v[60:63], v[64:67], v[112:127]
    ds_read_b128 v[40:43], v7 offset:0
    ds_read_b128 v[44:47], v7 offset:2048
    v_mfma_f32_32x32x16_bf16 v[128:143], v[60:63], v[68:71], v[128:143]
    ds_read_b64_tr_b16 v[48:49], v12 offset:12288
    ds_read_b64_tr_b16 v[50:51], v12 offset:13312
    v_mfma_f32_32x32x16_bf16 v[144:159], v[72:75], v[64:67], v[144:159]
    ds_read_b64_tr_b16 v[52:53], v13 offset:12288
    ds_read_b64_tr_b16 v[54:55], v13 offset:13312
    v_mfma_f32_32x32x16_bf16 v[160:175], v[72:75], v[68:71], v[160:175]
    v_mfma_f32_32x32x16_bf16 v[176:191], v[76:79], v[64:67], v[176:191]
    v_mfma_f32_32x32x16_bf16 v[192:207], v[76:79], v[68:71], v[192:207]
    s_waitcnt vmcnt(4)
    s_barrier
    s_waitcnt lgkmcnt(10)
    v_mfma_f32_32x32x16_bf16 v[80:95], v[208:211], v[216:219], v[80:95]
    ds_read_b64_tr_b16 v[56:57], v10 offset:32768
    ds_read_b64_tr_b16 v[58:59], v10 offset:33792
    v_mfma_f32_32x32x16_bf16 v[96:111], v[208:211], v[220:223], v[96:111]
    ds_read_b64_tr_b16 v[60:61], v11 offset:32768
    ds_read_b64_tr_b16 v[62:63], v11 offset:33792
    v_mfma_f32_32x32x16_bf16 v[112:127], v[212:215], v[216:219], v[112:127]
    ds_read_b128 v[64:67], v6 offset:16384
    ds_read_b128 v[68:71], v6 offset:18432
    v_mfma_f32_32x32x16_bf16 v[128:143], v[212:215], v[220:223], v[128:143]
    ds_read_b64_tr_b16 v[72:73], v10 offset:40960
    ds_read_b64_tr_b16 v[74:75], v10 offset:41984
    v_mfma_f32_32x32x16_bf16 v[144:159], v[224:227], v[216:219], v[144:159]
    ds_read_b64_tr_b16 v[76:77], v11 offset:40960
    ds_read_b64_tr_b16 v[78:79], v11 offset:41984
    v_mfma_f32_32x32x16_bf16 v[160:175], v[224:227], v[220:223], v[160:175]
    v_mfma_f32_32x32x16_bf16 v[176:191], v[228:231], v[216:219], v[176:191]
    v_mfma_f32_32x32x16_bf16 v[192:207], v[228:231], v[220:223], v[192:207]
    s_waitcnt lgkmcnt(10)
    v_mfma_f32_32x32x16_bf16 v[80:95], v[32:35], v[40:43], v[80:95]
    ds_read_b64_tr_b16 v[208:209], v10 offset:36864
    ds_read_b64_tr_b16 v[210:211], v10 offset:37888
    v_mfma_f32_32x32x16_bf16 v[96:111], v[32:35], v[44:47], v[96:111]
    ds_read_b64_tr_b16 v[212:213], v11 offset:36864
    ds_read_b64_tr_b16 v[214:215], v11 offset:37888
    v_mfma_f32_32x32x16_bf16 v[112:127], v[36:39], v[40:43], v[112:127]
    ds_read_b128 v[216:219], v7 offset:16384
    ds_read_b128 v[220:223], v7 offset:18432
    v_mfma_f32_32x32x16_bf16 v[128:143], v[36:39], v[44:47], v[128:143]
    ds_read_b64_tr_b16 v[224:225], v10 offset:45056
    ds_read_b64_tr_b16 v[226:227], v10 offset:46080
    v_mfma_f32_32x32x16_bf16 v[144:159], v[48:51], v[40:43], v[144:159]
    ds_read_b64_tr_b16 v[228:229], v11 offset:45056
    ds_read_b64_tr_b16 v[230:231], v11 offset:46080
    v_mfma_f32_32x32x16_bf16 v[160:175], v[48:51], v[44:47], v[160:175]
    v_mfma_f32_32x32x16_bf16 v[176:191], v[52:55], v[40:43], v[176:191]
    v_mfma_f32_32x32x16_bf16 v[192:207], v[52:55], v[44:47], v[192:207]
    s_waitcnt vmcnt(0)
    s_barrier
    s_waitcnt lgkmcnt(10)
    v_mfma_f32_32x32x16_bf16 v[80:95], v[56:59], v[64:67], v[80:95]
    ds_read_b64_tr_b16 v[32:33], v12 offset:16384
    ds_read_b64_tr_b16 v[34:35], v12 offset:17408
    v_mfma_f32_32x32x16_bf16 v[96:111], v[56:59], v[68:71], v[96:111]
    ds_read_b64_tr_b16 v[36:37], v13 offset:16384
    ds_read_b64_tr_b16 v[38:39], v13 offset:17408
    v_mfma_f32_32x32x16_bf16 v[112:127], v[60:63], v[64:67], v[112:127]
    ds_read_b128 v[40:43], v6 offset:49152
    ds_read_b128 v[44:47], v6 offset:51200
    v_mfma_f32_32x32x16_bf16 v[128:143], v[60:63], v[68:71], v[128:143]
    ds_read_b64_tr_b16 v[48:49], v12 offset:24576
    ds_read_b64_tr_b16 v[50:51], v12 offset:25600
    v_mfma_f32_32x32x16_bf16 v[144:159], v[72:75], v[64:67], v[144:159]
    ds_read_b64_tr_b16 v[52:53], v13 offset:24576
    ds_read_b64_tr_b16 v[54:55], v13 offset:25600
    v_mfma_f32_32x32x16_bf16 v[160:175], v[72:75], v[68:71], v[160:175]
    s_mov_b32 m0, s82
    s_nop 0
    buffer_load_dwordx4 v244, s[56:59], s83 offen offset:0 lds
    buffer_load_dwordx4 v245, s[56:59], s83 offen offset:1024 lds
    buffer_load_dwordx4 v246, s[56:59], s83 offen offset:2048 lds
    buffer_load_dwordx4 v247, s[56:59], s83 offen offset:3072 lds
    v_mfma_f32_32x32x16_bf16 v[176:191], v[76:79], v[64:67], v[176:191]
    v_mfma_f32_32x32x16_bf16 v[192:207], v[76:79], v[68:71], v[192:207]
    s_waitcnt lgkmcnt(10)
    v_mfma_f32_32x32x16_bf16 v[80:95], v[208:211], v[216:219], v[80:95]
    ds_read_b64_tr_b16 v[56:57], v12 offset:20480
    ds_read_b64_tr_b16 v[58:59], v12 offset:21504
    v_mfma_f32_32x32x16_bf16 v[96:111], v[208:211], v[220:223], v[96:111]
    ds_read_b64_tr_b16 v[60:61], v13 offset:20480
    ds_read_b64_tr_b16 v[62:63], v13 offset:21504
    v_mfma_f32_32x32x16_bf16 v[112:127], v[212:215], v[216:219], v[112:127]
    ds_read_b128 v[64:67], v7 offset:49152
    ds_read_b128 v[68:71], v7 offset:51200
    v_mfma_f32_32x32x16_bf16 v[128:143], v[212:215], v[220:223], v[128:143]
    ds_read_b64_tr_b16 v[72:73], v12 offset:28672
    ds_read_b64_tr_b16 v[74:75], v12 offset:29696
    v_mfma_f32_32x32x16_bf16 v[144:159], v[224:227], v[216:219], v[144:159]
    ds_read_b64_tr_b16 v[76:77], v13 offset:28672
    ds_read_b64_tr_b16 v[78:79], v13 offset:29696
    v_mfma_f32_32x32x16_bf16 v[160:175], v[224:227], v[220:223], v[160:175]
    v_mfma_f32_32x32x16_bf16 v[176:191], v[228:231], v[216:219], v[176:191]
    v_mfma_f32_32x32x16_bf16 v[192:207], v[228:231], v[220:223], v[192:207]
    s_waitcnt lgkmcnt(10)
    v_mfma_f32_32x32x16_bf16 v[80:95], v[32:35], v[40:43], v[80:95]
    buffer_load_dwordx2 v[208:209], v232, s[8:11], s77 offen offset:0
    v_mfma_f32_32x32x16_bf16 v[96:111], v[32:35], v[44:47], v[96:111]
    buffer_load_dwordx2 v[210:211], v232, s[8:11], s77 offen offset:16
    v_mfma_f32_32x32x16_bf16 v[112:127], v[36:39], v[40:43], v[112:127]
    buffer_load_dwordx2 v[212:213], v232, s[8:11], s77 offen offset:32
    v_mfma_f32_32x32x16_bf16 v[128:143], v[36:39], v[44:47], v[128:143]
    buffer_load_dwordx2 v[214:215], v232, s[8:11], s77 offen offset:48
    v_mfma_f32_32x32x16_bf16 v[144:159], v[48:51], v[40:43], v[144:159]
    buffer_load_dwordx2 v[216:217], v232, s[8:11], s77 offen offset:64
    v_mfma_f32_32x32x16_bf16 v[160:175], v[48:51], v[44:47], v[160:175]
    buffer_load_dwordx2 v[218:219], v232, s[8:11], s77 offen offset:80
    v_mfma_f32_32x32x16_bf16 v[176:191], v[52:55], v[40:43], v[176:191]
    buffer_load_dwordx2 v[220:221], v232, s[8:11], s77 offen offset:96
    v_mfma_f32_32x32x16_bf16 v[192:207], v[52:55], v[44:47], v[192:207]
    buffer_load_dwordx2 v[222:223], v232, s[8:11], s77 offen offset:112
    s_waitcnt lgkmcnt(0)
    v_mfma_f32_32x32x16_bf16 v[80:95], v[56:59], v[64:67], v[80:95]
    v_mfma_f32_32x32x16_bf16 v[96:111], v[56:59], v[68:71], v[96:111]
    v_mfma_f32_32x32x16_bf16 v[112:127], v[60:63], v[64:67], v[112:127]
    v_mfma_f32_32x32x16_bf16 v[128:143], v[60:63], v[68:71], v[128:143]
    v_mfma_f32_32x32x16_bf16 v[144:159], v[72:75], v[64:67], v[144:159]
    v_mfma_f32_32x32x16_bf16 v[160:175], v[72:75], v[68:71], v[160:175]
    v_mfma_f32_32x32x16_bf16 v[176:191], v[76:79], v[64:67], v[176:191]
    v_mfma_f32_32x32x16_bf16 v[192:207], v[76:79], v[68:71], v[192:207]
    s_setprio 0
QH_JOIN:
    s_nop 15
    s_mov_b32 s76, 0x3e0293ee
    s_mov_b32 s77, 0x3e0293ee
    v_pk_mul_f32 v[80:81], v[80:81], s[76:77]
    v_pk_mul_f32 v[82:83], v[82:83], s[76:77]
    v_pk_mul_f32 v[84:85], v[84:85], s[76:77]
    v_pk_mul_f32 v[86:87], v[86:87], s[76:77]
    v_pk_mul_f32 v[88:89], v[88:89], s[76:77]
    v_pk_mul_f32 v[90:91], v[90:91], s[76:77]
    v_pk_mul_f32 v[92:93], v[92:93], s[76:77]
    v_pk_mul_f32 v[94:95], v[94:95], s[76:77]
    v_cvt_pk_bf16_f32 v80, v80, v81
    v_cvt_pk_bf16_f32 v81, v82, v83
    v_cvt_pk_bf16_f32 v82, v84, v85
    v_cvt_pk_bf16_f32 v83, v86, v87
    v_cvt_pk_bf16_f32 v84, v88, v89
    v_cvt_pk_bf16_f32 v85, v90, v91
    v_cvt_pk_bf16_f32 v86, v92, v93
    v_cvt_pk_bf16_f32 v87, v94, v95
    v_permlane32_swap_b32 v80, v82
    v_permlane32_swap_b32 v81, v83
    ds_write_b128 v252, v[80:83] offset:0
    v_permlane32_swap_b32 v84, v86
    v_permlane32_swap_b32 v85, v87
    ds_write_b128 v253, v[84:87] offset:0
    v_pk_mul_f32 v[112:113], v[112:113], s[76:77]
    v_pk_mul_f32 v[114:115], v[114:115], s[76:77]
    v_pk_mul_f32 v[116:117], v[116:117], s[76:77]
    v_pk_mul_f32 v[118:119], v[118:119], s[76:77]
    v_pk_mul_f32 v[120:121], v[120:121], s[76:77]
    v_pk_mul_f32 v[122:123], v[122:123], s[76:77]
    v_pk_mul_f32 v[124:125], v[124:125], s[76:77]
    v_pk_mul_f32 v[126:127], v[126:127], s[76:77]
    v_cvt_pk_bf16_f32 v112, v112, v113
    v_cvt_pk_bf16_f32 v113, v114, v115
    v_cvt_pk_bf16_f32 v114, v116, v117
    v_cvt_pk_bf16_f32 v115, v118, v119
    v_cvt_pk_bf16_f32 v116, v120, v121
    v_cvt_pk_bf16_f32 v117, v122, v123
    v_cvt_pk_bf16_f32 v118, v124, v125
    v_cvt_pk_bf16_f32 v119, v126, v127
    v_permlane32_swap_b32 v112, v114
    v_permlane32_swap_b32 v113, v115
    ds_write_b128 v254, v[112:115] offset:0
    v_permlane32_swap_b32 v116, v118
    v_permlane32_swap_b32 v117, v119
    ds_write_b128 v255, v[116:119] offset:0
    v_pk_mul_f32 v[96:97], v[96:97], s[76:77]
    v_pk_mul_f32 v[98:99], v[98:99], s[76:77]
    v_pk_mul_f32 v[100:101], v[100:101], s[76:77]
    v_pk_mul_f32 v[102:103], v[102:103], s[76:77]
    v_pk_mul_f32 v[104:105], v[104:105], s[76:77]
    v_pk_mul_f32 v[106:107], v[106:107], s[76:77]
    v_pk_mul_f32 v[108:109], v[108:109], s[76:77]
    v_pk_mul_f32 v[110:111], v[110:111], s[76:77]
    v_cvt_pk_bf16_f32 v96, v96, v97
    v_cvt_pk_bf16_f32 v97, v98, v99
    v_cvt_pk_bf16_f32 v98, v100, v101
    v_cvt_pk_bf16_f32 v99, v102, v103
    v_cvt_pk_bf16_f32 v100, v104, v105
    v_cvt_pk_bf16_f32 v101, v106, v107
    v_cvt_pk_bf16_f32 v102, v108, v109
    v_cvt_pk_bf16_f32 v103, v110, v111
    v_permlane32_swap_b32 v96, v98
    v_permlane32_swap_b32 v97, v99
    ds_write_b128 v252, v[96:99] offset:8192
    v_permlane32_swap_b32 v100, v102
    v_permlane32_swap_b32 v101, v103
    ds_write_b128 v253, v[100:103] offset:8192
    v_pk_mul_f32 v[128:129], v[128:129], s[76:77]
    v_pk_mul_f32 v[130:131], v[130:131], s[76:77]
    v_pk_mul_f32 v[132:133], v[132:133], s[76:77]
    v_pk_mul_f32 v[134:135], v[134:135], s[76:77]
    v_pk_mul_f32 v[136:137], v[136:137], s[76:77]
    v_pk_mul_f32 v[138:139], v[138:139], s[76:77]
    v_pk_mul_f32 v[140:141], v[140:141], s[76:77]
    v_pk_mul_f32 v[142:143], v[142:143], s[76:77]
    v_cvt_pk_bf16_f32 v128, v128, v129
    v_cvt_pk_bf16_f32 v129, v130, v131
    v_cvt_pk_bf16_f32 v130, v132, v133
    v_cvt_pk_bf16_f32 v131, v134, v135
    v_cvt_pk_bf16_f32 v132, v136, v137
    v_cvt_pk_bf16_f32 v133, v138, v139
    v_cvt_pk_bf16_f32 v134, v140, v141
    v_cvt_pk_bf16_f32 v135, v142, v143
    v_permlane32_swap_b32 v128, v130
    v_permlane32_swap_b32 v129, v131
    ds_write_b128 v254, v[128:131] offset:8192
    v_permlane32_swap_b32 v132, v134
    v_permlane32_swap_b32 v133, v135
    ds_write_b128 v255, v[132:135] offset:8192
    s_waitcnt lgkmcnt(0)
    s_barrier
    ds_read_b128 v[32:35], v248 offset:0
    ds_read_b128 v[36:39], v249 offset:0
    ds_read_b128 v[40:43], v250 offset:0
    ds_read_b128 v[44:47], v251 offset:0
    ds_read_b128 v[48:51], v248 offset:4096
    ds_read_b128 v[52:55], v249 offset:4096
    ds_read_b128 v[56:59], v250 offset:4096
    ds_read_b128 v[60:63], v251 offset:4096
    s_lshr_b32 s65, s64, 2
    s_and_b32 s66, s64, 3
    s_and_b32 s3, s2, 7
    s_lshr_b32 s4, s2, 3
    s_and_b32 s5, s4, 3
    s_lshl_b32 s67, s3, 2
    s_add_u32 s67, s67, s5
    s_lshr_b32 s68, s4, 2
    s_add_u32 s48, s42, 0x2000000
    s_addc_u32 s49, s43, 0
    s_and_b32 s49, s49, 0xffff
    s_mov_b32 s50, 0x1000000
    s_mov_b32 s51, 0x20000
    s_add_u32 s52, s42, 0x3000000
    s_addc_u32 s53, s43, 0
    s_and_b32 s53, s53, 0xffff
    s_mov_b32 s54, 0x1000000
    s_mov_b32 s55, 0x20000
    s_add_u32 s56, s42, 0x4000000
    s_addc_u32 s57, s43, 0
    s_and_b32 s57, s57, 0xffff
    s_mov_b32 s58, 0x1700000
    s_mov_b32 s59, 0x20000
    v_mov_b32 v2, v244
    v_mov_b32 v3, v245
    v_mov_b32 v4, v246
    v_mov_b32 v5, v247
    v_mov_b32 v6, v233
    v_mov_b32 v30, v235
    v_mov_b32 v246, v236
    v_mov_b32 v7, v237
    v_xor_b32 v244, 64, v242
    v_xor_b32 v245, 96, v242
    v_mov_b32 v29, 0xf149f2ca
    v_mov_b32 v247, 0
    v_xor_b32 v8, 0, v27
    v_xor_b32 v9, 32, v27
    v_xor_b32 v10, 64, v27
    v_xor_b32 v11, 96, v27
    v_xor_b32 v12, 128, v27
    v_xor_b32 v13, 160, v27
    s_sub_u32 s69, 15, s68
    s_mov_b32 s82, 0
    s_lshl_b32 s75, s67, 19
    s_lshl_b32 s72, s65, 14
    s_add_u32 s75, s75, s72
    s_sub_u32 s71, s75, 32768
    s_lshl_b32 s80, s65, 16
    s_lshl_b32 s72, s66, 12
    s_add_u32 s80, s80, s72
    s_add_u32 s81, s80, 32768
    s_xor_b32 s80, s80, 16384
    s_mov_b32 s74, s75
    s_waitcnt vmcnt(0)
    s_lshl_b32 s72, s65, 1
    s_add_u32 s84, s66, 1
    s_sub_i32 s84, s84, s72
    s_max_i32 s84, s84, 0
    s_min_i32 s84, s84, 2
K3_PASS:
    s_sub_u32 s85, s69, 1
    s_cmp_eq_u32 s84, 2
    s_cselect_b32 s85, -1, s85
    s_mov_b32 s71, s75
    v_mov_b32 v20, 0
    v_mov_b32 v21, 0
    s_mov_b32 s70, 0
    s_waitcnt lgkmcnt(0)
    s_cmp_eq_u32 s65, 1
    s_cbranch_scc0 K3_NOSTAG
    s_barrier
    s_cmp_eq_u32 s62, 1
    s_cbranch_scc0 K3_NOSTAG
    s_mov_b32 s62, 0
    v_add_u32 v224, 0x10000, v242
    v_add_u32 v225, 0x10000, v243
    v_add_u32 v226, 0x10000, v244
    v_add_u32 v227, 0x10000, v245
    v_add_u32 v228, 0x10000, v246
    v_lshlrev_b32 v64, 16, v208
    v_and_b32 v65, 0xffff0000, v208
    v_lshlrev_b32 v66, 16, v209
    v_and_b32 v67, 0xffff0000, v209
    v_lshlrev_b32 v68, 16, v210
    v_and_b32 v69, 0xffff0000, v210
    v_lshlrev_b32 v70, 16, v211
    v_and_b32 v71, 0xffff0000, v211
    v_lshlrev_b32 v72, 16, v212
    v_and_b32 v73, 0xffff0000, v212
    v_lshlrev_b32 v74, 16, v213
    v_and_b32 v75, 0xffff0000, v213
    v_lshlrev_b32 v76, 16, v214
    v_and_b32 v77, 0xffff0000, v214
    v_lshlrev_b32 v78, 16, v215
    v_and_b32 v79, 0xffff0000, v215
    v_lshlrev_b32 v80, 16, v216
    v_and_b32 v81, 0xffff0000, v216
    v_lshlrev_b32 v82, 16, v217
    v_and_b32 v83, 0xffff0000, v217
    v_lshlrev_b32 v84, 16, v218
    v_and_b32 v85, 0xffff0000, v218
    v_lshlrev_b32 v86, 16, v219
    v_and_b32 v87, 0xffff0000, v219
    v_lshlrev_b32 v88, 16, v220
    v_and_b32 v89, 0xffff0000, v220
    v_lshlrev_b32 v90, 16, v221
    v_and_b32 v91, 0xffff0000, v221
    v_lshlrev_b32 v92, 16, v222
    v_and_b32 v93, 0xffff0000, v222
    v_lshlrev_b32 v94, 16, v223
    v_and_b32 v95, 0xffff0000, v223
    v_cvt_pk_bf16_f32 v112, v144, v145
    v_cvt_pk_bf16_f32 v114, v146, v147
    v_cvt_pk_bf16_f32 v116, v148, v149
    v_cvt_pk_bf16_f32 v118, v150, v151
    v_and_b32 v113, 0xffff0000, v112
    v_and_b32 v115, 0xffff0000, v114
    v_and_b32 v117, 0xffff0000, v116
    v_and_b32 v119, 0xffff0000, v118
    v_lshlrev_b32 v112, 16, v112
    v_lshlrev_b32 v114, 16, v114
    v_lshlrev_b32 v116, 16, v116
    v_lshlrev_b32 v118, 16, v118
    v_pk_add_f32 v[112:113], v[112:113], v[64:65]
    v_pk_add_f32 v[114:115], v[114:115], v[66:67]
    v_pk_add_f32 v[116:117], v[116:117], v[68:69]
    v_pk_add_f32 v[118:119], v[118:119], v[70:71]
    v_cvt_pk_bf16_f32 v112, v112, v113
    v_cvt_pk_bf16_f32 v114, v114, v115
    v_cvt_pk_bf16_f32 v116, v116, v117
    v_cvt_pk_bf16_f32 v118, v118, v119
    v_pk_max_i16 v112, v112, 0
    v_pk_max_i16 v114, v114, 0
    v_pk_max_i16 v116, v116, 0
    v_pk_max_i16 v118, v118, 0
    v_and_b32 v113, 0xffff0000, v112
    v_and_b32 v115, 0xffff0000, v114
    v_and_b32 v117, 0xffff0000, v116
    v_and_b32 v119, 0xffff0000, v118
    v_lshlrev_b32 v112, 16, v112
    v_lshlrev_b32 v114, 16, v114
    v_lshlrev_b32 v116, 16, v116
    v_lshlrev_b32 v118, 16, v118
    v_pk_mul_f32 v[112:113], v[112:113], v[112:113]
    v_pk_mul_f32 v[114:115], v[114:115], v[114:115]
    v_pk_mul_f32 v[116:117], v[116:117], v[116:117]
    v_pk_mul_f32 v[118:119], v[118:119], v[118:119]
    v_cvt_pk_bf16_f32 v144, v112, v113
    v_cvt_pk_bf16_f32 v145, v114, v115
    v_cvt_pk_bf16_f32 v146, v116, v117
    v_cvt_pk_bf16_f32 v147, v118, v119
    v_cvt_pk_bf16_f32 v112, v152, v153
    v_cvt_pk_bf16_f32 v114, v154, v155
    v_cvt_pk_bf16_f32 v116, v156, v157
    v_cvt_pk_bf16_f32 v118, v158, v159
    v_and_b32 v113, 0xffff0000, v112
    v_and_b32 v115, 0xffff0000, v114
    v_and_b32 v117, 0xffff0000, v116
    v_and_b32 v119, 0xffff0000, v118
    v_lshlrev_b32 v112, 16, v112
    v_lshlrev_b32 v114, 16, v114
    v_lshlrev_b32 v116, 16, v116
    v_lshlrev_b32 v118, 16, v118
    v_pk_add_f32 v[112:113], v[112:113], v[72:73]
    v_pk_add_f32 v[114:115], v[114:115], v[74:75]
    v_pk_add_f32 v[116:117], v[116:117], v[76:77]
    v_pk_add_f32 v[118:119], v[118:119], v[78:79]
    v_cvt_pk_bf16_f32 v112, v112, v113
    v_cvt_pk_bf16_f32 v114, v114, v115
    v_cvt_pk_bf16_f32 v116, v116, v117
    v_cvt_pk_bf16_f32 v118, v118, v119
    v_pk_max_i16 v112, v112, 0
    v_pk_max_i16 v114, v114, 0
    v_pk_max_i16 v116, v116, 0
    v_pk_max_i16 v118, v118, 0
    v_and_b32 v113, 0xffff0000, v112
    v_and_b32 v115, 0xffff0000, v114
    v_and_b32 v117, 0xffff0000, v116
    v_and_b32 v119, 0xffff0000, v118
    v_lshlrev_b32 v112, 16, v112
    v_lshlrev_b32 v114, 16, v114
    v_lshlrev_b32 v116, 16, v116
    v_lshlrev_b32 v118, 16, v118
    v_pk_mul_f32 v[112:113], v[112:113], v[112:113]
    v_pk_mul_f32 v[114:115], v[114:115], v[114:115]
    v_pk_mul_f32 v[116:117], v[116:117], v[116:117]
    v_pk_mul_f32 v[118:119], v[118:119], v[118:119]
    v_cvt_pk_bf16_f32 v148, v112, v113
    v_cvt_pk_bf16_f32 v149, v114, v115
    v_cvt_pk_bf16_f32 v150, v116, v117
    v_cvt_pk_bf16_f32 v151, v118, v119
    v_permlane32_swap_b32 v144, v146
    v_permlane32_swap_b32 v145, v147
    ds_write_b128 v224, v[144:147] offset:0
    v_permlane32_swap_b32 v148, v150
    v_permlane32_swap_b32 v149, v151
    ds_write_b128 v225, v[148:151] offset:0
    v_cvt_pk_bf16_f32 v112, v176, v177
    v_cvt_pk_bf16_f32 v114, v178, v179
    v_cvt_pk_bf16_f32 v116, v180, v181
    v_cvt_pk_bf16_f32 v118, v182, v183
    v_and_b32 v113, 0xffff0000, v112
    v_and_b32 v115, 0xffff0000, v114
    v_and_b32 v117, 0xffff0000, v116
    v_and_b32 v119, 0xffff0000, v118
    v_lshlrev_b32 v112, 16, v112
    v_lshlrev_b32 v114, 16, v114
    v_lshlrev_b32 v116, 16, v116
    v_lshlrev_b32 v118, 16, v118
    v_pk_add_f32 v[112:113], v[112:113], v[80:81]
    v_pk_add_f32 v[114:115], v[114:115], v[82:83]
    v_pk_add_f32 v[116:117], v[116:117], v[84:85]
    v_pk_add_f32 v[118:119], v[118:119], v[86:87]
    v_cvt_pk_bf16_f32 v112, v112, v113
    v_cvt_pk_bf16_f32 v114, v114, v115
    v_cvt_pk_bf16_f32 v116, v116, v117
    v_cvt_pk_bf16_f32 v118, v118, v119
    v_pk_max_i16 v112, v112, 0
    v_pk_max_i16 v114, v114, 0
    v_pk_max_i16 v116, v116, 0
    v_pk_max_i16 v118, v118, 0
    v_and_b32 v113, 0xffff0000, v112
    v_and_b32 v115, 0xffff0000, v114
    v_and_b32 v117, 0xffff0000, v116
    v_and_b32 v119, 0xffff0000, v118
    v_lshlrev_b32 v112, 16, v112
    v_lshlrev_b32 v114, 16, v114
    v_lshlrev_b32 v116, 16, v116
    v_lshlrev_b32 v118, 16, v118
    v_pk_mul_f32 v[112:113], v[112:113], v[112:113]
    v_pk_mul_f32 v[114:115], v[114:115], v[114:115]
    v_pk_mul_f32 v[116:117], v[116:117], v[116:117]
    v_pk_mul_f32 v[118:119], v[118:119], v[118:119]
    v_cvt_pk_bf16_f32 v176, v112, v113
    v_cvt_pk_bf16_f32 v177, v114, v115
    v_cvt_pk_bf16_f32 v178, v116, v117
    v_cvt_pk_bf16_f32 v179, v118, v119
    v_cvt_pk_bf16_f32 v112, v184, v185
    v_cvt_pk_bf16_f32 v114, v186, v187
    v_cvt_pk_bf16_f32 v116, v188, v189
    v_cvt_pk_bf16_f32 v118, v190, v191
    v_and_b32 v113, 0xffff0000, v112
    v_and_b32 v115, 0xffff0000, v114
    v_and_b32 v117, 0xffff0000, v116
    v_and_b32 v119, 0xffff0000, v118
    v_lshlrev_b32 v112, 16, v112
    v_lshlrev_b32 v114, 16, v114
    v_lshlrev_b32 v116, 16, v116
    v_lshlrev_b32 v118, 16, v118
    v_pk_add_f32 v[112:113], v[112:113], v[88:89]
    v_pk_add_f32 v[114:115], v[114:115], v[90:91]
    v_pk_add_f32 v[116:117], v[116:117], v[92:93]
    v_pk_add_f32 v[118:119], v[118:119], v[94:95]
    v_cvt_pk_bf16_f32 v112, v112, v113
    v_cvt_pk_bf16_f32 v114, v114, v115
    v_cvt_pk_bf16_f32 v116, v116, v117
    v_cvt_pk_bf16_f32 v118, v118, v119
    v_pk_max_i16 v112, v112, 0
    v_pk_max_i16 v114, v114, 0
    v_pk_max_i16 v116, v116, 0
    v_pk_max_i16 v118, v118, 0
    v_and_b32 v113, 0xffff0000, v112
    v_and_b32 v115, 0xffff0000, v114
    v_and_b32 v117, 0xffff0000, v116
    v_and_b32 v119, 0xffff0000, v118
    v_lshlrev_b32 v112, 16, v112
    v_lshlrev_b32 v114, 16, v114
    v_lshlrev_b32 v116, 16, v116
    v_lshlrev_b32 v118, 16, v118
    v_pk_mul_f32 v[112:113], v[112:113], v[112:113]
    v_pk_mul_f32 v[114:115], v[114:115], v[114:115]
    v_pk_mul_f32 v[116:117], v[116:117], v[116:117]
    v_pk_mul_f32 v[118:119], v[118:119], v[118:119]
    v_cvt_pk_bf16_f32 v180, v112, v113
    v_cvt_pk_bf16_f32 v181, v114, v115
    v_cvt_pk_bf16_f32 v182, v116, v117
    v_cvt_pk_bf16_f32 v183, v118, v119
    v_permlane32_swap_b32 v176, v178
    v_permlane32_swap_b32 v177, v179
    ds_write_b128 v226, v[176:179] offset:0
    v_permlane32_swap_b32 v180, v182
    v_permlane32_swap_b32 v181, v183
    ds_write_b128 v227, v[180:183] offset:0
    ds_read_b128 v[128:131], v228 offset:0
    ds_read_b128 v[132:135], v228 offset:1024
    ds_read_b128 v[136:139], v228 offset:2048
    ds_read_b128 v[140:143], v228 offset:3072
    v_cvt_pk_bf16_f32 v112, v160, v161
    v_cvt_pk_bf16_f32 v114, v162, v163
    v_cvt_pk_bf16_f32 v116, v164, v165
    v_cvt_pk_bf16_f32 v118, v166, v167
    v_and_b32 v113, 0xffff0000, v112
    v_and_b32 v115, 0xffff0000, v114
    v_and_b32 v117, 0xffff0000, v116
    v_and_b32 v119, 0xffff0000, v118
    v_lshlrev_b32 v112, 16, v112
    v_lshlrev_b32 v114, 16, v114
    v_lshlrev_b32 v116, 16, v116
    v_lshlrev_b32 v118, 16, v118
    v_pk_add_f32 v[112:113], v[112:113], v[64:65]
    v_pk_add_f32 v[114:115], v[114:115], v[66:67]
    v_pk_add_f32 v[116:117], v[116:117], v[68:69]
    v_pk_add_f32 v[118:119], v[118:119], v[70:71]
    v_cvt_pk_bf16_f32 v112, v112, v113
    v_cvt_pk_bf16_f32 v114, v114, v115
    v_cvt_pk_bf16_f32 v116, v116, v117
    v_cvt_pk_bf16_f32 v118, v118, v119
    v_pk_max_i16 v112, v112, 0
    v_pk_max_i16 v114, v114, 0
    v_pk_max_i16 v116, v116, 0
    v_pk_max_i16 v118, v118, 0
    v_and_b32 v113, 0xffff0000, v112
    v_and_b32 v115, 0xffff0000, v114
    v_and_b32 v117, 0xffff0000, v116
    v_and_b32 v119, 0xffff0000, v118
    v_lshlrev_b32 v112, 16, v112
    v_lshlrev_b32 v114, 16, v114
    v_lshlrev_b32 v116, 16, v116
    v_lshlrev_b32 v118, 16, v118
    v_pk_mul_f32 v[112:113], v[112:113], v[112:113]
    v_pk_mul_f32 v[114:115], v[114:115], v[114:115]
    v_pk_mul_f32 v[116:117], v[116:117], v[116:117]
    v_pk_mul_f32 v[118:119], v[118:119], v[118:119]
    v_cvt_pk_bf16_f32 v160, v112, v113
    v_cvt_pk_bf16_f32 v161, v114, v115
    v_cvt_pk_bf16_f32 v162, v116, v117
    v_cvt_pk_bf16_f32 v163, v118, v119
    v_cvt_pk_bf16_f32 v112, v168, v169
    v_cvt_pk_bf16_f32 v114, v170, v171
    v_cvt_pk_bf16_f32 v116, v172, v173
    v_cvt_pk_bf16_f32 v118, v174, v175
    v_and_b32 v113, 0xffff0000, v112
    v_and_b32 v115, 0xffff0000, v114
    v_and_b32 v117, 0xffff0000, v116
    v_and_b32 v119, 0xffff0000, v118
    v_lshlrev_b32 v112, 16, v112
    v_lshlrev_b32 v114, 16, v114
    v_lshlrev_b32 v116, 16, v116
    v_lshlrev_b32 v118, 16, v118
    v_pk_add_f32 v[112:113], v[112:113], v[72:73]
    v_pk_add_f32 v[114:115], v[114:115], v[74:75]
    v_pk_add_f32 v[116:117], v[116:117], v[76:77]
    v_pk_add_f32 v[118:119], v[118:119], v[78:79]
    v_cvt_pk_bf16_f32 v112, v112, v113
    v_cvt_pk_bf16_f32 v114, v114, v115
    v_cvt_pk_bf16_f32 v116, v116, v117
    v_cvt_pk_bf16_f32 v118, v118, v119
    v_pk_max_i16 v112, v112, 0
    v_pk_max_i16 v114, v114, 0
    v_pk_max_i16 v116, v116, 0
    v_pk_max_i16 v118, v118, 0
    v_and_b32 v113, 0xffff0000, v112
    v_and_b32 v115, 0xffff0000, v114
    v_and_b32 v117, 0xffff0000, v116
    v_and_b32 v119, 0xffff0000, v118
    v_lshlrev_b32 v112, 16, v112
    v_lshlrev_b32 v114, 16, v114
    v_lshlrev_b32 v116, 16, v116
    v_lshlrev_b32 v118, 16, v118
    v_pk_mul_f32 v[112:113], v[112:113], v[112:113]
    v_pk_mul_f32 v[114:115], v[114:115], v[114:115]
    v_pk_mul_f32 v[116:117], v[116:117], v[116:117]
    v_pk_mul_f32 v[118:119], v[118:119], v[118:119]
    v_cvt_pk_bf16_f32 v164, v112, v113
    v_cvt_pk_bf16_f32 v165, v114, v115
    v_cvt_pk_bf16_f32 v166, v116, v117
    v_cvt_pk_bf16_f32 v167, v118, v119
    v_permlane32_swap_b32 v160, v162
    v_permlane32_swap_b32 v161, v163
    ds_write_b128 v224, v[160:163] offset:4096
    v_permlane32_swap_b32 v164, v166
    v_permlane32_swap_b32 v165, v167
    ds_write_b128 v225, v[164:167] offset:4096
    v_cvt_pk_bf16_f32 v112, v192, v193
    v_cvt_pk_bf16_f32 v114, v194, v195
    v_cvt_pk_bf16_f32 v116, v196, v197
    v_cvt_pk_bf16_f32 v118, v198, v199
    v_and_b32 v113, 0xffff0000, v112
    v_and_b32 v115, 0xffff0000, v114
    v_and_b32 v117, 0xffff0000, v116
    v_and_b32 v119, 0xffff0000, v118
    v_lshlrev_b32 v112, 16, v112
    v_lshlrev_b32 v114, 16, v114
    v_lshlrev_b32 v116, 16, v116
    v_lshlrev_b32 v118, 16, v118
    v_pk_add_f32 v[112:113], v[112:113], v[80:81]
    v_pk_add_f32 v[114:115], v[114:115], v[82:83]
    v_pk_add_f32 v[116:117], v[116:117], v[84:85]
    v_pk_add_f32 v[118:119], v[118:119], v[86:87]
    v_cvt_pk_bf16_f32 v112, v112, v113
    v_cvt_pk_bf16_f32 v114, v114, v115
    v_cvt_pk_bf16_f32 v116, v116, v117
    v_cvt_pk_bf16_f32 v118, v118, v119
    v_pk_max_i16 v112, v112, 0
    v_pk_max_i16 v114, v114, 0
    v_pk_max_i16 v116, v116, 0
    v_pk_max_i16 v118, v118, 0
    v_and_b32 v113, 0xffff0000, v112
    v_and_b32 v115, 0xffff0000, v114
    v_and_b32 v117, 0xffff0000, v116
    v_and_b32 v119, 0xffff0000, v118
    v_lshlrev_b32 v112, 16, v112
    v_lshlrev_b32 v114, 16, v114
    v_lshlrev_b32 v116, 16, v116
    v_lshlrev_b32 v118, 16, v118
    v_pk_mul_f32 v[112:113], v[112:113], v[112:113]
    v_pk_mul_f32 v[114:115], v[114:115], v[114:115]
    v_pk_mul_f32 v[116:117], v[116:117], v[116:117]
    v_pk_mul_f32 v[118:119], v[118:119], v[118:119]
    v_cvt_pk_bf16_f32 v192, v112, v113
    v_cvt_pk_bf16_f32 v193, v114, v115
    v_cvt_pk_bf16_f32 v194, v116, v117
    v_cvt_pk_bf16_f32 v195, v118, v119
    v_cvt_pk_bf16_f32 v112, v200, v201
    v_cvt_pk_bf16_f32 v114, v202, v203
    v_cvt_pk_bf16_f32 v116, v204, v205
    v_cvt_pk_bf16_f32 v118, v206, v207
    v_and_b32 v113, 0xffff0000, v112
    v_and_b32 v115, 0xffff0000, v114
    v_and_b32 v117, 0xffff0000, v116
    v_and_b32 v119, 0xffff0000, v118
    v_lshlrev_b32 v112, 16, v112
    v_lshlrev_b32 v114, 16, v114
    v_lshlrev_b32 v116, 16, v116
    v_lshlrev_b32 v118, 16, v118
    v_pk_add_f32 v[112:113], v[112:113], v[88:89]
    v_pk_add_f32 v[114:115], v[114:115], v[90:91]
    v_pk_add_f32 v[116:117], v[116:117], v[92:93]
    v_pk_add_f32 v[118:119], v[118:119], v[94:95]
    v_cvt_pk_bf16_f32 v112, v112, v113
    v_cvt_pk_bf16_f32 v114, v114, v115
    v_cvt_pk_bf16_f32 v116, v116, v117
    v_cvt_pk_bf16_f32 v118, v118, v119
    v_pk_max_i16 v112, v112, 0
    v_pk_max_i16 v114, v114, 0
    v_pk_max_i16 v116, v116, 0
    v_pk_max_i16 v118, v118, 0
    v_and_b32 v113, 0xffff0000, v112
    v_and_b32 v115, 0xffff0000, v114
    v_and_b32 v117, 0xffff0000, v116
    v_and_b32 v119, 0xffff0000, v118
    v_lshlrev_b32 v112, 16, v112
    v_lshlrev_b32 v114, 16, v114
    v_lshlrev_b32 v116, 16, v116
    v_lshlrev_b32 v118, 16, v118
    v_pk_mul_f32 v[112:113], v[112:113], v[112:113]
    v_pk_mul_f32 v[114:115], v[114:115], v[114:115]
    v_pk_mul_f32 v[116:117], v[116:117], v[116:117]
    v_pk_mul_f32 v[118:119], v[118:119], v[118:119]
    v_cvt_pk_bf16_f32 v196, v112, v113
    v_cvt_pk_bf16_f32 v197, v114, v115
    v_cvt_pk_bf16_f32 v198, v116, v117
    v_cvt_pk_bf16_f32 v199, v118, v119
    v_permlane32_swap_b32 v192, v194
    v_permlane32_swap_b32 v193, v195
    ds_write_b128 v226, v[192:195] offset:4096
    v_permlane32_swap_b32 v196, v198
    v_permlane32_swap_b32 v197, v199
    ds_write_b128 v227, v[196:199] offset:4096
    ds_read_b128 v[96:99], v228 offset:4096
    ds_read_b128 v[100:103], v228 offset:5120
    ds_read_b128 v[104:107], v228 offset:6144
    ds_read_b128 v[108:111], v228 offset:7168
    s_waitcnt lgkmcnt(0)
    s_barrier
    buffer_store_dwordx4 v[128:131], v7, s[56:59], s61 offen sc1
    s_add_u32 s61, s61, 512
    buffer_store_dwordx4 v[132:135], v7, s[56:59], s61 offen sc1
    s_add_u32 s61, s61, 512
    buffer_store_dwordx4 v[136:139], v7, s[56:59], s61 offen sc1
    s_add_u32 s61, s61, 512
    buffer_store_dwordx4 v[140:143], v7, s[56:59], s61 offen sc1
    s_add_u32 s61, s61, 512
    buffer_store_dwordx4 v[96:99], v7, s[56:59], s61 offen sc1
    s_add_u32 s61, s61, 512
    buffer_store_dwordx4 v[100:103], v7, s[56:59], s61 offen sc1
    s_add_u32 s61, s61, 512
    buffer_store_dwordx4 v[104:107], v7, s[56:59], s61 offen sc1
    s_add_u32 s61, s61, 512
    buffer_store_dwordx4 v[108:111], v7, s[56:59], s61 offen sc1
    s_branch K3_M0
K3_NOSTAG:
    s_waitcnt vmcnt(4)
K3_NOSTAGW:
    s_barrier
K3_M0:
    s_add_u32 s72, s71, 32768
    s_cmp_eq_u32 s70, s69
    s_cselect_b32 s72, s74, s72
    ds_read_b128 v[112:115], v8 offset:0
    ds_read_b128 v[116:119], v9 offset:0
    ds_read_b128 v[120:123], v10 offset:0
    ds_read_b128 v[124:127], v11 offset:0
    ds_read_b128 v[128:131], v12 offset:0
    s_waitcnt lgkmcnt(4)
    v_mfma_f32_32x32x16_bf16 v[64:79], v[112:115], v[32:35], 0
    ds_read_b128 v[132:135], v13 offset:0
    v_mov_b32 v144, 0
    v_mov_b32 v145, 0
    v_mov_b32 v146, 0
    v_mov_b32 v147, 0
    s_waitcnt lgkmcnt(4)
    v_mfma_f32_32x32x16_bf16 v[64:79], v[116:119], v[36:39], v[64:79]
    ds_read_b128 v[136:139], v14 offset:0
    s_mov_b32 m0, s80
    s_nop 0
    buffer_load_dwordx4 v2, s[48:51], s72 offen offset:0 lds
    v_mov_b32 v148, 0
    v_mov_b32 v149, 0
    v_mov_b32 v150, 0
    v_mov_b32 v151, 0
    s_waitcnt lgkmcnt(4)
    v_mfma_f32_32x32x16_bf16 v[64:79], v[120:123], v[40:43], v[64:79]
    ds_read_b128 v[140:143], v15 offset:0
    v_mov_b32 v152, 0
    v_mov_b32 v153, 0
    v_mov_b32 v154, 0
    v_mov_b32 v155, 0
    s_waitcnt lgkmcnt(4)
    v_mfma_f32_32x32x16_bf16 v[64:79], v[124:127], v[44:47], v[64:79]
    ds_read_b128 v[112:115], v8 offset:8192
    s_mov_b32 m0, s80
    s_nop 0
    buffer_load_dwordx4 v3, s[48:51], s72 offen offset:1024 lds
    v_mov_b32 v156, 0
    v_mov_b32 v157, 0
    v_mov_b32 v158, 0
    v_mov_b32 v159, 0
    s_waitcnt lgkmcnt(4)
    v_mfma_f32_32x32x16_bf16 v[64:79], v[128:131], v[48:51], v[64:79]
    ds_read_b128 v[116:119], v9 offset:8192
    v_mov_b32 v160, 0
    v_mov_b32 v161, 0
    v_mov_b32 v162, 0
    v_mov_b32 v163, 0
    s_waitcnt lgkmcnt(4)
    v_mfma_f32_32x32x16_bf16 v[64:79], v[132:135], v[52:55], v[64:79]
    ds_read_b128 v[120:123], v10 offset:8192
    s_mov_b32 m0, s80
    s_nop 0
    buffer_load_dwordx4 v4, s[48:51], s72 offen offset:2048 lds
    v_mov_b32 v164, 0
    v_mov_b32 v165, 0
    v_mov_b32 v166, 0
    v_mov_b32 v167, 0
    s_waitcnt lgkmcnt(4)
    v_mfma_f32_32x32x16_bf16 v[64:79], v[136:139], v[56:59], v[64:79]
    ds_read_b128 v[124:127], v11 offset:8192
    v_mov_b32 v168, 0
    v_mov_b32 v169, 0
    v_mov_b32 v170, 0
    v_mov_b32 v171, 0
    s_waitcnt lgkmcnt(4)
    v_mfma_f32_32x32x16_bf16 v[64:79], v[140:143], v[60:63], v[64:79]
    ds_read_b128 v[128:131], v12 offset:8192
    s_mov_b32 m0, s80
    s_nop 0
    buffer_load_dwordx4 v5, s[48:51], s72 offen offset:3072 lds
    v_mov_b32 v172, 0
    v_mov_b32 v173, 0
    v_mov_b32 v174, 0
    v_mov_b32 v175, 0
    s_waitcnt lgkmcnt(4)
    v_mfma_f32_32x32x16_bf16 v[80:95], v[112:115], v[32:35], 0
    ds_read_b128 v[132:135], v13 offset:8192
    v_mov_b32 v176, 0
    v_mov_b32 v177, 0
    v_mov_b32 v178, 0
    v_mov_b32 v179, 0
    s_waitcnt lgkmcnt(4)
    v_mfma_f32_32x32x16_bf16 v[80:95], v[116:119], v[36:39], v[80:95]
    ds_read_b128 v[136:139], v14 offset:8192
    s_mov_b32 m0, s81
    s_nop 0
    buffer_load_dwordx4 v6, s[52:55], s71 offen offset:0 lds
    v_mov_b32 v180, 0
    v_mov_b32 v181, 0
    v_mov_b32 v182, 0
    v_mov_b32 v183, 0
    s_waitcnt lgkmcnt(4)
    v_mfma_f32_32x32x16_bf16 v[80:95], v[120:123], v[40:43], v[80:95]
    ds_read_b128 v[140:143], v15 offset:8192
    v_mov_b32 v184, 0
    v_mov_b32 v185, 0
    v_mov_b32 v186, 0
    v_mov_b32 v187, 0
    s_waitcnt lgkmcnt(4)
    v_mfma_f32_32x32x16_bf16 v[80:95], v[124:127], v[44:47], v[80:95]
    s_mov_b32 m0, s81
    s_nop 0
    buffer_load_dwordx4 v6, s[52:55], s71 offen offset:1024 lds
    v_mov_b32 v188, 0
    v_mov_b32 v189, 0
    v_mov_b32 v190, 0
    v_mov_b32 v191, 0
    s_waitcnt lgkmcnt(3)
    v_mfma_f32_32x32x16_bf16 v[80:95], v[128:131], v[48:51], v[80:95]
    v_mov_b32 v192, 0
    v_mov_b32 v193, 0
    v_mov_b32 v194, 0
    v_mov_b32 v195, 0
    s_waitcnt lgkmcnt(2)
    v_mfma_f32_32x32x16_bf16 v[80:95], v[132:135], v[52:55], v[80:95]
    s_mov_b32 m0, s81
    s_nop 0
    buffer_load_dwordx4 v6, s[52:55], s71 offen offset:2048 lds
    v_mov_b32 v196, 0
    v_mov_b32 v197, 0
    v_mov_b32 v198, 0
    v_mov_b32 v199, 0
    s_waitcnt lgkmcnt(1)
    v_mfma_f32_32x32x16_bf16 v[80:95], v[136:139], v[56:59], v[80:95]
    v_mov_b32 v200, 0
    v_mov_b32 v201, 0
    v_mov_b32 v202, 0
    v_mov_b32 v203, 0
    s_waitcnt lgkmcnt(0)
    v_mfma_f32_32x32x16_bf16 v[80:95], v[140:143], v[60:63], v[80:95]
    s_mov_b32 m0, s81
    s_nop 0
    buffer_load_dwordx4 v6, s[52:55], s71 offen offset:3072 lds
    s_xor_b32 s80, s80, 16384
    s_xor_b32 s81, s81, 16384
    s_add_u32 s71, s71, 32768
    v_mov_b32 v204, 0
    v_mov_b32 v205, 0
    v_mov_b32 v206, 0
    v_mov_b32 v207, 0
    s_barrier
    s_nop 15
.p2align 6
    s_nop 0
    s_nop 0
    s_nop 0
K3_LOOP:
    s_cmp_eq_u32 s70, s69
    s_cbranch_scc1 K3_LAST
    s_add_u32 s72, s71, 32768
    s_add_u32 s73, s70, 1
    s_cmp_eq_u32 s73, s69
    s_cselect_b32 s76, s74, s72
    s_cmp_eq_u32 s70, 0
    s_cbranch_scc1 K3_V0
    s_setprio 0
    v_exp_f32 v112, v64
    v_exp_f32 v113, v65
    v_exp_f32 v114, v66
    v_exp_f32 v115, v67
    s_mov_b32 m0, s80
    s_nop 0
    buffer_load_dwordx4 v2, s[48:51], s76 offen offset:0 lds
    v_exp_f32 v116, v68
    v_exp_f32 v117, v69
    v_exp_f32 v118, v70
    v_exp_f32 v119, v71
    s_mov_b32 m0, s80
    s_nop 0
    buffer_load_dwordx4 v3, s[48:51], s76 offen offset:1024 lds
    v_exp_f32 v120, v72
    v_exp_f32 v121, v73
    v_exp_f32 v122, v74
    v_exp_f32 v123, v75
    s_mov_b32 m0, s80
    s_nop 0
    buffer_load_dwordx4 v4, s[48:51], s76 offen offset:2048 lds
    v_exp_f32 v124, v76
    v_exp_f32 v125, v77
    v_exp_f32 v126, v78
    v_exp_f32 v127, v79
    s_mov_b32 m0, s80
    s_nop 0
    buffer_load_dwordx4 v5, s[48:51], s76 offen offset:3072 lds
    v_exp_f32 v128, v80
    v_exp_f32 v129, v81
    v_exp_f32 v130, v82
    v_exp_f32 v131, v83
    s_mov_b32 m0, s81
    s_nop 0
    buffer_load_dwordx4 v6, s[52:55], s71 offen offset:0 lds
    v_exp_f32 v132, v84
    v_exp_f32 v133, v85
    v_exp_f32 v134, v86
    v_exp_f32 v135, v87
    s_mov_b32 m0, s81
    s_nop 0
    buffer_load_dwordx4 v6, s[52:55], s71 offen offset:1024 lds
    v_exp_f32 v136, v88
    v_exp_f32 v137, v89
    v_exp_f32 v138, v90
    v_exp_f32 v139, v91
    s_mov_b32 m0, s81
    s_nop 0
    buffer_load_dwordx4 v6, s[52:55], s71 offen offset:2048 lds
    v_exp_f32 v140, v92
    v_exp_f32 v141, v93
    v_exp_f32 v142, v94
    v_exp_f32 v143, v95
    s_mov_b32 m0, s81
    s_nop 0
    buffer_load_dwordx4 v6, s[52:55], s71 offen offset:3072 lds
    s_xor_b32 s80, s80, 16384
    s_xor_b32 s81, s81, 16384
    s_add_u32 s71, s71, 32768
    v_add_f32 v247, v112, v113
    v_add_f32 v253, v114, v115
    v_add_f32 v247, v247, v116
    v_add_f32 v253, v253, v117
    v_add_f32 v247, v247, v118
    v_add_f32 v253, v253, v119
    v_add_f32 v247, v247, v120
    v_add_f32 v253, v253, v121
    v_add_f32 v247, v247, v122
    v_add_f32 v253, v253, v123
    v_add_f32 v247, v247, v124
    v_add_f32 v253, v253, v125
    v_add_f32 v247, v247, v126
    v_add_f32 v253, v253, v127
    v_add_f32 v247, v247, v128
    v_add_f32 v253, v253, v129
    v_add_f32 v247, v247, v130
    v_add_f32 v253, v253, v131
    v_add_f32 v247, v247, v132
    v_add_f32 v253, v253, v133
    v_add_f32 v247, v247, v134
    v_add_f32 v253, v253, v135
    v_add_f32 v247, v247, v136
    v_add_f32 v253, v253, v137
    v_add_f32 v247, v247, v138
    v_add_f32 v253, v253, v139
    v_add_f32 v247, v247, v140
    v_add_f32 v253, v253, v141
    v_add_f32 v247, v247, v142
    v_add_f32 v253, v253, v143
    v_cvt_pk_bf16_f32 v96, v112, v113
    v_cvt_pk_bf16_f32 v97, v114, v115
    v_cvt_pk_bf16_f32 v98, v116, v117
    v_cvt_pk_bf16_f32 v99, v118, v119
    v_cvt_pk_bf16_f32 v100, v120, v121
    v_cvt_pk_bf16_f32 v101, v122, v123
    v_cvt_pk_bf16_f32 v102, v124, v125
    v_cvt_pk_bf16_f32 v103, v126, v127
    v_cvt_pk_bf16_f32 v104, v128, v129
    v_cvt_pk_bf16_f32 v105, v130, v131
    v_cvt_pk_bf16_f32 v106, v132, v133
    v_cvt_pk_bf16_f32 v107, v134, v135
    v_cvt_pk_bf16_f32 v108, v136, v137
    v_cvt_pk_bf16_f32 v109, v138, v139
    v_cvt_pk_bf16_f32 v110, v140, v141
    v_cvt_pk_bf16_f32 v111, v142, v143
    v_xor_b32 v8, 0x4000, v8
    v_xor_b32 v9, 0x4000, v9
    v_xor_b32 v10, 0x4000, v10
    v_xor_b32 v11, 0x4000, v11
    v_xor_b32 v12, 0x4000, v12
    v_xor_b32 v13, 0x4000, v13
    v_xor_b32 v14, 0x4000, v14
    v_xor_b32 v15, 0x4000, v15
    v_add_f32 v247, v247, v253
    v_cmp_lt_f32 vcc, 0x49800000, v247
    s_cbranch_vccnz K3_VRARE
    v_add_f32 v21, v21, v247
    v_mov_b32 v247, 0
    s_setprio 2
K3_VDONE:
    s_cmp_eq_u32 s70, s85
    s_cbranch_scc1 K3_MSKIP
    ds_read_b128 v[112:115], v8 offset:0
    ds_read_b128 v[116:119], v9 offset:0
    ds_read_b128 v[120:123], v10 offset:0
    ds_read_b128 v[124:127], v11 offset:0
    ds_read_b128 v[128:131], v12 offset:0
    s_barrier
K3_MGO:
    s_waitcnt lgkmcnt(4)
    v_mfma_f32_32x32x16_bf16 v[64:79], v[112:115], v[32:35], v[208:223]
    ds_read_b128 v[132:135], v13 offset:0
    s_waitcnt lgkmcnt(4)
    v_mfma_f32_32x32x16_bf16 v[64:79], v[116:119], v[36:39], v[64:79]
    ds_read_b128 v[136:139], v14 offset:0
    s_waitcnt lgkmcnt(4)
    v_mfma_f32_32x32x16_bf16 v[64:79], v[120:123], v[40:43], v[64:79]
    ds_read_b128 v[140:143], v15 offset:0
    s_waitcnt lgkmcnt(4)
    v_mfma_f32_32x32x16_bf16 v[64:79], v[124:127], v[44:47], v[64:79]
    ds_read_b128 v[112:115], v8 offset:8192
    s_waitcnt lgkmcnt(4)
    v_mfma_f32_32x32x16_bf16 v[64:79], v[128:131], v[48:51], v[64:79]
    ds_read_b128 v[116:119], v9 offset:8192
    s_waitcnt lgkmcnt(4)
    v_mfma_f32_32x32x16_bf16 v[64:79], v[132:135], v[52:55], v[64:79]
    ds_read_b128 v[120:123], v10 offset:8192
    s_waitcnt lgkmcnt(4)
    v_mfma_f32_32x32x16_bf16 v[64:79], v[136:139], v[56:59], v[64:79]
    ds_read_b128 v[124:127], v11 offset:8192
    s_waitcnt lgkmcnt(4)
    v_mfma_f32_32x32x16_bf16 v[64:79], v[140:143], v[60:63], v[64:79]
    ds_read_b128 v[128:131], v12 offset:8192
    s_waitcnt lgkmcnt(4)
    v_mfma_f32_32x32x16_bf16 v[80:95], v[112:115], v[32:35], v[208:223]
    ds_read_b128 v[132:135], v13 offset:8192
    s_waitcnt lgkmcnt(4)
    v_mfma_f32_32x32x16_bf16 v[80:95], v[116:119], v[36:39], v[80:95]
    ds_read_b128 v[136:139], v14 offset:8192
    s_waitcnt lgkmcnt(4)
    v_mfma_f32_32x32x16_bf16 v[80:95], v[120:123], v[40:43], v[80:95]
    ds_read_b128 v[140:143], v15 offset:8192
    s_waitcnt lgkmcnt(4)
    v_mfma_f32_32x32x16_bf16 v[80:95], v[124:127], v[44:47], v[80:95]
    ds_read_b64_tr_b16 v[112:113], v16 offset:0
    ds_read_b64_tr_b16 v[114:115], v16 offset:2048
    s_waitcnt lgkmcnt(5)
    v_mfma_f32_32x32x16_bf16 v[80:95], v[128:131], v[48:51], v[80:95]
    ds_read_b64_tr_b16 v[116:117], v17 offset:0
    ds_read_b64_tr_b16 v[118:119], v17 offset:2048
    s_waitcnt lgkmcnt(6)
    v_mfma_f32_32x32x16_bf16 v[80:95], v[132:135], v[52:55], v[80:95]
    ds_read_b64_tr_b16 v[120:121], v18 offset:0
    ds_read_b64_tr_b16 v[122:123], v18 offset:2048
    s_waitcnt lgkmcnt(7)
    v_mfma_f32_32x32x16_bf16 v[80:95], v[136:139], v[56:59], v[80:95]
    ds_read_b64_tr_b16 v[124:125], v19 offset:0
    ds_read_b64_tr_b16 v[126:127], v19 offset:2048
    s_waitcnt lgkmcnt(8)
    v_mfma_f32_32x32x16_bf16 v[80:95], v[140:143], v[60:63], v[80:95]
    ds_read_b64_tr_b16 v[128:129], v16 offset:4096
    ds_read_b64_tr_b16 v[130:131], v16 offset:6144
    s_waitcnt lgkmcnt(8)
    v_mfma_f32_32x32x16_bf16 v[144:159], v[112:115], v[96:99], v[144:159]
    ds_read_b64_tr_b16 v[132:133], v17 offset:4096
    ds_read_b64_tr_b16 v[134:135], v17 offset:6144
    s_waitcnt lgkmcnt(8)
    v_mfma_f32_32x32x16_bf16 v[160:175], v[116:119], v[96:99], v[160:175]
    ds_read_b64_tr_b16 v[136:137], v18 offset:4096
    ds_read_b64_tr_b16 v[138:139], v18 offset:6144
    s_waitcnt lgkmcnt(8)
    v_mfma_f32_32x32x16_bf16 v[176:191], v[120:123], v[96:99], v[176:191]
    ds_read_b64_tr_b16 v[140:141], v19 offset:4096
    ds_read_b64_tr_b16 v[142:143], v19 offset:6144
    s_waitcnt lgkmcnt(8)
    v_mfma_f32_32x32x16_bf16 v[192:207], v[124:127], v[96:99], v[192:207]
    ds_read_b64_tr_b16 v[112:113], v16 offset:8192
    ds_read_b64_tr_b16 v[114:115], v16 offset:10240
    s_waitcnt lgkmcnt(8)
    v_mfma_f32_32x32x16_bf16 v[144:159], v[128:131], v[100:103], v[144:159]
    ds_read_b64_tr_b16 v[116:117], v17 offset:8192
    ds_read_b64_tr_b16 v[118:119], v17 offset:10240
    s_waitcnt lgkmcnt(8)
    v_mfma_f32_32x32x16_bf16 v[160:175], v[132:135], v[100:103], v[160:175]
    ds_read_b64_tr_b16 v[120:121], v18 offset:8192
    ds_read_b64_tr_b16 v[122:123], v18 offset:10240
    s_waitcnt lgkmcnt(8)
    v_mfma_f32_32x32x16_bf16 v[176:191], v[136:139], v[100:103], v[176:191]
    ds_read_b64_tr_b16 v[124:125], v19 offset:8192
    ds_read_b64_tr_b16 v[126:127], v19 offset:10240
    s_waitcnt lgkmcnt(8)
    v_mfma_f32_32x32x16_bf16 v[192:207], v[140:143], v[100:103], v[192:207]
    ds_read_b64_tr_b16 v[128:129], v16 offset:12288
    ds_read_b64_tr_b16 v[130:131], v16 offset:14336
    s_waitcnt lgkmcnt(8)
    v_mfma_f32_32x32x16_bf16 v[144:159], v[112:115], v[104:107], v[144:159]
    ds_read_b64_tr_b16 v[132:133], v17 offset:12288
    ds_read_b64_tr_b16 v[134:135], v17 offset:14336
    s_waitcnt lgkmcnt(8)
    v_mfma_f32_32x32x16_bf16 v[160:175], v[116:119], v[104:107], v[160:175]
    ds_read_b64_tr_b16 v[136:137], v18 offset:12288
    ds_read_b64_tr_b16 v[138:139], v18 offset:14336
    s_waitcnt lgkmcnt(8)
    v_mfma_f32_32x32x16_bf16 v[176:191], v[120:123], v[104:107], v[176:191]
    ds_read_b64_tr_b16 v[140:141], v19 offset:12288
    ds_read_b64_tr_b16 v[142:143], v19 offset:14336
    s_waitcnt lgkmcnt(8)
    v_mfma_f32_32x32x16_bf16 v[192:207], v[124:127], v[104:107], v[192:207]
    s_waitcnt lgkmcnt(6)
    v_mfma_f32_32x32x16_bf16 v[144:159], v[128:131], v[108:111], v[144:159]
    s_waitcnt lgkmcnt(4)
    v_mfma_f32_32x32x16_bf16 v[160:175], v[132:135], v[108:111], v[160:175]
    s_waitcnt lgkmcnt(2)
    v_mfma_f32_32x32x16_bf16 v[176:191], v[136:139], v[108:111], v[176:191]
    s_waitcnt lgkmcnt(0)
    v_mfma_f32_32x32x16_bf16 v[192:207], v[140:143], v[108:111], v[192:207]
K3_MTAIL:
    v_xor_b32 v16, 0x4000, v16
    v_xor_b32 v17, 0x4000, v17
    v_xor_b32 v18, 0x4000, v18
    v_xor_b32 v19, 0x4000, v19
    s_add_u32 s70, s70, 1
    s_waitcnt vmcnt(0)
    s_barrier
    s_branch K3_LOOP
K3_V0:
    s_setprio 0
    s_nop 15
    v_max3_f32 v23, v64, v65, v66
    v_max3_f32 v24, v67, v68, v69
    v_max3_f32 v23, v23, v70, v71
    v_max3_f32 v24, v24, v72, v73
    v_max3_f32 v23, v23, v74, v75
    v_max3_f32 v24, v24, v76, v77
    v_max3_f32 v23, v23, v78, v79
    v_max3_f32 v24, v24, v80, v81
    v_max3_f32 v23, v23, v82, v83
    v_max3_f32 v24, v24, v84, v85
    v_max3_f32 v23, v23, v86, v87
    v_max3_f32 v24, v24, v88, v89
    v_max3_f32 v23, v23, v90, v91
    v_max3_f32 v24, v24, v92, v93
    v_max3_f32 v23, v23, v94, v95
    v_max_f32 v23, v23, v24
    v_mov_b32 v24, v23
    s_nop 1
    v_permlane32_swap_b32 v23, v24
    v_max_f32 v23, v23, v24
K3_RAREZ:
    s_cmp_eq_u32 s70, 0
    s_mov_b32 s101, 0
    s_cselect_b32 s72, 0xff7fffff, s101
    v_max_f32 v24, s72, v23
    v_cmp_lt_f32 vcc, 0xefa18f08, v23
    s_nop 1
    v_cndmask_b32 v24, 0, v24, vcc
    v_add_f32 v20, v20, v24
    v_sub_f32 v25, 0, v24
    v_exp_f32 v25, v25
    v_sub_f32 v26, 0, v20
    v_sub_f32 v64, v64, v24
    v_sub_f32 v65, v65, v24
    v_sub_f32 v66, v66, v24
    v_sub_f32 v67, v67, v24
    v_sub_f32 v68, v68, v24
    v_sub_f32 v69, v69, v24
    v_sub_f32 v70, v70, v24
    v_sub_f32 v71, v71, v24
    v_sub_f32 v72, v72, v24
    v_sub_f32 v73, v73, v24
    v_sub_f32 v74, v74, v24
    v_sub_f32 v75, v75, v24
    v_sub_f32 v76, v76, v24
    v_sub_f32 v77, v77, v24
    v_sub_f32 v78, v78, v24
    v_sub_f32 v79, v79, v24
    v_sub_f32 v80, v80, v24
    v_sub_f32 v81, v81, v24
    v_sub_f32 v82, v82, v24
    v_sub_f32 v83, v83, v24
    v_sub_f32 v84, v84, v24
    v_sub_f32 v85, v85, v24
    v_sub_f32 v86, v86, v24
    v_sub_f32 v87, v87, v24
    v_sub_f32 v88, v88, v24
    v_sub_f32 v89, v89, v24
    v_sub_f32 v90, v90, v24
    v_sub_f32 v91, v91, v24
    v_sub_f32 v92, v92, v24
    v_sub_f32 v93, v93, v24
    v_sub_f32 v94, v94, v24
    v_sub_f32 v95, v95, v24
    v_mov_b32 v208, v26
    v_mov_b32 v209, v26
    v_mov_b32 v210, v26
    v_mov_b32 v211, v26
    v_mov_b32 v212, v26
    v_mov_b32 v213, v26
    v_mov_b32 v214, v26
    v_mov_b32 v215, v26
    v_mov_b32 v216, v26
    v_mov_b32 v217, v26
    v_mov_b32 v218, v26
    v_mov_b32 v219, v26
    v_mov_b32 v220, v26
    v_mov_b32 v221, v26
    v_mov_b32 v222, v26
    v_mov_b32 v223, v26
    s_cmp_eq_u32 s70, 0
    s_cbranch_scc1 K3_SKIPZ
    v_mul_f32 v21, v21, v25
    v_mul_f32 v144, v144, v25
    v_mul_f32 v145, v145, v25
    v_mul_f32 v146, v146, v25
    v_mul_f32 v147, v147, v25
    v_mul_f32 v148, v148, v25
    v_mul_f32 v149, v149, v25
    v_mul_f32 v150, v150, v25
    v_mul_f32 v151, v151, v25
    v_mul_f32 v152, v152, v25
    v_mul_f32 v153, v153, v25
    v_mul_f32 v154, v154, v25
    v_mul_f32 v155, v155, v25
    v_mul_f32 v156, v156, v25
    v_mul_f32 v157, v157, v25
    v_mul_f32 v158, v158, v25
    v_mul_f32 v159, v159, v25
    v_mul_f32 v160, v160, v25
    v_mul_f32 v161, v161, v25
    v_mul_f32 v162, v162, v25
    v_mul_f32 v163, v163, v25
    v_mul_f32 v164, v164, v25
    v_mul_f32 v165, v165, v25
    v_mul_f32 v166, v166, v25
    v_mul_f32 v167, v167, v25
    v_mul_f32 v168, v168, v25
    v_mul_f32 v169, v169, v25
    v_mul_f32 v170, v170, v25
    v_mul_f32 v171, v171, v25
    v_mul_f32 v172, v172, v25
    v_mul_f32 v173, v173, v25
    v_mul_f32 v174, v174, v25
    v_mul_f32 v175, v175, v25
    v_mul_f32 v176, v176, v25
    v_mul_f32 v177, v177, v25
    v_mul_f32 v178, v178, v25
    v_mul_f32 v179, v179, v25
    v_mul_f32 v180, v180, v25
    v_mul_f32 v181, v181, v25
    v_mul_f32 v182, v182, v25
    v_mul_f32 v183, v183, v25
    v_mul_f32 v184, v184, v25
    v_mul_f32 v185, v185, v25
    v_mul_f32 v186, v186, v25
    v_mul_f32 v187, v187, v25
    v_mul_f32 v188, v188, v25
    v_mul_f32 v189, v189, v25
    v_mul_f32 v190, v190, v25
    v_mul_f32 v191, v191, v25
    v_mul_f32 v192, v192, v25
    v_mul_f32 v193, v193, v25
    v_mul_f32 v194, v194, v25
    v_mul_f32 v195, v195, v25
    v_mul_f32 v196, v196, v25
    v_mul_f32 v197, v197, v25
    v_mul_f32 v198, v198, v25
    v_mul_f32 v199, v199, v25
    v_mul_f32 v200, v200, v25
    v_mul_f32 v201, v201, v25
    v_mul_f32 v202, v202, v25
    v_mul_f32 v203, v203, v25
    v_mul_f32 v204, v204, v25
    v_mul_f32 v205, v205, v25
    v_mul_f32 v206, v206, v25
    v_mul_f32 v207, v207, v25
K3_SKIPZ:
    v_exp_f32 v64, v64
    v_exp_f32 v65, v65
    v_exp_f32 v66, v66
    v_exp_f32 v67, v67
    s_mov_b32 m0, s80
    s_nop 0
    buffer_load_dwordx4 v2, s[48:51], s76 offen offset:0 lds
    v_exp_f32 v68, v68
    v_exp_f32 v69, v69
    v_exp_f32 v70, v70
    v_exp_f32 v71, v71
    s_mov_b32 m0, s80
    s_nop 0
    buffer_load_dwordx4 v3, s[48:51], s76 offen offset:1024 lds
    v_exp_f32 v72, v72
    v_exp_f32 v73, v73
    v_exp_f32 v74, v74
    v_exp_f32 v75, v75
    s_mov_b32 m0, s80
    s_nop 0
    buffer_load_dwordx4 v4, s[48:51], s76 offen offset:2048 lds
    v_exp_f32 v76, v76
    v_exp_f32 v77, v77
    v_exp_f32 v78, v78
    v_exp_f32 v79, v79
    s_mov_b32 m0, s80
    s_nop 0
    buffer_load_dwordx4 v5, s[48:51], s76 offen offset:3072 lds
    v_exp_f32 v80, v80
    v_exp_f32 v81, v81
    v_exp_f32 v82, v82
    v_exp_f32 v83, v83
    s_mov_b32 m0, s81
    s_nop 0
    buffer_load_dwordx4 v6, s[52:55], s71 offen offset:0 lds
    v_exp_f32 v84, v84
    v_exp_f32 v85, v85
    v_exp_f32 v86, v86
    v_exp_f32 v87, v87
    s_mov_b32 m0, s81
    s_nop 0
    buffer_load_dwordx4 v6, s[52:55], s71 offen offset:1024 lds
    v_exp_f32 v88, v88
    v_exp_f32 v89, v89
    v_exp_f32 v90, v90
    v_exp_f32 v91, v91
    s_mov_b32 m0, s81
    s_nop 0
    buffer_load_dwordx4 v6, s[52:55], s71 offen offset:2048 lds
    v_exp_f32 v92, v92
    v_exp_f32 v93, v93
    v_exp_f32 v94, v94
    v_exp_f32 v95, v95
    s_mov_b32 m0, s81
    s_nop 0
    buffer_load_dwordx4 v6, s[52:55], s71 offen offset:3072 lds
    s_xor_b32 s80, s80, 16384
    s_xor_b32 s81, s81, 16384
    s_add_u32 s71, s71, 32768
    v_add_f32 v23, v64, v65
    v_add_f32 v247, v66, v67
    v_add_f32 v23, v23, v68
    v_add_f32 v247, v247, v69
    v_add_f32 v23, v23, v70
    v_add_f32 v247, v247, v71
    v_add_f32 v23, v23, v72
    v_add_f32 v247, v247, v73
    v_add_f32 v23, v23, v74
    v_add_f32 v247, v247, v75
    v_add_f32 v23, v23, v76
    v_add_f32 v247, v247, v77
    v_add_f32 v23, v23, v78
    v_add_f32 v247, v247, v79
    v_add_f32 v23, v23, v80
    v_add_f32 v247, v247, v81
    v_add_f32 v23, v23, v82
    v_add_f32 v247, v247, v83
    v_add_f32 v23, v23, v84
    v_add_f32 v247, v247, v85
    v_add_f32 v23, v23, v86
    v_add_f32 v247, v247, v87
    v_add_f32 v23, v23, v88
    v_add_f32 v247, v247, v89
    v_add_f32 v23, v23, v90
    v_add_f32 v247, v247, v91
    v_add_f32 v23, v23, v92
    v_add_f32 v247, v247, v93
    v_add_f32 v23, v23, v94
    v_add_f32 v247, v247, v95
    v_cvt_pk_bf16_f32 v96, v64, v65
    v_cvt_pk_bf16_f32 v97, v66, v67
    v_cvt_pk_bf16_f32 v98, v68, v69
    v_cvt_pk_bf16_f32 v99, v70, v71
    v_cvt_pk_bf16_f32 v100, v72, v73
    v_cvt_pk_bf16_f32 v101, v74, v75
    v_cvt_pk_bf16_f32 v102, v76, v77
    v_cvt_pk_bf16_f32 v103, v78, v79
    v_cvt_pk_bf16_f32 v104, v80, v81
    v_cvt_pk_bf16_f32 v105, v82, v83
    v_cvt_pk_bf16_f32 v106, v84, v85
    v_cvt_pk_bf16_f32 v107, v86, v87
    v_cvt_pk_bf16_f32 v108, v88, v89
    v_cvt_pk_bf16_f32 v109, v90, v91
    v_cvt_pk_bf16_f32 v110, v92, v93
    v_cvt_pk_bf16_f32 v111, v94, v95
    v_add_f32 v21, v21, v23
    v_xor_b32 v8, 0x4000, v8
    v_xor_b32 v9, 0x4000, v9
    v_xor_b32 v10, 0x4000, v10
    v_xor_b32 v11, 0x4000, v11
    v_xor_b32 v12, 0x4000, v12
    v_xor_b32 v13, 0x4000, v13
    v_xor_b32 v14, 0x4000, v14
    v_xor_b32 v15, 0x4000, v15
    v_add_f32 v21, v21, v247
    v_mov_b32 v247, 0
    s_setprio 2
    s_waitcnt vmcnt(8)
    s_barrier
    ds_read_b128 v[112:115], v8 offset:0
    ds_read_b128 v[116:119], v9 offset:0
    ds_read_b128 v[120:123], v10 offset:0
    ds_read_b128 v[124:127], v11 offset:0
    ds_read_b128 v[128:131], v12 offset:0
    s_branch K3_MGO
K3_MSKIP:
    s_cmp_eq_u32 s84, 0
    s_cbranch_scc1 K3_MSKIP0
    ds_read_b128 v[112:115], v8 offset:0
    ds_read_b128 v[116:119], v9 offset:0
    ds_read_b128 v[120:123], v10 offset:0
    ds_read_b128 v[124:127], v11 offset:0
    ds_read_b128 v[128:131], v12 offset:0
    s_barrier
    s_waitcnt lgkmcnt(4)
    v_mfma_f32_32x32x16_bf16 v[64:79], v[112:115], v[32:35], v[208:223]
    ds_read_b128 v[132:135], v13 offset:0
    s_waitcnt lgkmcnt(4)
    v_mfma_f32_32x32x16_bf16 v[64:79], v[116:119], v[36:39], v[64:79]
    ds_read_b128 v[136:139], v14 offset:0
    s_waitcnt lgkmcnt(4)
    v_mfma_f32_32x32x16_bf16 v[64:79], v[120:123], v[40:43], v[64:79]
    ds_read_b128 v[140:143], v15 offset:0
    s_waitcnt lgkmcnt(4)
    v_mfma_f32_32x32x16_bf16 v[64:79], v[124:127], v[44:47], v[64:79]
    ds_read_b64_tr_b16 v[112:113], v16 offset:0
    ds_read_b64_tr_b16 v[114:115], v16 offset:2048
    s_waitcnt lgkmcnt(5)
    v_mfma_f32_32x32x16_bf16 v[64:79], v[128:131], v[48:51], v[64:79]
    ds_read_b64_tr_b16 v[116:117], v17 offset:0
    ds_read_b64_tr_b16 v[118:119], v17 offset:2048
    s_waitcnt lgkmcnt(6)
    v_mfma_f32_32x32x16_bf16 v[64:79], v[132:135], v[52:55], v[64:79]
    ds_read_b64_tr_b16 v[120:121], v18 offset:0
    ds_read_b64_tr_b16 v[122:123], v18 offset:2048
    s_waitcnt lgkmcnt(7)
    v_mfma_f32_32x32x16_bf16 v[64:79], v[136:139], v[56:59], v[64:79]
    ds_read_b64_tr_b16 v[124:125], v19 offset:0
    ds_read_b64_tr_b16 v[126:127], v19 offset:2048
    s_waitcnt lgkmcnt(8)
    v_mfma_f32_32x32x16_bf16 v[64:79], v[140:143], v[60:63], v[64:79]
    ds_read_b64_tr_b16 v[128:129], v16 offset:4096
    ds_read_b64_tr_b16 v[130:131], v16 offset:6144
    s_waitcnt lgkmcnt(8)
    v_mfma_f32_32x32x16_bf16 v[144:159], v[112:115], v[96:99], v[144:159]
    ds_read_b64_tr_b16 v[132:133], v17 offset:4096
    ds_read_b64_tr_b16 v[134:135], v17 offset:6144
    s_waitcnt lgkmcnt(8)
    v_mfma_f32_32x32x16_bf16 v[160:175], v[116:119], v[96:99], v[160:175]
    ds_read_b64_tr_b16 v[136:137], v18 offset:4096
    ds_read_b64_tr_b16 v[138:139], v18 offset:6144
    s_waitcnt lgkmcnt(8)
    v_mfma_f32_32x32x16_bf16 v[176:191], v[120:123], v[96:99], v[176:191]
    ds_read_b64_tr_b16 v[140:141], v19 offset:4096
    ds_read_b64_tr_b16 v[142:143], v19 offset:6144
    s_waitcnt lgkmcnt(8)
    v_mfma_f32_32x32x16_bf16 v[192:207], v[124:127], v[96:99], v[192:207]
    ds_read_b64_tr_b16 v[112:113], v16 offset:8192
    ds_read_b64_tr_b16 v[114:115], v16 offset:10240
    s_waitcnt lgkmcnt(8)
    v_mfma_f32_32x32x16_bf16 v[144:159], v[128:131], v[100:103], v[144:159]
    ds_read_b64_tr_b16 v[116:117], v17 offset:8192
    ds_read_b64_tr_b16 v[118:119], v17 offset:10240
    s_waitcnt lgkmcnt(8)
    v_mfma_f32_32x32x16_bf16 v[160:175], v[132:135], v[100:103], v[160:175]
    ds_read_b64_tr_b16 v[120:121], v18 offset:8192
    ds_read_b64_tr_b16 v[122:123], v18 offset:10240
    s_waitcnt lgkmcnt(8)
    v_mfma_f32_32x32x16_bf16 v[176:191], v[136:139], v[100:103], v[176:191]
    ds_read_b64_tr_b16 v[124:125], v19 offset:8192
    ds_read_b64_tr_b16 v[126:127], v19 offset:10240
    s_waitcnt lgkmcnt(8)
    v_mfma_f32_32x32x16_bf16 v[192:207], v[140:143], v[100:103], v[192:207]
    ds_read_b64_tr_b16 v[128:129], v16 offset:12288
    ds_read_b64_tr_b16 v[130:131], v16 offset:14336
    s_waitcnt lgkmcnt(8)
    v_mfma_f32_32x32x16_bf16 v[144:159], v[112:115], v[104:107], v[144:159]
    ds_read_b64_tr_b16 v[132:133], v17 offset:12288
    ds_read_b64_tr_b16 v[134:135], v17 offset:14336
    s_waitcnt lgkmcnt(8)
    v_mfma_f32_32x32x16_bf16 v[160:175], v[116:119], v[104:107], v[160:175]
    ds_read_b64_tr_b16 v[136:137], v18 offset:12288
    ds_read_b64_tr_b16 v[138:139], v18 offset:14336
    s_waitcnt lgkmcnt(8)
    v_mfma_f32_32x32x16_bf16 v[176:191], v[120:123], v[104:107], v[176:191]
    ds_read_b64_tr_b16 v[140:141], v19 offset:12288
    ds_read_b64_tr_b16 v[142:143], v19 offset:14336
    s_waitcnt lgkmcnt(8)
    v_mfma_f32_32x32x16_bf16 v[192:207], v[124:127], v[104:107], v[192:207]
    s_waitcnt lgkmcnt(6)
    v_mfma_f32_32x32x16_bf16 v[144:159], v[128:131], v[108:111], v[144:159]
    s_waitcnt lgkmcnt(4)
    v_mfma_f32_32x32x16_bf16 v[160:175], v[132:135], v[108:111], v[160:175]
    s_waitcnt lgkmcnt(2)
    v_mfma_f32_32x32x16_bf16 v[176:191], v[136:139], v[108:111], v[176:191]
    s_waitcnt lgkmcnt(0)
    v_mfma_f32_32x32x16_bf16 v[192:207], v[140:143], v[108:111], v[192:207]
    s_branch K3_MTAIL
K3_MSKIP0:
    ds_read_b64_tr_b16 v[112:113], v16 offset:0
    ds_read_b64_tr_b16 v[114:115], v16 offset:2048
    ds_read_b64_tr_b16 v[116:117], v17 offset:0
    ds_read_b64_tr_b16 v[118:119], v17 offset:2048
    ds_read_b64_tr_b16 v[120:121], v18 offset:0
    ds_read_b64_tr_b16 v[122:123], v18 offset:2048
    ds_read_b64_tr_b16 v[124:125], v19 offset:0
    ds_read_b64_tr_b16 v[126:127], v19 offset:2048
    ds_read_b64_tr_b16 v[128:129], v16 offset:4096
    ds_read_b64_tr_b16 v[130:131], v16 offset:6144
    s_barrier
    s_waitcnt lgkmcnt(8)
    v_mfma_f32_32x32x16_bf16 v[144:159], v[112:115], v[96:99], v[144:159]
    ds_read_b64_tr_b16 v[132:133], v17 offset:4096
    ds_read_b64_tr_b16 v[134:135], v17 offset:6144
    s_waitcnt lgkmcnt(8)
    v_mfma_f32_32x32x16_bf16 v[160:175], v[116:119], v[96:99], v[160:175]
    ds_read_b64_tr_b16 v[136:137], v18 offset:4096
    ds_read_b64_tr_b16 v[138:139], v18 offset:6144
    s_waitcnt lgkmcnt(8)
    v_mfma_f32_32x32x16_bf16 v[176:191], v[120:123], v[96:99], v[176:191]
    ds_read_b64_tr_b16 v[140:141], v19 offset:4096
    ds_read_b64_tr_b16 v[142:143], v19 offset:6144
    s_waitcnt lgkmcnt(8)
    v_mfma_f32_32x32x16_bf16 v[192:207], v[124:127], v[96:99], v[192:207]
    ds_read_b64_tr_b16 v[112:113], v16 offset:8192
    ds_read_b64_tr_b16 v[114:115], v16 offset:10240
    s_waitcnt lgkmcnt(8)
    v_mfma_f32_32x32x16_bf16 v[144:159], v[128:131], v[100:103], v[144:159]
    ds_read_b64_tr_b16 v[116:117], v17 offset:8192
    ds_read_b64_tr_b16 v[118:119], v17 offset:10240
    s_waitcnt lgkmcnt(8)
    v_mfma_f32_32x32x16_bf16 v[160:175], v[132:135], v[100:103], v[160:175]
    ds_read_b64_tr_b16 v[120:121], v18 offset:8192
    ds_read_b64_tr_b16 v[122:123], v18 offset:10240
    s_waitcnt lgkmcnt(8)
    v_mfma_f32_32x32x16_bf16 v[176:191], v[136:139], v[100:103], v[176:191]
    ds_read_b64_tr_b16 v[124:125], v19 offset:8192
    ds_read_b64_tr_b16 v[126:127], v19 offset:10240
    s_waitcnt lgkmcnt(8)
    v_mfma_f32_32x32x16_bf16 v[192:207], v[140:143], v[100:103], v[192:207]
    ds_read_b64_tr_b16 v[128:129], v16 offset:12288
    ds_read_b64_tr_b16 v[130:131], v16 offset:14336
    s_waitcnt lgkmcnt(8)
    v_mfma_f32_32x32x16_bf16 v[144:159], v[112:115], v[104:107], v[144:159]
    ds_read_b64_tr_b16 v[132:133], v17 offset:12288
    ds_read_b64_tr_b16 v[134:135], v17 offset:14336
    s_waitcnt lgkmcnt(8)
    v_mfma_f32_32x32x16_bf16 v[160:175], v[116:119], v[104:107], v[160:175]
    ds_read_b64_tr_b16 v[136:137], v18 offset:12288
    ds_read_b64_tr_b16 v[138:139], v18 offset:14336
    s_waitcnt lgkmcnt(8)
    v_mfma_f32_32x32x16_bf16 v[176:191], v[120:123], v[104:107], v[176:191]
    ds_read_b64_tr_b16 v[140:141], v19 offset:12288
    ds_read_b64_tr_b16 v[142:143], v19 offset:14336
    s_waitcnt lgkmcnt(8)
    v_mfma_f32_32x32x16_bf16 v[192:207], v[124:127], v[104:107], v[192:207]
    s_waitcnt lgkmcnt(6)
    v_mfma_f32_32x32x16_bf16 v[144:159], v[128:131], v[108:111], v[144:159]
    s_waitcnt lgkmcnt(4)
    v_mfma_f32_32x32x16_bf16 v[160:175], v[132:135], v[108:111], v[160:175]
    s_waitcnt lgkmcnt(2)
    v_mfma_f32_32x32x16_bf16 v[176:191], v[136:139], v[108:111], v[176:191]
    s_waitcnt lgkmcnt(0)
    v_mfma_f32_32x32x16_bf16 v[192:207], v[140:143], v[108:111], v[192:207]
    s_branch K3_MTAIL
K3_VRARE:
    v_mov_b32 v247, 0
    s_setprio 0
    s_nop 15
    v_max3_f32 v23, v64, v65, v66
    v_max3_f32 v24, v67, v68, v69
    v_max3_f32 v23, v23, v70, v71
    v_max3_f32 v24, v24, v72, v73
    v_max3_f32 v23, v23, v74, v75
    v_max3_f32 v24, v24, v76, v77
    v_max3_f32 v23, v23, v78, v79
    v_max3_f32 v24, v24, v80, v81
    v_max3_f32 v23, v23, v82, v83
    v_max3_f32 v24, v24, v84, v85
    v_max3_f32 v23, v23, v86, v87
    v_max3_f32 v24, v24, v88, v89
    v_max3_f32 v23, v23, v90, v91
    v_max3_f32 v24, v24, v92, v93
    v_max3_f32 v23, v23, v94, v95
    v_max_f32 v23, v23, v24
    v_mov_b32 v24, v23
    s_nop 1
    v_permlane32_swap_b32 v23, v24
    v_max_f32 v23, v23, v24
K3_RARER:
    s_cmp_eq_u32 s70, 0
    s_mov_b32 s101, 0
    s_cselect_b32 s72, 0xff7fffff, s101
    v_max_f32 v24, s72, v23
    v_cmp_lt_f32 vcc, 0xefa18f08, v23
    s_nop 1
    v_cndmask_b32 v24, 0, v24, vcc
    v_add_f32 v20, v20, v24
    v_sub_f32 v25, 0, v24
    v_exp_f32 v25, v25
    v_sub_f32 v26, 0, v20
    v_sub_f32 v64, v64, v24
    v_sub_f32 v65, v65, v24
    v_sub_f32 v66, v66, v24
    v_sub_f32 v67, v67, v24
    v_sub_f32 v68, v68, v24
    v_sub_f32 v69, v69, v24
    v_sub_f32 v70, v70, v24
    v_sub_f32 v71, v71, v24
    v_sub_f32 v72, v72, v24
    v_sub_f32 v73, v73, v24
    v_sub_f32 v74, v74, v24
    v_sub_f32 v75, v75, v24
    v_sub_f32 v76, v76, v24
    v_sub_f32 v77, v77, v24
    v_sub_f32 v78, v78, v24
    v_sub_f32 v79, v79, v24
    v_sub_f32 v80, v80, v24
    v_sub_f32 v81, v81, v24
    v_sub_f32 v82, v82, v24
    v_sub_f32 v83, v83, v24
    v_sub_f32 v84, v84, v24
    v_sub_f32 v85, v85, v24
    v_sub_f32 v86, v86, v24
    v_sub_f32 v87, v87, v24
    v_sub_f32 v88, v88, v24
    v_sub_f32 v89, v89, v24
    v_sub_f32 v90, v90, v24
    v_sub_f32 v91, v91, v24
    v_sub_f32 v92, v92, v24
    v_sub_f32 v93, v93, v24
    v_sub_f32 v94, v94, v24
    v_sub_f32 v95, v95, v24
    v_mov_b32 v208, v26
    v_mov_b32 v209, v26
    v_mov_b32 v210, v26
    v_mov_b32 v211, v26
    v_mov_b32 v212, v26
    v_mov_b32 v213, v26
    v_mov_b32 v214, v26
    v_mov_b32 v215, v26
    v_mov_b32 v216, v26
    v_mov_b32 v217, v26
    v_mov_b32 v218, v26
    v_mov_b32 v219, v26
    v_mov_b32 v220, v26
    v_mov_b32 v221, v26
    v_mov_b32 v222, v26
    v_mov_b32 v223, v26
    s_cmp_eq_u32 s70, 0
    s_cbranch_scc1 K3_SKIPR
    v_mul_f32 v21, v21, v25
    v_mul_f32 v144, v144, v25
    v_mul_f32 v145, v145, v25
    v_mul_f32 v146, v146, v25
    v_mul_f32 v147, v147, v25
    v_mul_f32 v148, v148, v25
    v_mul_f32 v149, v149, v25
    v_mul_f32 v150, v150, v25
    v_mul_f32 v151, v151, v25
    v_mul_f32 v152, v152, v25
    v_mul_f32 v153, v153, v25
    v_mul_f32 v154, v154, v25
    v_mul_f32 v155, v155, v25
    v_mul_f32 v156, v156, v25
    v_mul_f32 v157, v157, v25
    v_mul_f32 v158, v158, v25
    v_mul_f32 v159, v159, v25
    v_mul_f32 v160, v160, v25
    v_mul_f32 v161, v161, v25
    v_mul_f32 v162, v162, v25
    v_mul_f32 v163, v163, v25
    v_mul_f32 v164, v164, v25
    v_mul_f32 v165, v165, v25
    v_mul_f32 v166, v166, v25
    v_mul_f32 v167, v167, v25
    v_mul_f32 v168, v168, v25
    v_mul_f32 v169, v169, v25
    v_mul_f32 v170, v170, v25
    v_mul_f32 v171, v171, v25
    v_mul_f32 v172, v172, v25
    v_mul_f32 v173, v173, v25
    v_mul_f32 v174, v174, v25
    v_mul_f32 v175, v175, v25
    v_mul_f32 v176, v176, v25
    v_mul_f32 v177, v177, v25
    v_mul_f32 v178, v178, v25
    v_mul_f32 v179, v179, v25
    v_mul_f32 v180, v180, v25
    v_mul_f32 v181, v181, v25
    v_mul_f32 v182, v182, v25
    v_mul_f32 v183, v183, v25
    v_mul_f32 v184, v184, v25
    v_mul_f32 v185, v185, v25
    v_mul_f32 v186, v186, v25
    v_mul_f32 v187, v187, v25
    v_mul_f32 v188, v188, v25
    v_mul_f32 v189, v189, v25
    v_mul_f32 v190, v190, v25
    v_mul_f32 v191, v191, v25
    v_mul_f32 v192, v192, v25
    v_mul_f32 v193, v193, v25
    v_mul_f32 v194, v194, v25
    v_mul_f32 v195, v195, v25
    v_mul_f32 v196, v196, v25
    v_mul_f32 v197, v197, v25
    v_mul_f32 v198, v198, v25
    v_mul_f32 v199, v199, v25
    v_mul_f32 v200, v200, v25
    v_mul_f32 v201, v201, v25
    v_mul_f32 v202, v202, v25
    v_mul_f32 v203, v203, v25
    v_mul_f32 v204, v204, v25
    v_mul_f32 v205, v205, v25
    v_mul_f32 v206, v206, v25
    v_mul_f32 v207, v207, v25
K3_SKIPR:
    v_exp_f32 v64, v64
    v_exp_f32 v65, v65
    v_exp_f32 v66, v66
    v_exp_f32 v67, v67
    v_exp_f32 v68, v68
    v_exp_f32 v69, v69
    v_exp_f32 v70, v70
    v_exp_f32 v71, v71
    v_exp_f32 v72, v72
    v_exp_f32 v73, v73
    v_exp_f32 v74, v74
    v_exp_f32 v75, v75
    v_exp_f32 v76, v76
    v_exp_f32 v77, v77
    v_exp_f32 v78, v78
    v_exp_f32 v79, v79
    v_exp_f32 v80, v80
    v_exp_f32 v81, v81
    v_exp_f32 v82, v82
    v_exp_f32 v83, v83
    v_exp_f32 v84, v84
    v_exp_f32 v85, v85
    v_exp_f32 v86, v86
    v_exp_f32 v87, v87
    v_exp_f32 v88, v88
    v_exp_f32 v89, v89
    v_exp_f32 v90, v90
    v_exp_f32 v91, v91
    v_exp_f32 v92, v92
    v_exp_f32 v93, v93
    v_exp_f32 v94, v94
    v_exp_f32 v95, v95
    v_add_f32 v23, v64, v65
    v_add_f32 v247, v66, v67
    v_add_f32 v23, v23, v68
    v_add_f32 v247, v247, v69
    v_add_f32 v23, v23, v70
    v_add_f32 v247, v247, v71
    v_add_f32 v23, v23, v72
    v_add_f32 v247, v247, v73
    v_add_f32 v23, v23, v74
    v_add_f32 v247, v247, v75
    v_add_f32 v23, v23, v76
    v_add_f32 v247, v247, v77
    v_add_f32 v23, v23, v78
    v_add_f32 v247, v247, v79
    v_add_f32 v23, v23, v80
    v_add_f32 v247, v247, v81
    v_add_f32 v23, v23, v82
    v_add_f32 v247, v247, v83
    v_add_f32 v23, v23, v84
    v_add_f32 v247, v247, v85
    v_add_f32 v23, v23, v86
    v_add_f32 v247, v247, v87
    v_add_f32 v23, v23, v88
    v_add_f32 v247, v247, v89
    v_add_f32 v23, v23, v90
    v_add_f32 v247, v247, v91
    v_add_f32 v23, v23, v92
    v_add_f32 v247, v247, v93
    v_add_f32 v23, v23, v94
    v_add_f32 v247, v247, v95
    v_cvt_pk_bf16_f32 v96, v64, v65
    v_cvt_pk_bf16_f32 v97, v66, v67
    v_cvt_pk_bf16_f32 v98, v68, v69
    v_cvt_pk_bf16_f32 v99, v70, v71
    v_cvt_pk_bf16_f32 v100, v72, v73
    v_cvt_pk_bf16_f32 v101, v74, v75
    v_cvt_pk_bf16_f32 v102, v76, v77
    v_cvt_pk_bf16_f32 v103, v78, v79
    v_cvt_pk_bf16_f32 v104, v80, v81
    v_cvt_pk_bf16_f32 v105, v82, v83
    v_cvt_pk_bf16_f32 v106, v84, v85
    v_cvt_pk_bf16_f32 v107, v86, v87
    v_cvt_pk_bf16_f32 v108, v88, v89
    v_cvt_pk_bf16_f32 v109, v90, v91
    v_cvt_pk_bf16_f32 v110, v92, v93
    v_cvt_pk_bf16_f32 v111, v94, v95
    v_add_f32 v21, v21, v23
    v_add_f32 v21, v21, v247
    v_mov_b32 v247, 0
    s_setprio 2
    s_branch K3_VDONE
K3_LAST:
    s_cmp_eq_u32 s84, 0
    s_cbranch_scc0 K3_LFULL
    v_xor_b32 v8, 0x4000, v8
    v_xor_b32 v9, 0x4000, v9
    v_xor_b32 v10, 0x4000, v10
    v_xor_b32 v11, 0x4000, v11
    v_xor_b32 v12, 0x4000, v12
    v_xor_b32 v13, 0x4000, v13
    v_xor_b32 v14, 0x4000, v14
    v_xor_b32 v15, 0x4000, v15
    s_branch K3_LDONE
K3_LFULL:
    s_cmp_eq_u32 s84, 2
    s_cbranch_scc1 K3_LTWO
    s_setprio 0
    s_nop 15
    v_cmp_gt_i32 s[8:9], 0, v22
    v_cmp_gt_i32 s[10:11], 1, v22
    v_cmp_gt_i32 s[12:13], 2, v22
    v_cmp_gt_i32 s[14:15], 3, v22
    v_cndmask_b32 v64, v64, v29, s[8:9]
    v_cndmask_b32 v65, v65, v29, s[10:11]
    v_cndmask_b32 v66, v66, v29, s[12:13]
    v_cndmask_b32 v67, v67, v29, s[14:15]
    v_cmp_gt_i32 s[8:9], 8, v22
    v_cmp_gt_i32 s[10:11], 9, v22
    v_cmp_gt_i32 s[12:13], 10, v22
    v_cmp_gt_i32 s[14:15], 11, v22
    v_cndmask_b32 v68, v68, v29, s[8:9]
    v_cndmask_b32 v69, v69, v29, s[10:11]
    v_cndmask_b32 v70, v70, v29, s[12:13]
    v_cndmask_b32 v71, v71, v29, s[14:15]
    v_cmp_gt_i32 s[8:9], 16, v22
    v_cmp_gt_i32 s[10:11], 17, v22
    v_cmp_gt_i32 s[12:13], 18, v22
    v_cmp_gt_i32 s[14:15], 19, v22
    v_cndmask_b32 v72, v72, v29, s[8:9]
    v_cndmask_b32 v73, v73, v29, s[10:11]
    v_cndmask_b32 v74, v74, v29, s[12:13]
    v_cndmask_b32 v75, v75, v29, s[14:15]
    v_cmp_gt_i32 s[8:9], 24, v22
    v_cmp_gt_i32 s[10:11], 25, v22
    v_cmp_gt_i32 s[12:13], 26, v22
    v_cmp_gt_i32 s[14:15], 27, v22
    v_cndmask_b32 v76, v76, v29, s[8:9]
    v_cndmask_b32 v77, v77, v29, s[10:11]
    v_cndmask_b32 v78, v78, v29, s[12:13]
    v_cndmask_b32 v79, v79, v29, s[14:15]
    v_max3_f32 v23, v64, v65, v66
    v_max3_f32 v24, v67, v68, v69
    v_max3_f32 v23, v23, v70, v71
    v_max3_f32 v24, v24, v72, v73
    v_max3_f32 v23, v23, v74, v75
    v_max3_f32 v24, v24, v76, v77
    v_max3_f32 v23, v23, v78, v79
    v_max_f32 v23, v23, v24
    v_mov_b32 v24, v23
    s_nop 1
    v_permlane32_swap_b32 v23, v24
    v_max_f32 v23, v23, v24
    s_cmp_eq_u32 s70, 0
    s_cbranch_scc1 K3_RAREH
    v_cmp_lt_f32 vcc, 0x41a00000, v23
    s_cbranch_vccz K3_SKIPH
K3_RAREH:
    s_cmp_eq_u32 s70, 0
    s_mov_b32 s101, 0
    s_cselect_b32 s72, 0xff7fffff, s101
    v_max_f32 v24, s72, v23
    v_cmp_lt_f32 vcc, 0xefa18f08, v23
    s_nop 1
    v_cndmask_b32 v24, 0, v24, vcc
    v_add_f32 v20, v20, v24
    v_sub_f32 v25, 0, v24
    v_exp_f32 v25, v25
    v_sub_f32 v26, 0, v20
    v_sub_f32 v64, v64, v24
    v_sub_f32 v65, v65, v24
    v_sub_f32 v66, v66, v24
    v_sub_f32 v67, v67, v24
    v_sub_f32 v68, v68, v24
    v_sub_f32 v69, v69, v24
    v_sub_f32 v70, v70, v24
    v_sub_f32 v71, v71, v24
    v_sub_f32 v72, v72, v24
    v_sub_f32 v73, v73, v24
    v_sub_f32 v74, v74, v24
    v_sub_f32 v75, v75, v24
    v_sub_f32 v76, v76, v24
    v_sub_f32 v77, v77, v24
    v_sub_f32 v78, v78, v24
    v_sub_f32 v79, v79, v24
    v_mov_b32 v208, v26
    v_mov_b32 v209, v26
    v_mov_b32 v210, v26
    v_mov_b32 v211, v26
    v_mov_b32 v212, v26
    v_mov_b32 v213, v26
    v_mov_b32 v214, v26
    v_mov_b32 v215, v26
    v_mov_b32 v216, v26
    v_mov_b32 v217, v26
    v_mov_b32 v218, v26
    v_mov_b32 v219, v26
    v_mov_b32 v220, v26
    v_mov_b32 v221, v26
    v_mov_b32 v222, v26
    v_mov_b32 v223, v26
    s_cmp_eq_u32 s70, 0
    s_cbranch_scc1 K3_SKIPH
    v_mul_f32 v21, v21, v25
    v_mul_f32 v144, v144, v25
    v_mul_f32 v145, v145, v25
    v_mul_f32 v146, v146, v25
    v_mul_f32 v147, v147, v25
    v_mul_f32 v148, v148, v25
    v_mul_f32 v149, v149, v25
    v_mul_f32 v150, v150, v25
    v_mul_f32 v151, v151, v25
    v_mul_f32 v152, v152, v25
    v_mul_f32 v153, v153, v25
    v_mul_f32 v154, v154, v25
    v_mul_f32 v155, v155, v25
    v_mul_f32 v156, v156, v25
    v_mul_f32 v157, v157, v25
    v_mul_f32 v158, v158, v25
    v_mul_f32 v159, v159, v25
    v_mul_f32 v160, v160, v25
    v_mul_f32 v161, v161, v25
    v_mul_f32 v162, v162, v25
    v_mul_f32 v163, v163, v25
    v_mul_f32 v164, v164, v25
    v_mul_f32 v165, v165, v25
    v_mul_f32 v166, v166, v25
    v_mul_f32 v167, v167, v25
    v_mul_f32 v168, v168, v25
    v_mul_f32 v169, v169, v25
    v_mul_f32 v170, v170, v25
    v_mul_f32 v171, v171, v25
    v_mul_f32 v172, v172, v25
    v_mul_f32 v173, v173, v25
    v_mul_f32 v174, v174, v25
    v_mul_f32 v175, v175, v25
    v_mul_f32 v176, v176, v25
    v_mul_f32 v177, v177, v25
    v_mul_f32 v178, v178, v25
    v_mul_f32 v179, v179, v25
    v_mul_f32 v180, v180, v25
    v_mul_f32 v181, v181, v25
    v_mul_f32 v182, v182, v25
    v_mul_f32 v183, v183, v25
    v_mul_f32 v184, v184, v25
    v_mul_f32 v185, v185, v25
    v_mul_f32 v186, v186, v25
    v_mul_f32 v187, v187, v25
    v_mul_f32 v188, v188, v25
    v_mul_f32 v189, v189, v25
    v_mul_f32 v190, v190, v25
    v_mul_f32 v191, v191, v25
    v_mul_f32 v192, v192, v25
    v_mul_f32 v193, v193, v25
    v_mul_f32 v194, v194, v25
    v_mul_f32 v195, v195, v25
    v_mul_f32 v196, v196, v25
    v_mul_f32 v197, v197, v25
    v_mul_f32 v198, v198, v25
    v_mul_f32 v199, v199, v25
    v_mul_f32 v200, v200, v25
    v_mul_f32 v201, v201, v25
    v_mul_f32 v202, v202, v25
    v_mul_f32 v203, v203, v25
    v_mul_f32 v204, v204, v25
    v_mul_f32 v205, v205, v25
    v_mul_f32 v206, v206, v25
    v_mul_f32 v207, v207, v25
K3_SKIPH:
    v_exp_f32 v64, v64
    v_exp_f32 v65, v65
    v_exp_f32 v66, v66
    v_exp_f32 v67, v67
    v_exp_f32 v68, v68
    v_exp_f32 v69, v69
    v_exp_f32 v70, v70
    v_exp_f32 v71, v71
    v_exp_f32 v72, v72
    v_exp_f32 v73, v73
    v_exp_f32 v74, v74
    v_exp_f32 v75, v75
    v_exp_f32 v76, v76
    v_exp_f32 v77, v77
    v_exp_f32 v78, v78
    v_exp_f32 v79, v79
    v_add_f32 v23, v64, v65
    v_add_f32 v247, v66, v67
    v_add_f32 v23, v23, v68
    v_add_f32 v247, v247, v69
    v_add_f32 v23, v23, v70
    v_add_f32 v247, v247, v71
    v_add_f32 v23, v23, v72
    v_add_f32 v247, v247, v73
    v_add_f32 v23, v23, v74
    v_add_f32 v247, v247, v75
    v_add_f32 v23, v23, v76
    v_add_f32 v247, v247, v77
    v_add_f32 v23, v23, v78
    v_add_f32 v247, v247, v79
    v_cvt_pk_bf16_f32 v96, v64, v65
    v_cvt_pk_bf16_f32 v97, v66, v67
    v_cvt_pk_bf16_f32 v98, v68, v69
    v_cvt_pk_bf16_f32 v99, v70, v71
    v_cvt_pk_bf16_f32 v100, v72, v73
    v_cvt_pk_bf16_f32 v101, v74, v75
    v_cvt_pk_bf16_f32 v102, v76, v77
    v_cvt_pk_bf16_f32 v103, v78, v79
    v_add_f32 v21, v21, v23
    v_xor_b32 v8, 0x4000, v8
    v_xor_b32 v9, 0x4000, v9
    v_xor_b32 v10, 0x4000, v10
    v_xor_b32 v11, 0x4000, v11
    v_xor_b32 v12, 0x4000, v12
    v_xor_b32 v13, 0x4000, v13
    v_xor_b32 v14, 0x4000, v14
    v_xor_b32 v15, 0x4000, v15
    v_add_f32 v21, v21, v247
    v_mov_b32 v247, 0
    s_setprio 2
    s_branch K3_LDONE
K3_LTWO:
    s_setprio 0
    s_nop 15
    v_cmp_gt_i32 s[8:9], 32, v22
    v_cmp_gt_i32 s[10:11], 33, v22
    v_cmp_gt_i32 s[12:13], 34, v22
    v_cmp_gt_i32 s[14:15], 35, v22
    v_cndmask_b32 v80, v80, v29, s[8:9]
    v_cndmask_b32 v81, v81, v29, s[10:11]
    v_cndmask_b32 v82, v82, v29, s[12:13]
    v_cndmask_b32 v83, v83, v29, s[14:15]
    v_cmp_gt_i32 s[8:9], 40, v22
    v_cmp_gt_i32 s[10:11], 41, v22
    v_cmp_gt_i32 s[12:13], 42, v22
    v_cmp_gt_i32 s[14:15], 43, v22
    v_cndmask_b32 v84, v84, v29, s[8:9]
    v_cndmask_b32 v85, v85, v29, s[10:11]
    v_cndmask_b32 v86, v86, v29, s[12:13]
    v_cndmask_b32 v87, v87, v29, s[14:15]
    v_cmp_gt_i32 s[8:9], 48, v22
    v_cmp_gt_i32 s[10:11], 49, v22
    v_cmp_gt_i32 s[12:13], 50, v22
    v_cmp_gt_i32 s[14:15], 51, v22
    v_cndmask_b32 v88, v88, v29, s[8:9]
    v_cndmask_b32 v89, v89, v29, s[10:11]
    v_cndmask_b32 v90, v90, v29, s[12:13]
    v_cndmask_b32 v91, v91, v29, s[14:15]
    v_cmp_gt_i32 s[8:9], 56, v22
    v_cmp_gt_i32 s[10:11], 57, v22
    v_cmp_gt_i32 s[12:13], 58, v22
    v_cmp_gt_i32 s[14:15], 59, v22
    v_cndmask_b32 v92, v92, v29, s[8:9]
    v_cndmask_b32 v93, v93, v29, s[10:11]
    v_cndmask_b32 v94, v94, v29, s[12:13]
    v_cndmask_b32 v95, v95, v29, s[14:15]
    v_max3_f32 v23, v64, v65, v66
    v_max3_f32 v24, v67, v68, v69
    v_max3_f32 v23, v23, v70, v71
    v_max3_f32 v24, v24, v72, v73
    v_max3_f32 v23, v23, v74, v75
    v_max3_f32 v24, v24, v76, v77
    v_max3_f32 v23, v23, v78, v79
    v_max3_f32 v24, v24, v80, v81
    v_max3_f32 v23, v23, v82, v83
    v_max3_f32 v24, v24, v84, v85
    v_max3_f32 v23, v23, v86, v87
    v_max3_f32 v24, v24, v88, v89
    v_max3_f32 v23, v23, v90, v91
    v_max3_f32 v24, v24, v92, v93
    v_max3_f32 v23, v23, v94, v95
    v_max_f32 v23, v23, v24
    v_mov_b32 v24, v23
    s_nop 1
    v_permlane32_swap_b32 v23, v24
    v_max_f32 v23, v23, v24
    s_cmp_eq_u32 s70, 0
    s_cbranch_scc1 K3_RAREC
    v_cmp_lt_f32 vcc, 0x41a00000, v23
    s_cbranch_vccz K3_SKIPC
K3_RAREC:
    s_cmp_eq_u32 s70, 0
    s_mov_b32 s101, 0
    s_cselect_b32 s72, 0xff7fffff, s101
    v_max_f32 v24, s72, v23
    v_cmp_lt_f32 vcc, 0xefa18f08, v23
    s_nop 1
    v_cndmask_b32 v24, 0, v24, vcc
    v_add_f32 v20, v20, v24
    v_sub_f32 v25, 0, v24
    v_exp_f32 v25, v25
    v_sub_f32 v26, 0, v20
    v_sub_f32 v64, v64, v24
    v_sub_f32 v65, v65, v24
    v_sub_f32 v66, v66, v24
    v_sub_f32 v67, v67, v24
    v_sub_f32 v68, v68, v24
    v_sub_f32 v69, v69, v24
    v_sub_f32 v70, v70, v24
    v_sub_f32 v71, v71, v24
    v_sub_f32 v72, v72, v24
    v_sub_f32 v73, v73, v24
    v_sub_f32 v74, v74, v24
    v_sub_f32 v75, v75, v24
    v_sub_f32 v76, v76, v24
    v_sub_f32 v77, v77, v24
    v_sub_f32 v78, v78, v24
    v_sub_f32 v79, v79, v24
    v_sub_f32 v80, v80, v24
    v_sub_f32 v81, v81, v24
    v_sub_f32 v82, v82, v24
    v_sub_f32 v83, v83, v24
    v_sub_f32 v84, v84, v24
    v_sub_f32 v85, v85, v24
    v_sub_f32 v86, v86, v24
    v_sub_f32 v87, v87, v24
    v_sub_f32 v88, v88, v24
    v_sub_f32 v89, v89, v24
    v_sub_f32 v90, v90, v24
    v_sub_f32 v91, v91, v24
    v_sub_f32 v92, v92, v24
    v_sub_f32 v93, v93, v24
    v_sub_f32 v94, v94, v24
    v_sub_f32 v95, v95, v24
    v_mov_b32 v208, v26
    v_mov_b32 v209, v26
    v_mov_b32 v210, v26
    v_mov_b32 v211, v26
    v_mov_b32 v212, v26
    v_mov_b32 v213, v26
    v_mov_b32 v214, v26
    v_mov_b32 v215, v26
    v_mov_b32 v216, v26
    v_mov_b32 v217, v26
    v_mov_b32 v218, v26
    v_mov_b32 v219, v26
    v_mov_b32 v220, v26
    v_mov_b32 v221, v26
    v_mov_b32 v222, v26
    v_mov_b32 v223, v26
    s_cmp_eq_u32 s70, 0
    s_cbranch_scc1 K3_SKIPC
    v_mul_f32 v21, v21, v25
    v_mul_f32 v144, v144, v25
    v_mul_f32 v145, v145, v25
    v_mul_f32 v146, v146, v25
    v_mul_f32 v147, v147, v25
    v_mul_f32 v148, v148, v25
    v_mul_f32 v149, v149, v25
    v_mul_f32 v150, v150, v25
    v_mul_f32 v151, v151, v25
    v_mul_f32 v152, v152, v25
    v_mul_f32 v153, v153, v25
    v_mul_f32 v154, v154, v25
    v_mul_f32 v155, v155, v25
    v_mul_f32 v156, v156, v25
    v_mul_f32 v157, v157, v25
    v_mul_f32 v158, v158, v25
    v_mul_f32 v159, v159, v25
    v_mul_f32 v160, v160, v25
    v_mul_f32 v161, v161, v25
    v_mul_f32 v162, v162, v25
    v_mul_f32 v163, v163, v25
    v_mul_f32 v164, v164, v25
    v_mul_f32 v165, v165, v25
    v_mul_f32 v166, v166, v25
    v_mul_f32 v167, v167, v25
    v_mul_f32 v168, v168, v25
    v_mul_f32 v169, v169, v25
    v_mul_f32 v170, v170, v25
    v_mul_f32 v171, v171, v25
    v_mul_f32 v172, v172, v25
    v_mul_f32 v173, v173, v25
    v_mul_f32 v174, v174, v25
    v_mul_f32 v175, v175, v25
    v_mul_f32 v176, v176, v25
    v_mul_f32 v177, v177, v25
    v_mul_f32 v178, v178, v25
    v_mul_f32 v179, v179, v25
    v_mul_f32 v180, v180, v25
    v_mul_f32 v181, v181, v25
    v_mul_f32 v182, v182, v25
    v_mul_f32 v183, v183, v25
    v_mul_f32 v184, v184, v25
    v_mul_f32 v185, v185, v25
    v_mul_f32 v186, v186, v25
    v_mul_f32 v187, v187, v25
    v_mul_f32 v188, v188, v25
    v_mul_f32 v189, v189, v25
    v_mul_f32 v190, v190, v25
    v_mul_f32 v191, v191, v25
    v_mul_f32 v192, v192, v25
    v_mul_f32 v193, v193, v25
    v_mul_f32 v194, v194, v25
    v_mul_f32 v195, v195, v25
    v_mul_f32 v196, v196, v25
    v_mul_f32 v197, v197, v25
    v_mul_f32 v198, v198, v25
    v_mul_f32 v199, v199, v25
    v_mul_f32 v200, v200, v25
    v_mul_f32 v201, v201, v25
    v_mul_f32 v202, v202, v25
    v_mul_f32 v203, v203, v25
    v_mul_f32 v204, v204, v25
    v_mul_f32 v205, v205, v25
    v_mul_f32 v206, v206, v25
    v_mul_f32 v207, v207, v25
K3_SKIPC:
    v_exp_f32 v64, v64
    v_exp_f32 v65, v65
    v_exp_f32 v66, v66
    v_exp_f32 v67, v67
    v_exp_f32 v68, v68
    v_exp_f32 v69, v69
    v_exp_f32 v70, v70
    v_exp_f32 v71, v71
    v_exp_f32 v72, v72
    v_exp_f32 v73, v73
    v_exp_f32 v74, v74
    v_exp_f32 v75, v75
    v_exp_f32 v76, v76
    v_exp_f32 v77, v77
    v_exp_f32 v78, v78
    v_exp_f32 v79, v79
    v_exp_f32 v80, v80
    v_exp_f32 v81, v81
    v_exp_f32 v82, v82
    v_exp_f32 v83, v83
    v_exp_f32 v84, v84
    v_exp_f32 v85, v85
    v_exp_f32 v86, v86
    v_exp_f32 v87, v87
    v_exp_f32 v88, v88
    v_exp_f32 v89, v89
    v_exp_f32 v90, v90
    v_exp_f32 v91, v91
    v_exp_f32 v92, v92
    v_exp_f32 v93, v93
    v_exp_f32 v94, v94
    v_exp_f32 v95, v95
    v_add_f32 v23, v64, v65
    v_add_f32 v247, v66, v67
    v_add_f32 v23, v23, v68
    v_add_f32 v247, v247, v69
    v_add_f32 v23, v23, v70
    v_add_f32 v247, v247, v71
    v_add_f32 v23, v23, v72
    v_add_f32 v247, v247, v73
    v_add_f32 v23, v23, v74
    v_add_f32 v247, v247, v75
    v_add_f32 v23, v23, v76
    v_add_f32 v247, v247, v77
    v_add_f32 v23, v23, v78
    v_add_f32 v247, v247, v79
    v_add_f32 v23, v23, v80
    v_add_f32 v247, v247, v81
    v_add_f32 v23, v23, v82
    v_add_f32 v247, v247, v83
    v_add_f32 v23, v23, v84
    v_add_f32 v247, v247, v85
    v_add_f32 v23, v23, v86
    v_add_f32 v247, v247, v87
    v_add_f32 v23, v23, v88
    v_add_f32 v247, v247, v89
    v_add_f32 v23, v23, v90
    v_add_f32 v247, v247, v91
    v_add_f32 v23, v23, v92
    v_add_f32 v247, v247, v93
    v_add_f32 v23, v23, v94
    v_add_f32 v247, v247, v95
    v_cvt_pk_bf16_f32 v96, v64, v65
    v_cvt_pk_bf16_f32 v97, v66, v67
    v_cvt_pk_bf16_f32 v98, v68, v69
    v_cvt_pk_bf16_f32 v99, v70, v71
    v_cvt_pk_bf16_f32 v100, v72, v73
    v_cvt_pk_bf16_f32 v101, v74, v75
    v_cvt_pk_bf16_f32 v102, v76, v77
    v_cvt_pk_bf16_f32 v103, v78, v79
    v_cvt_pk_bf16_f32 v104, v80, v81
    v_cvt_pk_bf16_f32 v105, v82, v83
    v_cvt_pk_bf16_f32 v106, v84, v85
    v_cvt_pk_bf16_f32 v107, v86, v87
    v_cvt_pk_bf16_f32 v108, v88, v89
    v_cvt_pk_bf16_f32 v109, v90, v91
    v_cvt_pk_bf16_f32 v110, v92, v93
    v_cvt_pk_bf16_f32 v111, v94, v95
    v_add_f32 v21, v21, v23
    v_xor_b32 v8, 0x4000, v8
    v_xor_b32 v9, 0x4000, v9
    v_xor_b32 v10, 0x4000, v10
    v_xor_b32 v11, 0x4000, v11
    v_xor_b32 v12, 0x4000, v12
    v_xor_b32 v13, 0x4000, v13
    v_xor_b32 v14, 0x4000, v14
    v_xor_b32 v15, 0x4000, v15
    v_add_f32 v21, v21, v247
    v_mov_b32 v247, 0
    s_setprio 2
K3_LDONE:
    s_waitcnt vmcnt(0)
    s_barrier
K3_FINAL:
    s_cmp_eq_u32 s82, 1
    s_cbranch_scc0 K3_NOTCH
    s_lshl_b32 s72, s2, 9
    v_add_u32 v72, s72, v0
    v_lshlrev_b32 v72, 6, v72
    s_mov_b32 s44, s26
    s_and_b32 s45, s27, 0xffff
    s_mov_b32 s46, 0x400000
    s_mov_b32 s47, 0x20000
    s_mov_b32 s8, s34
    s_and_b32 s9, s35, 0xffff
    s_mov_b32 s10, 0x1c0000
    s_mov_b32 s11, 0x20000
    v_subrev_u32 v73, 0x400000, v72
    buffer_load_dword v74, v72, s[44:47], 0 offen
    buffer_load_dword v74, v73, s[8:11], 0 offen
K3_NOTCH:
    s_xor_b32 s72, s65, 1
    s_lshl_b32 s72, s72, 16
    s_sub_u32 s72, 98304, s72
    v_add_u32 v64, s72, v242
    v_add_u32 v65, s72, v243
    v_add_u32 v66, s72, v244
    v_add_u32 v67, s72, v245
    s_cmp_eq_u32 s84, 2
    s_cbranch_scc1 K3_FFULL
    s_cmp_eq_u32 s84, 0
    s_cbranch_scc1 K3_FNONE
    ds_read_b64_tr_b16 v[112:113], v16 offset:0
    ds_read_b64_tr_b16 v[114:115], v16 offset:2048
    ds_read_b64_tr_b16 v[116:117], v17 offset:0
    ds_read_b64_tr_b16 v[118:119], v17 offset:2048
    ds_read_b64_tr_b16 v[120:121], v18 offset:0
    ds_read_b64_tr_b16 v[122:123], v18 offset:2048
    ds_read_b64_tr_b16 v[124:125], v19 offset:0
    ds_read_b64_tr_b16 v[126:127], v19 offset:2048
    ds_read_b64_tr_b16 v[128:129], v16 offset:4096
    ds_read_b64_tr_b16 v[130:131], v16 offset:6144
    s_waitcnt lgkmcnt(8)
    v_mfma_f32_32x32x16_bf16 v[144:159], v[112:115], v[96:99], v[144:159]
    ds_read_b64_tr_b16 v[132:133], v17 offset:4096
    ds_read_b64_tr_b16 v[134:135], v17 offset:6144
    s_waitcnt lgkmcnt(8)
    v_mfma_f32_32x32x16_bf16 v[160:175], v[116:119], v[96:99], v[160:175]
    ds_read_b64_tr_b16 v[136:137], v18 offset:4096
    ds_read_b64_tr_b16 v[138:139], v18 offset:6144
    ds_read_b128 v[32:35], v64 offset:0
    ds_read_b128 v[36:39], v65 offset:0
    s_waitcnt lgkmcnt(10)
    v_mfma_f32_32x32x16_bf16 v[176:191], v[120:123], v[96:99], v[176:191]
    ds_read_b64_tr_b16 v[140:141], v19 offset:4096
    ds_read_b64_tr_b16 v[142:143], v19 offset:6144
    s_waitcnt lgkmcnt(10)
    v_mfma_f32_32x32x16_bf16 v[192:207], v[124:127], v[96:99], v[192:207]
    ds_read_b128 v[40:43], v66 offset:0
    ds_read_b128 v[44:47], v67 offset:0
    s_waitcnt lgkmcnt(10)
    v_mfma_f32_32x32x16_bf16 v[144:159], v[128:131], v[100:103], v[144:159]
    s_waitcnt lgkmcnt(8)
    v_mfma_f32_32x32x16_bf16 v[160:175], v[132:135], v[100:103], v[160:175]
    ds_read_b128 v[48:51], v64 offset:4096
    ds_read_b128 v[52:55], v65 offset:4096
    s_waitcnt lgkmcnt(8)
    v_mfma_f32_32x32x16_bf16 v[176:191], v[136:139], v[100:103], v[176:191]
    s_waitcnt lgkmcnt(4)
    v_mfma_f32_32x32x16_bf16 v[192:207], v[140:143], v[100:103], v[192:207]
    ds_read_b128 v[56:59], v66 offset:4096
    ds_read_b128 v[60:63], v67 offset:4096
    s_branch K3_FDONE
K3_FNONE:
    ds_read_b128 v[32:35], v64 offset:0
    ds_read_b128 v[36:39], v65 offset:0
    ds_read_b128 v[40:43], v66 offset:0
    ds_read_b128 v[44:47], v67 offset:0
    ds_read_b128 v[48:51], v64 offset:4096
    ds_read_b128 v[52:55], v65 offset:4096
    ds_read_b128 v[56:59], v66 offset:4096
    ds_read_b128 v[60:63], v67 offset:4096
    s_branch K3_FDONE
K3_FFULL:
    ds_read_b64_tr_b16 v[112:113], v16 offset:0
    ds_read_b64_tr_b16 v[114:115], v16 offset:2048
    ds_read_b64_tr_b16 v[116:117], v17 offset:0
    ds_read_b64_tr_b16 v[118:119], v17 offset:2048
    ds_read_b64_tr_b16 v[120:121], v18 offset:0
    ds_read_b64_tr_b16 v[122:123], v18 offset:2048
    ds_read_b64_tr_b16 v[124:125], v19 offset:0
    ds_read_b64_tr_b16 v[126:127], v19 offset:2048
    ds_read_b64_tr_b16 v[128:129], v16 offset:4096
    ds_read_b64_tr_b16 v[130:131], v16 offset:6144
    s_waitcnt lgkmcnt(8)
    v_mfma_f32_32x32x16_bf16 v[144:159], v[112:115], v[96:99], v[144:159]
    ds_read_b64_tr_b16 v[132:133], v17 offset:4096
    ds_read_b64_tr_b16 v[134:135], v17 offset:6144
    s_waitcnt lgkmcnt(8)
    v_mfma_f32_32x32x16_bf16 v[160:175], v[116:119], v[96:99], v[160:175]
    ds_read_b64_tr_b16 v[136:137], v18 offset:4096
    ds_read_b64_tr_b16 v[138:139], v18 offset:6144
    ds_read_b128 v[32:35], v64 offset:0
    s_waitcnt lgkmcnt(9)
    v_mfma_f32_32x32x16_bf16 v[176:191], v[120:123], v[96:99], v[176:191]
    ds_read_b64_tr_b16 v[140:141], v19 offset:4096
    ds_read_b64_tr_b16 v[142:143], v19 offset:6144
    s_waitcnt lgkmcnt(9)
    v_mfma_f32_32x32x16_bf16 v[192:207], v[124:127], v[96:99], v[192:207]
    ds_read_b64_tr_b16 v[112:113], v16 offset:8192
    ds_read_b64_tr_b16 v[114:115], v16 offset:10240
    ds_read_b128 v[36:39], v65 offset:0
    s_waitcnt lgkmcnt(10)
    v_mfma_f32_32x32x16_bf16 v[144:159], v[128:131], v[100:103], v[144:159]
    ds_read_b64_tr_b16 v[116:117], v17 offset:8192
    ds_read_b64_tr_b16 v[118:119], v17 offset:10240
    s_waitcnt lgkmcnt(10)
    v_mfma_f32_32x32x16_bf16 v[160:175], v[132:135], v[100:103], v[160:175]
    ds_read_b64_tr_b16 v[120:121], v18 offset:8192
    ds_read_b64_tr_b16 v[122:123], v18 offset:10240
    ds_read_b128 v[40:43], v66 offset:0
    s_waitcnt lgkmcnt(11)
    v_mfma_f32_32x32x16_bf16 v[176:191], v[136:139], v[100:103], v[176:191]
    ds_read_b64_tr_b16 v[124:125], v19 offset:8192
    ds_read_b64_tr_b16 v[126:127], v19 offset:10240
    s_waitcnt lgkmcnt(10)
    v_mfma_f32_32x32x16_bf16 v[192:207], v[140:143], v[100:103], v[192:207]
    ds_read_b64_tr_b16 v[128:129], v16 offset:12288
    ds_read_b64_tr_b16 v[130:131], v16 offset:14336
    ds_read_b128 v[44:47], v67 offset:0
    s_waitcnt lgkmcnt(11)
    v_mfma_f32_32x32x16_bf16 v[144:159], v[112:115], v[104:107], v[144:159]
    ds_read_b64_tr_b16 v[132:133], v17 offset:12288
    ds_read_b64_tr_b16 v[134:135], v17 offset:14336
    s_waitcnt lgkmcnt(10)
    v_mfma_f32_32x32x16_bf16 v[160:175], v[116:119], v[104:107], v[160:175]
    ds_read_b64_tr_b16 v[136:137], v18 offset:12288
    ds_read_b64_tr_b16 v[138:139], v18 offset:14336
    ds_read_b128 v[48:51], v64 offset:4096
    s_waitcnt lgkmcnt(11)
    v_mfma_f32_32x32x16_bf16 v[176:191], v[120:123], v[104:107], v[176:191]
    ds_read_b64_tr_b16 v[140:141], v19 offset:12288
    ds_read_b64_tr_b16 v[142:143], v19 offset:14336
    s_waitcnt lgkmcnt(10)
    v_mfma_f32_32x32x16_bf16 v[192:207], v[124:127], v[104:107], v[192:207]
    ds_read_b128 v[52:55], v65 offset:4096
    s_waitcnt lgkmcnt(9)
    v_mfma_f32_32x32x16_bf16 v[144:159], v[128:131], v[108:111], v[144:159]
    s_waitcnt lgkmcnt(6)
    v_mfma_f32_32x32x16_bf16 v[160:175], v[132:135], v[108:111], v[160:175]
    ds_read_b128 v[56:59], v66 offset:4096
    s_waitcnt lgkmcnt(5)
    v_mfma_f32_32x32x16_bf16 v[176:191], v[136:139], v[108:111], v[176:191]
    s_waitcnt lgkmcnt(2)
    v_mfma_f32_32x32x16_bf16 v[192:207], v[140:143], v[108:111], v[192:207]
    ds_read_b128 v[60:63], v67 offset:4096
K3_FDONE:
    v_xor_b32 v16, 0x4000, v16
    v_xor_b32 v17, 0x4000, v17
    v_xor_b32 v18, 0x4000, v18
    v_xor_b32 v19, 0x4000, v19
    v_lshlrev_b32 v31, 3, v1
    v_add_u32 v31, s80, v31
    s_barrier
    s_cmp_eq_u32 s65, 0
    s_cbranch_scc0 K3_NOSTAG2
    s_nop 15
    v_mov_b32 v26, v21
    v_mov_b32 v23, v21
    s_nop 1
    v_permlane32_swap_b32 v26, v23
    v_add_f32 v21, v26, v23
    ds_write_b128 v30, v[176:179] offset:0
    ds_write_b128 v30, v[180:183] offset:1024
    ds_write_b128 v30, v[184:187] offset:2048
    ds_write_b128 v30, v[188:191] offset:3072
    ds_write_b128 v30, v[192:195] offset:4096
    ds_write_b128 v30, v[196:199] offset:5120
    ds_write_b128 v30, v[200:203] offset:6144
    ds_write_b128 v30, v[204:207] offset:7168
    ds_write_b64 v31, v[20:21]
    s_waitcnt lgkmcnt(0)
    s_barrier
K3_NOSTAG2:
    s_nop 15
    s_lshl_b32 s72, s69, 7
    s_lshl_b32 s73, s66, 5
    s_add_u32 s72, s72, s73
    s_lshl_b32 s73, s72, 6
    s_lshl_b32 s72, s67, 19
    s_add_u32 s73, s73, s72
    s_lshl_b32 s72, s65, 18
    s_add_u32 s73, s73, s72
    s_cmp_eq_u32 s65, 1
    s_cbranch_scc1 K3_MERGE1
    s_barrier
    v_xor_b32 v25, 0x10000, v30
    v_xor_b32 v24, 0x10000, v31
    ds_read_b128 v[208:211], v25 offset:0
    ds_read_b128 v[212:215], v25 offset:1024
    ds_read_b128 v[216:219], v25 offset:2048
    ds_read_b128 v[220:223], v25 offset:3072
    ds_read_b128 v[224:227], v25 offset:4096
    ds_read_b128 v[228:231], v25 offset:5120
    ds_read_b128 v[232:235], v25 offset:6144
    ds_read_b128 v[236:239], v25 offset:7168
    ds_read_b64 v[240:241], v24
    s_waitcnt lgkmcnt(0)
    v_mov_b32 v26, 0xff7fffff
    v_cmp_lt_f32 vcc, 0, v21
    s_nop 1
    v_cndmask_b32 v20, v26, v20, vcc
    v_cmp_lt_f32 vcc, 0, v241
    s_nop 1
    v_cndmask_b32 v240, v26, v240, vcc
    v_max_f32 v23, v20, v240
    v_sub_f32 v24, v20, v23
    v_sub_f32 v25, v240, v23
    v_exp_f32 v24, v24
    v_exp_f32 v25, v25
    v_mul_f32 v21, v21, v24
    v_fmac_f32 v21, v241, v25
    v_rcp_f32 v21, v21
    s_nop 0
    v_mul_f32 v24, v24, v21
    v_mul_f32 v25, v25, v21
    v_mul_f32 v144, v144, v24
    v_fmac_f32 v144, v208, v25
    v_mul_f32 v145, v145, v24
    v_fmac_f32 v145, v209, v25
    v_mul_f32 v146, v146, v24
    v_fmac_f32 v146, v210, v25
    v_mul_f32 v147, v147, v24
    v_fmac_f32 v147, v211, v25
    v_mul_f32 v148, v148, v24
    v_fmac_f32 v148, v212, v25
    v_mul_f32 v149, v149, v24
    v_fmac_f32 v149, v213, v25
    v_mul_f32 v150, v150, v24
    v_fmac_f32 v150, v214, v25
    v_mul_f32 v151, v151, v24
    v_fmac_f32 v151, v215, v25
    v_mul_f32 v152, v152, v24
    v_fmac_f32 v152, v216, v25
    v_mul_f32 v153, v153, v24
    v_fmac_f32 v153, v217, v25
    v_mul_f32 v154, v154, v24
    v_fmac_f32 v154, v218, v25
    v_mul_f32 v155, v155, v24
    v_fmac_f32 v155, v219, v25
    v_mul_f32 v156, v156, v24
    v_fmac_f32 v156, v220, v25
    v_mul_f32 v157, v157, v24
    v_fmac_f32 v157, v221, v25
    v_mul_f32 v158, v158, v24
    v_fmac_f32 v158, v222, v25
    v_mul_f32 v159, v159, v24
    v_fmac_f32 v159, v223, v25
    v_mul_f32 v160, v160, v24
    v_fmac_f32 v160, v224, v25
    v_mul_f32 v161, v161, v24
    v_fmac_f32 v161, v225, v25
    v_mul_f32 v162, v162, v24
    v_fmac_f32 v162, v226, v25
    v_mul_f32 v163, v163, v24
    v_fmac_f32 v163, v227, v25
    v_mul_f32 v164, v164, v24
    v_fmac_f32 v164, v228, v25
    v_mul_f32 v165, v165, v24
    v_fmac_f32 v165, v229, v25
    v_mul_f32 v166, v166, v24
    v_fmac_f32 v166, v230, v25
    v_mul_f32 v167, v167, v24
    v_fmac_f32 v167, v231, v25
    v_mul_f32 v168, v168, v24
    v_fmac_f32 v168, v232, v25
    v_mul_f32 v169, v169, v24
    v_fmac_f32 v169, v233, v25
    v_mul_f32 v170, v170, v24
    v_fmac_f32 v170, v234, v25
    v_mul_f32 v171, v171, v24
    v_fmac_f32 v171, v235, v25
    v_mul_f32 v172, v172, v24
    v_fmac_f32 v172, v236, v25
    v_mul_f32 v173, v173, v24
    v_fmac_f32 v173, v237, v25
    v_mul_f32 v174, v174, v24
    v_fmac_f32 v174, v238, v25
    v_mul_f32 v175, v175, v24
    v_fmac_f32 v175, v239, v25
    v_cvt_pk_bf16_f32 v112, v144, v145
    v_cvt_pk_bf16_f32 v113, v146, v147
    v_cvt_pk_bf16_f32 v114, v148, v149
    v_cvt_pk_bf16_f32 v115, v150, v151
    v_cvt_pk_bf16_f32 v116, v152, v153
    v_cvt_pk_bf16_f32 v117, v154, v155
    v_cvt_pk_bf16_f32 v118, v156, v157
    v_cvt_pk_bf16_f32 v119, v158, v159
    v_permlane32_swap_b32 v112, v114
    v_permlane32_swap_b32 v113, v115
    ds_write_b128 v242, v[112:115]
    v_permlane32_swap_b32 v116, v118
    v_permlane32_swap_b32 v117, v119
    ds_write_b128 v243, v[116:119]
    v_cvt_pk_bf16_f32 v120, v160, v161
    v_cvt_pk_bf16_f32 v121, v162, v163
    v_cvt_pk_bf16_f32 v122, v164, v165
    v_cvt_pk_bf16_f32 v123, v166, v167
    v_cvt_pk_bf16_f32 v124, v168, v169
    v_cvt_pk_bf16_f32 v125, v170, v171
    v_cvt_pk_bf16_f32 v126, v172, v173
    v_cvt_pk_bf16_f32 v127, v174, v175
    v_permlane32_swap_b32 v120, v122
    v_permlane32_swap_b32 v121, v123
    ds_write_b128 v244, v[120:123]
    v_permlane32_swap_b32 v124, v126
    v_permlane32_swap_b32 v125, v127
    ds_write_b128 v245, v[124:127]
    ds_read_b128 v[128:131], v246 offset:0
    ds_read_b128 v[132:135], v246 offset:1024
    ds_read_b128 v[136:139], v246 offset:2048
    ds_read_b128 v[140:143], v246 offset:3072
    s_waitcnt lgkmcnt(3)
    buffer_store_dwordx4 v[128:131], v7, s[56:59], s73 offen sc1
    s_add_u32 s73, s73, 512
    s_waitcnt lgkmcnt(2)
    buffer_store_dwordx4 v[132:135], v7, s[56:59], s73 offen sc1
    s_add_u32 s73, s73, 512
    s_waitcnt lgkmcnt(1)
    buffer_store_dwordx4 v[136:139], v7, s[56:59], s73 offen sc1
    s_add_u32 s73, s73, 512
    s_waitcnt lgkmcnt(0)
    buffer_store_dwordx4 v[140:143], v7, s[56:59], s73 offen sc1
    s_branch K3_MERGED
K3_MERGE1:
    v_xor_b32 v25, 0x10000, v30
    v_xor_b32 v24, 0x10000, v31
    ds_read_b128 v[208:211], v25 offset:0
    ds_read_b128 v[212:215], v25 offset:1024
    ds_read_b128 v[216:219], v25 offset:2048
    ds_read_b128 v[220:223], v25 offset:3072
    ds_read_b128 v[224:227], v25 offset:4096
    ds_read_b128 v[228:231], v25 offset:5120
    ds_read_b128 v[232:235], v25 offset:6144
    ds_read_b128 v[236:239], v25 offset:7168
    ds_read_b64 v[240:241], v24
    v_mov_b32 v26, v21
    v_mov_b32 v23, v21
    s_nop 1
    v_permlane32_swap_b32 v26, v23
    v_add_f32 v21, v26, v23
    ds_write_b128 v30, v[144:147] offset:0
    ds_write_b128 v30, v[148:151] offset:1024
    ds_write_b128 v30, v[152:155] offset:2048
    ds_write_b128 v30, v[156:159] offset:3072
    ds_write_b128 v30, v[160:163] offset:4096
    ds_write_b128 v30, v[164:167] offset:5120
    ds_write_b128 v30, v[168:171] offset:6144
    ds_write_b128 v30, v[172:175] offset:7168
    ds_write_b64 v31, v[20:21]
    s_waitcnt lgkmcnt(0)
    s_barrier
    v_mov_b32 v26, 0xff7fffff
    v_cmp_lt_f32 vcc, 0, v21
    s_nop 1
    v_cndmask_b32 v20, v26, v20, vcc
    v_cmp_lt_f32 vcc, 0, v241
    s_nop 1
    v_cndmask_b32 v240, v26, v240, vcc
    v_max_f32 v23, v20, v240
    v_sub_f32 v24, v20, v23
    v_sub_f32 v25, v240, v23
    v_exp_f32 v24, v24
    v_exp_f32 v25, v25
    v_mul_f32 v21, v21, v24
    v_fmac_f32 v21, v241, v25
    v_rcp_f32 v21, v21
    s_nop 0
    v_mul_f32 v24, v24, v21
    v_mul_f32 v25, v25, v21
    v_mul_f32 v176, v176, v24
    v_fmac_f32 v176, v208, v25
    v_mul_f32 v177, v177, v24
    v_fmac_f32 v177, v209, v25
    v_mul_f32 v178, v178, v24
    v_fmac_f32 v178, v210, v25
    v_mul_f32 v179, v179, v24
    v_fmac_f32 v179, v211, v25
    v_mul_f32 v180, v180, v24
    v_fmac_f32 v180, v212, v25
    v_mul_f32 v181, v181, v24
    v_fmac_f32 v181, v213, v25
    v_mul_f32 v182, v182, v24
    v_fmac_f32 v182, v214, v25
    v_mul_f32 v183, v183, v24
    v_fmac_f32 v183, v215, v25
    v_mul_f32 v184, v184, v24
    v_fmac_f32 v184, v216, v25
    v_mul_f32 v185, v185, v24
    v_fmac_f32 v185, v217, v25
    v_mul_f32 v186, v186, v24
    v_fmac_f32 v186, v218, v25
    v_mul_f32 v187, v187, v24
    v_fmac_f32 v187, v219, v25
    v_mul_f32 v188, v188, v24
    v_fmac_f32 v188, v220, v25
    v_mul_f32 v189, v189, v24
    v_fmac_f32 v189, v221, v25
    v_mul_f32 v190, v190, v24
    v_fmac_f32 v190, v222, v25
    v_mul_f32 v191, v191, v24
    v_fmac_f32 v191, v223, v25
    v_mul_f32 v192, v192, v24
    v_fmac_f32 v192, v224, v25
    v_mul_f32 v193, v193, v24
    v_fmac_f32 v193, v225, v25
    v_mul_f32 v194, v194, v24
    v_fmac_f32 v194, v226, v25
    v_mul_f32 v195, v195, v24
    v_fmac_f32 v195, v227, v25
    v_mul_f32 v196, v196, v24
    v_fmac_f32 v196, v228, v25
    v_mul_f32 v197, v197, v24
    v_fmac_f32 v197, v229, v25
    v_mul_f32 v198, v198, v24
    v_fmac_f32 v198, v230, v25
    v_mul_f32 v199, v199, v24
    v_fmac_f32 v199, v231, v25
    v_mul_f32 v200, v200, v24
    v_fmac_f32 v200, v232, v25
    v_mul_f32 v201, v201, v24
    v_fmac_f32 v201, v233, v25
    v_mul_f32 v202, v202, v24
    v_fmac_f32 v202, v234, v25
    v_mul_f32 v203, v203, v24
    v_fmac_f32 v203, v235, v25
    v_mul_f32 v204, v204, v24
    v_fmac_f32 v204, v236, v25
    v_mul_f32 v205, v205, v24
    v_fmac_f32 v205, v237, v25
    v_mul_f32 v206, v206, v24
    v_fmac_f32 v206, v238, v25
    v_mul_f32 v207, v207, v24
    v_fmac_f32 v207, v239, v25
    v_cvt_pk_bf16_f32 v112, v176, v177
    v_cvt_pk_bf16_f32 v113, v178, v179
    v_cvt_pk_bf16_f32 v114, v180, v181
    v_cvt_pk_bf16_f32 v115, v182, v183
    v_cvt_pk_bf16_f32 v116, v184, v185
    v_cvt_pk_bf16_f32 v117, v186, v187
    v_cvt_pk_bf16_f32 v118, v188, v189
    v_cvt_pk_bf16_f32 v119, v190, v191
    v_permlane32_swap_b32 v112, v114
    v_permlane32_swap_b32 v113, v115
    ds_write_b128 v242, v[112:115]
    v_permlane32_swap_b32 v116, v118
    v_permlane32_swap_b32 v117, v119
    ds_write_b128 v243, v[116:119]
    v_cvt_pk_bf16_f32 v120, v192, v193
    v_cvt_pk_bf16_f32 v121, v194, v195
    v_cvt_pk_bf16_f32 v122, v196, v197
    v_cvt_pk_bf16_f32 v123, v198, v199
    v_cvt_pk_bf16_f32 v124, v200, v201
    v_cvt_pk_bf16_f32 v125, v202, v203
    v_cvt_pk_bf16_f32 v126, v204, v205
    v_cvt_pk_bf16_f32 v127, v206, v207
    v_permlane32_swap_b32 v120, v122
    v_permlane32_swap_b32 v121, v123
    ds_write_b128 v244, v[120:123]
    v_permlane32_swap_b32 v124, v126
    v_permlane32_swap_b32 v125, v127
    ds_write_b128 v245, v[124:127]
    ds_read_b128 v[128:131], v246 offset:0
    ds_read_b128 v[132:135], v246 offset:1024
    ds_read_b128 v[136:139], v246 offset:2048
    ds_read_b128 v[140:143], v246 offset:3072
    s_waitcnt lgkmcnt(3)
    buffer_store_dwordx4 v[128:131], v7, s[56:59], s73 offen sc1
    s_add_u32 s73, s73, 512
    s_waitcnt lgkmcnt(2)
    buffer_store_dwordx4 v[132:135], v7, s[56:59], s73 offen sc1
    s_add_u32 s73, s73, 512
    s_waitcnt lgkmcnt(1)
    buffer_store_dwordx4 v[136:139], v7, s[56:59], s73 offen sc1
    s_add_u32 s73, s73, 512
    s_waitcnt lgkmcnt(0)
    buffer_store_dwordx4 v[140:143], v7, s[56:59], s73 offen sc1
K3_MERGED:
    s_nop 7
    s_cmp_eq_u32 s82, 1
    s_cbranch_scc1 K3_PEND
    s_mov_b32 s82, 1
    s_mov_b32 s69, s68
    s_mov_b32 s74, 0x7ff00000
    s_branch K3_PASS
K3_PEND:
K3_END:
    s_endpgm
.text
.globl k4_out_kernel
.p2align 8
.type k4_out_kernel,@function
k4_out_kernel:
    s_cmp_ge_u32 s2, 256
    s_cbranch_scc1 K4_END
    s_load_dwordx16 s[16:31], s[0:1], 0
    s_load_dwordx8 s[32:39], s[0:1], 64
    s_load_dwordx4 s[40:43], s[0:1], 96
    s_and_b32 s3, s2, 7
    s_lshr_b32 s4, s2, 3
    s_and_b32 s5, s4, 3
    s_lshr_b32 s4, s4, 2
    s_and_b32 s6, s3, 1
    s_lshl_b32 s6, s6, 3
    s_add_u32 s4, s4, s6
    s_lshr_b32 s3, s3, 1
    s_mov_b32 s51, 0x20000
    s_mul_i32 s6, s3, 1472
    s_lshl_b32 s65, s4, 13
    s_lshl_b32 s72, s6, 12
    s_add_u32 s65, s65, s72
    s_lshl_b32 s7, s5, 8
    s_mov_b32 s67, 1024
    s_mov_b32 s68, 0
    v_and_b32 v1, 63, v0
    v_lshrrev_b32 v14, 6, v0
    s_nop 0
    v_readfirstlane_b32 s64, v14
    s_and_b32 s69, s64, 1
    s_lshr_b32 s70, s64, 1
    v_lshrrev_b32 v14, 2, v1
    s_lshl_b32 s72, s64, 4
    v_add_u32 v14, s72, v14
    s_mov_b32 s73, 64
    v_mul_lo_u32 v14, v14, s73
    v_lshrrev_b32 v15, 4, v1
    v_and_b32 v16, 3, v1
    v_xor_b32 v15, v15, v16
    v_lshl_add_u32 v2, v15, 4, v14
    v_add_u32 v3, 1024, v2
    v_lshrrev_b32 v14, 4, v1
    s_lshl_b32 s72, s64, 2
    v_add_u32 v15, s72, v14
    v_mul_lo_u32 v15, v15, s67
    v_bfe_u32 v16, v1, 2, 2
    v_and_b32 v17, 3, v1
    v_xor_b32 v18, v16, v14
    v_lshlrev_b32 v18, 6, v18
    v_lshl_add_u32 v18, v17, 4, v18
    v_add_u32 v4, v15, v18
    v_mov_b32 v5, v4
    s_lshl_b32 s71, s64, 10
    s_lshl_b32 s74, s64, 10
    s_waitcnt lgkmcnt(0)
    s_add_u32 s44, s42, 0x4000000
    s_addc_u32 s45, s43, 0
    s_and_b32 s45, s45, 0xffff
    s_mov_b32 s46, 0x1700000
    s_mov_b32 s47, 0x20000
    s_add_u32 s52, s42, 0x6000000
    s_addc_u32 s53, s43, 0
    s_and_b32 s53, s53, 0xffff
    s_mov_b32 s54, 0x800000
    s_mov_b32 s55, 0x20000
    s_and_b32 s27, s27, 0xffff
    s_and_b32 s35, s35, 0xffff
    s_add_u32 m0, s71, 0
    s_nop 0
    buffer_load_dwordx4 v2, s[44:47], s65 offen lds
    s_add_u32 s65, s65, 131072
    s_cmp_lt_u32 s6, 4096
    s_cselect_b32 s48, s26, s34
    s_cselect_b32 s49, s27, s35
    s_mov_b32 s101, 0x1c0000
    s_cselect_b32 s50, 0x400000, s101
    s_mov_b32 s101, 4096
    s_cselect_b32 s72, 0, s101
    s_sub_u32 s72, s6, s72
    s_lshl_b32 s66, s72, 10
    s_add_u32 s66, s66, s7
    s_add_u32 s6, s6, 32
    s_add_u32 m0, s74, 8192
    s_nop 0
    buffer_load_dwordx4 v4, s[48:51], s66 offen lds
    s_add_u32 s66, s66, s68
    s_add_u32 m0, s71, 16384
    s_nop 0
    buffer_load_dwordx4 v2, s[44:47], s65 offen lds
    s_add_u32 s65, s65, 131072
    s_cmp_lt_u32 s6, 4096
    s_cselect_b32 s48, s26, s34
    s_cselect_b32 s49, s27, s35
    s_mov_b32 s101, 0x1c0000
    s_cselect_b32 s50, 0x400000, s101
    s_mov_b32 s101, 4096
    s_cselect_b32 s72, 0, s101
    s_sub_u32 s72, s6, s72
    s_lshl_b32 s66, s72, 10
    s_add_u32 s66, s66, s7
    s_add_u32 s6, s6, 32
    s_add_u32 m0, s74, 24576
    s_nop 0
    buffer_load_dwordx4 v4, s[48:51], s66 offen lds
    s_add_u32 s66, s66, s68
    s_add_u32 m0, s71, 32768
    s_nop 0
    buffer_load_dwordx4 v2, s[44:47], s65 offen lds
    s_add_u32 s65, s65, 131072
    s_cmp_lt_u32 s6, 4096
    s_cselect_b32 s48, s26, s34
    s_cselect_b32 s49, s27, s35
    s_mov_b32 s101, 0x1c0000
    s_cselect_b32 s50, 0x400000, s101
    s_mov_b32 s101, 4096
    s_cselect_b32 s72, 0, s101
    s_sub_u32 s72, s6, s72
    s_lshl_b32 s66, s72, 10
    s_add_u32 s66, s66, s7
    s_add_u32 s6, s6, 32
    s_add_u32 m0, s74, 40960
    s_nop 0
    buffer_load_dwordx4 v4, s[48:51], s66 offen lds
    s_add_u32 s66, s66, s68
    s_add_u32 m0, s71, 49152
    s_nop 0
    buffer_load_dwordx4 v2, s[44:47], s65 offen lds
    s_add_u32 s65, s65, 131072
    s_cmp_lt_u32 s6, 4096
    s_cselect_b32 s48, s26, s34
    s_cselect_b32 s49, s27, s35
    s_mov_b32 s101, 0x1c0000
    s_cselect_b32 s50, 0x400000, s101
    s_mov_b32 s101, 4096
    s_cselect_b32 s72, 0, s101
    s_sub_u32 s72, s6, s72
    s_lshl_b32 s66, s72, 10
    s_add_u32 s66, s66, s7
    s_add_u32 s6, s6, 32
    s_add_u32 m0, s74, 57344
    s_nop 0
    buffer_load_dwordx4 v4, s[48:51], s66 offen lds
    s_add_u32 s66, s66, s68
    s_add_u32 m0, s71, 65536
    s_nop 0
    buffer_load_dwordx4 v2, s[44:47], s65 offen lds
    s_add_u32 s65, s65, 131072
    s_cmp_lt_u32 s6, 4096
    s_cselect_b32 s48, s26, s34
    s_cselect_b32 s49, s27, s35
    s_mov_b32 s101, 0x1c0000
    s_cselect_b32 s50, 0x400000, s101
    s_mov_b32 s101, 4096
    s_cselect_b32 s72, 0, s101
    s_sub_u32 s72, s6, s72
    s_lshl_b32 s66, s72, 10
    s_add_u32 s66, s66, s7
    s_add_u32 s6, s6, 32
    s_add_u32 m0, s74, 73728
    s_nop 0
    buffer_load_dwordx4 v4, s[48:51], s66 offen lds
    s_add_u32 s66, s66, s68
    s_add_u32 m0, s71, 81920
    s_nop 0
    buffer_load_dwordx4 v2, s[44:47], s65 offen lds
    s_add_u32 s65, s65, 131072
    s_cmp_lt_u32 s6, 4096
    s_cselect_b32 s48, s26, s34
    s_cselect_b32 s49, s27, s35
    s_mov_b32 s101, 0x1c0000
    s_cselect_b32 s50, 0x400000, s101
    s_mov_b32 s101, 4096
    s_cselect_b32 s72, 0, s101
    s_sub_u32 s72, s6, s72
    s_lshl_b32 s66, s72, 10
    s_add_u32 s66, s66, s7
    s_add_u32 s6, s6, 32
    s_add_u32 m0, s74, 90112
    s_nop 0
    buffer_load_dwordx4 v4, s[48:51], s66 offen lds
    s_add_u32 s66, s66, s68
    v_and_b32 v14, 31, v1
    s_mul_i32 s72, s70, 2048
    v_lshlrev_b32 v14, 6, v14
    v_add_u32 v14, s72, v14
    v_lshrrev_b32 v15, 5, v1
    v_bfe_u32 v16, v1, 2, 2
    v_xor_b32 v15, v15, v16
    v_lshl_add_u32 v6, v15, 4, v14
    v_xor_b32 v7, 32, v6
    v_add_u32 v8, 65536, v6
    v_add_u32 v9, 65536, v7
    v_add_u32 v28, 131072, v6
    v_add_u32 v29, 131072, v7
    v_lshrrev_b32 v14, 5, v1
    v_lshlrev_b32 v14, 3, v14
    v_bfe_u32 v15, v1, 2, 2
    v_add_u32 v14, v14, v15
    v_mul_u32_u24 v14, 256, v14
    s_lshl_b32 s72, s69, 1
    v_xor_b32 v15, s72, v15
    v_lshl_add_u32 v14, v15, 6, v14
    v_bfe_u32 v15, v1, 4, 1
    v_lshl_add_u32 v14, v15, 5, v14
    v_and_b32 v15, 3, v1
    v_lshl_add_u32 v14, v15, 3, v14
    v_add_u32 v10, 8192, v14
    v_xor_b32 v11, 64, v10
    v_add_u32 v12, 65536, v10
    v_add_u32 v13, 65536, v11
    v_add_u32 v30, 131072, v10
    v_add_u32 v31, 131072, v11
    s_waitcnt vmcnt(10)
    s_barrier
    ds_read_b64_tr_b16 v[32:33], v10 offset:0
    ds_read_b64_tr_b16 v[34:35], v10 offset:1024
    ds_read_b64_tr_b16 v[36:37], v11 offset:0
    ds_read_b64_tr_b16 v[38:39], v11 offset:1024
    ds_read_b128 v[64:67], v6 offset:0
    ds_read_b64_tr_b16 v[40:41], v10 offset:4096
    ds_read_b64_tr_b16 v[42:43], v10 offset:5120
    ds_read_b64_tr_b16 v[44:45], v11 offset:4096
    ds_read_b64_tr_b16 v[46:47], v11 offset:5120
    ds_read_b128 v[68:71], v7 offset:0
    s_waitcnt vmcnt(6)
    s_barrier
    s_waitcnt lgkmcnt(5)
    v_mfma_f32_32x32x16_bf16 v[128:143], v[32:35], v[64:67], 0
    s_add_u32 m0, s71, 98304
    s_nop 0
    buffer_load_dwordx4 v2, s[44:47], s65 offen lds
    s_add_u32 s65, s65, 131072
    s_cmp_lt_u32 s6, 4096
    s_cselect_b32 s48, s26, s34
    s_cselect_b32 s49, s27, s35
    s_mov_b32 s101, 0x1c0000
    s_cselect_b32 s50, 0x400000, s101
    s_mov_b32 s101, 4096
    s_cselect_b32 s72, 0, s101
    s_sub_u32 s72, s6, s72
    s_lshl_b32 s66, s72, 10
    s_add_u32 s66, s66, s7
    s_add_u32 s6, s6, 32
    s_add_u32 m0, s74, 106496
    s_nop 0
    buffer_load_dwordx4 v4, s[48:51], s66 offen lds
    s_add_u32 s66, s66, s68
    ds_read_b64_tr_b16 v[48:49], v10 offset:16384
    ds_read_b64_tr_b16 v[50:51], v10 offset:17408
    v_mfma_f32_32x32x16_bf16 v[144:159], v[36:39], v[64:67], 0
    ds_read_b64_tr_b16 v[52:53], v11 offset:16384
    ds_read_b64_tr_b16 v[54:55], v11 offset:17408
    ds_read_b128 v[72:75], v6 offset:16384
    s_waitcnt lgkmcnt(5)
    v_mfma_f32_32x32x16_bf16 v[128:143], v[40:43], v[68:71], v[128:143]
    ds_read_b64_tr_b16 v[56:57], v10 offset:20480
    ds_read_b64_tr_b16 v[58:59], v10 offset:21504
    ds_read_b64_tr_b16 v[60:61], v11 offset:20480
    ds_read_b64_tr_b16 v[62:63], v11 offset:21504
    v_mfma_f32_32x32x16_bf16 v[144:159], v[44:47], v[68:71], v[144:159]
    ds_read_b128 v[76:79], v7 offset:16384
    s_add_u32 m0, s71, 114688
    s_nop 0
    buffer_load_dwordx4 v2, s[44:47], s65 offen lds
    s_add_u32 s65, s65, 131072
    s_cmp_lt_u32 s6, 4096
    s_cselect_b32 s48, s26, s34
    s_cselect_b32 s49, s27, s35
    s_mov_b32 s101, 0x1c0000
    s_cselect_b32 s50, 0x400000, s101
    s_mov_b32 s101, 4096
    s_cselect_b32 s72, 0, s101
    s_sub_u32 s72, s6, s72
    s_lshl_b32 s66, s72, 10
    s_add_u32 s66, s66, s7
    s_add_u32 s6, s6, 32
    s_add_u32 m0, s74, 122880
    s_nop 0
    buffer_load_dwordx4 v4, s[48:51], s66 offen lds
    s_add_u32 s66, s66, s68
    s_waitcnt lgkmcnt(5)
    v_mfma_f32_32x32x16_bf16 v[128:143], v[48:51], v[72:75], v[128:143]
    s_add_u32 m0, s71, 131072
    s_nop 0
    buffer_load_dwordx4 v2, s[44:47], s65 offen lds
    s_add_u32 s65, s65, 131072
    s_cmp_lt_u32 s6, 4096
    s_cselect_b32 s48, s26, s34
    s_cselect_b32 s49, s27, s35
    s_mov_b32 s101, 0x1c0000
    s_cselect_b32 s50, 0x400000, s101
    s_mov_b32 s101, 4096
    s_cselect_b32 s72, 0, s101
    s_sub_u32 s72, s6, s72
    s_lshl_b32 s66, s72, 10
    s_add_u32 s66, s66, s7
    s_add_u32 s6, s6, 32
    s_add_u32 m0, s74, 139264
    s_nop 0
    buffer_load_dwordx4 v4, s[48:51], s66 offen lds
    s_add_u32 s66, s66, s68
    ds_read_b64_tr_b16 v[32:33], v10 offset:32768
    ds_read_b64_tr_b16 v[34:35], v10 offset:33792
    v_mfma_f32_32x32x16_bf16 v[144:159], v[52:55], v[72:75], v[144:159]
    ds_read_b64_tr_b16 v[36:37], v11 offset:32768
    ds_read_b64_tr_b16 v[38:39], v11 offset:33792
    ds_read_b128 v[64:67], v6 offset:32768
    s_waitcnt lgkmcnt(5)
    v_mfma_f32_32x32x16_bf16 v[128:143], v[56:59], v[76:79], v[128:143]
    ds_read_b64_tr_b16 v[40:41], v10 offset:36864
    ds_read_b64_tr_b16 v[42:43], v10 offset:37888
    ds_read_b64_tr_b16 v[44:45], v11 offset:36864
    ds_read_b64_tr_b16 v[46:47], v11 offset:37888
    v_mfma_f32_32x32x16_bf16 v[144:159], v[60:63], v[76:79], v[144:159]
    ds_read_b128 v[68:71], v7 offset:32768
    s_add_u32 m0, s71, 147456
    s_nop 0
    buffer_load_dwordx4 v2, s[44:47], s65 offen lds
    s_add_u32 s65, s65, 131072
    s_cmp_lt_u32 s6, 4096
    s_cselect_b32 s48, s26, s34
    s_cselect_b32 s49, s27, s35
    s_mov_b32 s101, 0x1c0000
    s_cselect_b32 s50, 0x400000, s101
    s_mov_b32 s101, 4096
    s_cselect_b32 s72, 0, s101
    s_sub_u32 s72, s6, s72
    s_lshl_b32 s66, s72, 10
    s_add_u32 s66, s66, s7
    s_add_u32 s6, s6, 32
    s_add_u32 m0, s74, 155648
    s_nop 0
    buffer_load_dwordx4 v4, s[48:51], s66 offen lds
    s_add_u32 s66, s66, s68
    s_waitcnt vmcnt(10)
    s_barrier
    s_waitcnt lgkmcnt(5)
    v_mfma_f32_32x32x16_bf16 v[128:143], v[32:35], v[64:67], v[128:143]
    ds_read_b64_tr_b16 v[48:49], v10 offset:49152
    ds_read_b64_tr_b16 v[50:51], v10 offset:50176
    ds_read_b64_tr_b16 v[52:53], v11 offset:49152
    v_mfma_f32_32x32x16_bf16 v[144:159], v[36:39], v[64:67], v[144:159]
    ds_read_b64_tr_b16 v[54:55], v11 offset:50176
    ds_read_b128 v[72:75], v6 offset:49152
    s_waitcnt lgkmcnt(5)
    v_mfma_f32_32x32x16_bf16 v[128:143], v[40:43], v[68:71], v[128:143]
    ds_read_b64_tr_b16 v[56:57], v10 offset:53248
    ds_read_b64_tr_b16 v[58:59], v10 offset:54272
    ds_read_b64_tr_b16 v[60:61], v11 offset:53248
    ds_read_b64_tr_b16 v[62:63], v11 offset:54272
    v_mfma_f32_32x32x16_bf16 v[144:159], v[44:47], v[68:71], v[144:159]
    ds_read_b128 v[76:79], v7 offset:49152
    s_add_u32 m0, s71, 0
    s_nop 0
    buffer_load_dwordx4 v2, s[44:47], s65 offen lds
    s_add_u32 s65, s65, 131072
    s_cmp_lt_u32 s6, 4096
    s_cselect_b32 s48, s26, s34
    s_cselect_b32 s49, s27, s35
    s_mov_b32 s101, 0x1c0000
    s_cselect_b32 s50, 0x400000, s101
    s_mov_b32 s101, 4096
    s_cselect_b32 s72, 0, s101
    s_sub_u32 s72, s6, s72
    s_lshl_b32 s66, s72, 10
    s_add_u32 s66, s66, s7
    s_add_u32 s6, s6, 32
    s_add_u32 m0, s74, 8192
    s_nop 0
    buffer_load_dwordx4 v4, s[48:51], s66 offen lds
    s_add_u32 s66, s66, s68
    s_waitcnt lgkmcnt(5)
    v_mfma_f32_32x32x16_bf16 v[128:143], v[48:51], v[72:75], v[128:143]
    ds_read_b64_tr_b16 v[32:33], v12 offset:0
    ds_read_b64_tr_b16 v[34:35], v12 offset:1024
    ds_read_b64_tr_b16 v[36:37], v13 offset:0
    v_mfma_f32_32x32x16_bf16 v[144:159], v[52:55], v[72:75], v[144:159]
    ds_read_b64_tr_b16 v[38:39], v13 offset:1024
    ds_read_b128 v[64:67], v8 offset:0
    s_waitcnt lgkmcnt(5)
    v_mfma_f32_32x32x16_bf16 v[128:143], v[56:59], v[76:79], v[128:143]
    ds_read_b64_tr_b16 v[40:41], v12 offset:4096
    ds_read_b64_tr_b16 v[42:43], v12 offset:5120
    ds_read_b64_tr_b16 v[44:45], v13 offset:4096
    ds_read_b64_tr_b16 v[46:47], v13 offset:5120
    v_mfma_f32_32x32x16_bf16 v[144:159], v[60:63], v[76:79], v[144:159]
    ds_read_b128 v[68:71], v9 offset:0
    s_add_u32 m0, s71, 16384
    s_nop 0
    buffer_load_dwordx4 v2, s[44:47], s65 offen lds
    s_add_u32 s65, s65, 131072
    s_cmp_lt_u32 s6, 4096
    s_cselect_b32 s48, s26, s34
    s_cselect_b32 s49, s27, s35
    s_mov_b32 s101, 0x1c0000
    s_cselect_b32 s50, 0x400000, s101
    s_mov_b32 s101, 4096
    s_cselect_b32 s72, 0, s101
    s_sub_u32 s72, s6, s72
    s_lshl_b32 s66, s72, 10
    s_add_u32 s66, s66, s7
    s_add_u32 s6, s6, 32
    s_add_u32 m0, s74, 24576
    s_nop 0
    buffer_load_dwordx4 v4, s[48:51], s66 offen lds
    s_add_u32 s66, s66, s68
    s_waitcnt vmcnt(10)
    s_barrier
    s_waitcnt lgkmcnt(5)
    v_mfma_f32_32x32x16_bf16 v[128:143], v[32:35], v[64:67], v[128:143]
    ds_read_b64_tr_b16 v[48:49], v12 offset:16384
    ds_read_b64_tr_b16 v[50:51], v12 offset:17408
    ds_read_b64_tr_b16 v[52:53], v13 offset:16384
    v_mfma_f32_32x32x16_bf16 v[144:159], v[36:39], v[64:67], v[144:159]
    ds_read_b64_tr_b16 v[54:55], v13 offset:17408
    ds_read_b128 v[72:75], v8 offset:16384
    s_waitcnt lgkmcnt(5)
    v_mfma_f32_32x32x16_bf16 v[128:143], v[40:43], v[68:71], v[128:143]
    ds_read_b64_tr_b16 v[56:57], v12 offset:20480
    ds_read_b64_tr_b16 v[58:59], v12 offset:21504
    ds_read_b64_tr_b16 v[60:61], v13 offset:20480
    ds_read_b64_tr_b16 v[62:63], v13 offset:21504
    v_mfma_f32_32x32x16_bf16 v[144:159], v[44:47], v[68:71], v[144:159]
    ds_read_b128 v[76:79], v9 offset:16384
    s_add_u32 m0, s71, 32768
    s_nop 0
    buffer_load_dwordx4 v2, s[44:47], s65 offen lds
    s_add_u32 s65, s65, 131072
    s_cmp_lt_u32 s6, 4096
    s_cselect_b32 s48, s26, s34
    s_cselect_b32 s49, s27, s35
    s_mov_b32 s101, 0x1c0000
    s_cselect_b32 s50, 0x400000, s101
    s_mov_b32 s101, 4096
    s_cselect_b32 s72, 0, s101
    s_sub_u32 s72, s6, s72
    s_lshl_b32 s66, s72, 10
    s_add_u32 s66, s66, s7
    s_add_u32 s6, s6, 32
    s_add_u32 m0, s74, 40960
    s_nop 0
    buffer_load_dwordx4 v4, s[48:51], s66 offen lds
    s_add_u32 s66, s66, s68
    s_waitcnt lgkmcnt(5)
    v_mfma_f32_32x32x16_bf16 v[128:143], v[48:51], v[72:75], v[128:143]
    ds_read_b64_tr_b16 v[32:33], v12 offset:32768
    ds_read_b64_tr_b16 v[34:35], v12 offset:33792
    ds_read_b64_tr_b16 v[36:37], v13 offset:32768
    v_mfma_f32_32x32x16_bf16 v[144:159], v[52:55], v[72:75], v[144:159]
    ds_read_b64_tr_b16 v[38:39], v13 offset:33792
    ds_read_b128 v[64:67], v8 offset:32768
    s_waitcnt lgkmcnt(5)
    v_mfma_f32_32x32x16_bf16 v[128:143], v[56:59], v[76:79], v[128:143]
    ds_read_b64_tr_b16 v[40:41], v12 offset:36864
    ds_read_b64_tr_b16 v[42:43], v12 offset:37888
    ds_read_b64_tr_b16 v[44:45], v13 offset:36864
    ds_read_b64_tr_b16 v[46:47], v13 offset:37888
    v_mfma_f32_32x32x16_bf16 v[144:159], v[60:63], v[76:79], v[144:159]
    ds_read_b128 v[68:71], v9 offset:32768
    s_add_u32 m0, s71, 49152
    s_nop 0
    buffer_load_dwordx4 v2, s[44:47], s65 offen lds
    s_add_u32 s65, s65, 131072
    s_cmp_lt_u32 s6, 4096
    s_cselect_b32 s48, s26, s34
    s_cselect_b32 s49, s27, s35
    s_mov_b32 s101, 0x1c0000
    s_cselect_b32 s50, 0x400000, s101
    s_mov_b32 s101, 4096
    s_cselect_b32 s72, 0, s101
    s_sub_u32 s72, s6, s72
    s_lshl_b32 s66, s72, 10
    s_add_u32 s66, s66, s7
    s_add_u32 s6, s6, 32
    s_add_u32 m0, s74, 57344
    s_nop 0
    buffer_load_dwordx4 v4, s[48:51], s66 offen lds
    s_add_u32 s66, s66, s68
    s_waitcnt vmcnt(10)
    s_barrier
    s_waitcnt lgkmcnt(5)
    v_mfma_f32_32x32x16_bf16 v[128:143], v[32:35], v[64:67], v[128:143]
    ds_read_b64_tr_b16 v[48:49], v12 offset:49152
    ds_read_b64_tr_b16 v[50:51], v12 offset:50176
    ds_read_b64_tr_b16 v[52:53], v13 offset:49152
    v_mfma_f32_32x32x16_bf16 v[144:159], v[36:39], v[64:67], v[144:159]
    ds_read_b64_tr_b16 v[54:55], v13 offset:50176
    ds_read_b128 v[72:75], v8 offset:49152
    s_waitcnt lgkmcnt(5)
    v_mfma_f32_32x32x16_bf16 v[128:143], v[40:43], v[68:71], v[128:143]
    ds_read_b64_tr_b16 v[56:57], v12 offset:53248
    ds_read_b64_tr_b16 v[58:59], v12 offset:54272
    ds_read_b64_tr_b16 v[60:61], v13 offset:53248
    ds_read_b64_tr_b16 v[62:63], v13 offset:54272
    v_mfma_f32_32x32x16_bf16 v[144:159], v[44:47], v[68:71], v[144:159]
    ds_read_b128 v[76:79], v9 offset:49152
    s_add_u32 m0, s71, 65536
    s_nop 0
    buffer_load_dwordx4 v2, s[44:47], s65 offen lds
    s_add_u32 s65, s65, 131072
    s_cmp_lt_u32 s6, 4096
    s_cselect_b32 s48, s26, s34
    s_cselect_b32 s49, s27, s35
    s_mov_b32 s101, 0x1c0000
    s_cselect_b32 s50, 0x400000, s101
    s_mov_b32 s101, 4096
    s_cselect_b32 s72, 0, s101
    s_sub_u32 s72, s6, s72
    s_lshl_b32 s66, s72, 10
    s_add_u32 s66, s66, s7
    s_add_u32 s6, s6, 32
    s_add_u32 m0, s74, 73728
    s_nop 0
    buffer_load_dwordx4 v4, s[48:51], s66 offen lds
    s_add_u32 s66, s66, s68
    s_waitcnt lgkmcnt(5)
    v_mfma_f32_32x32x16_bf16 v[128:143], v[48:51], v[72:75], v[128:143]
    ds_read_b64_tr_b16 v[32:33], v30 offset:0
    ds_read_b64_tr_b16 v[34:35], v30 offset:1024
    ds_read_b64_tr_b16 v[36:37], v31 offset:0
    v_mfma_f32_32x32x16_bf16 v[144:159], v[52:55], v[72:75], v[144:159]
    ds_read_b64_tr_b16 v[38:39], v31 offset:1024
    ds_read_b128 v[64:67], v28 offset:0
    s_waitcnt lgkmcnt(5)
    v_mfma_f32_32x32x16_bf16 v[128:143], v[56:59], v[76:79], v[128:143]
    ds_read_b64_tr_b16 v[40:41], v30 offset:4096
    ds_read_b64_tr_b16 v[42:43], v30 offset:5120
    ds_read_b64_tr_b16 v[44:45], v31 offset:4096
    ds_read_b64_tr_b16 v[46:47], v31 offset:5120
    v_mfma_f32_32x32x16_bf16 v[144:159], v[60:63], v[76:79], v[144:159]
    ds_read_b128 v[68:71], v29 offset:0
    s_add_u32 m0, s71, 81920
    s_nop 0
    buffer_load_dwordx4 v2, s[44:47], s65 offen lds
    s_add_u32 s65, s65, 131072
    s_cmp_lt_u32 s6, 4096
    s_cselect_b32 s48, s26, s34
    s_cselect_b32 s49, s27, s35
    s_mov_b32 s101, 0x1c0000
    s_cselect_b32 s50, 0x400000, s101
    s_mov_b32 s101, 4096
    s_cselect_b32 s72, 0, s101
    s_sub_u32 s72, s6, s72
    s_lshl_b32 s66, s72, 10
    s_add_u32 s66, s66, s7
    s_add_u32 s6, s6, 32
    s_add_u32 m0, s74, 90112
    s_nop 0
    buffer_load_dwordx4 v4, s[48:51], s66 offen lds
    s_add_u32 s66, s66, s68
    s_waitcnt vmcnt(10)
    s_barrier
    s_waitcnt lgkmcnt(5)
    v_mfma_f32_32x32x16_bf16 v[128:143], v[32:35], v[64:67], v[128:143]
    ds_read_b64_tr_b16 v[48:49], v30 offset:16384
    ds_read_b64_tr_b16 v[50:51], v30 offset:17408
    ds_read_b64_tr_b16 v[52:53], v31 offset:16384
    v_mfma_f32_32x32x16_bf16 v[144:159], v[36:39], v[64:67], v[144:159]
    ds_read_b64_tr_b16 v[54:55], v31 offset:17408
    ds_read_b128 v[72:75], v28 offset:16384
    s_waitcnt lgkmcnt(5)
    v_mfma_f32_32x32x16_bf16 v[128:143], v[40:43], v[68:71], v[128:143]
    ds_read_b64_tr_b16 v[56:57], v30 offset:20480
    ds_read_b64_tr_b16 v[58:59], v30 offset:21504
    ds_read_b64_tr_b16 v[60:61], v31 offset:20480
    ds_read_b64_tr_b16 v[62:63], v31 offset:21504
    v_mfma_f32_32x32x16_bf16 v[144:159], v[44:47], v[68:71], v[144:159]
    ds_read_b128 v[76:79], v29 offset:16384
    s_add_u32 m0, s71, 98304
    s_nop 0
    buffer_load_dwordx4 v2, s[44:47], s65 offen lds
    s_add_u32 s65, s65, 131072
    s_cmp_lt_u32 s6, 4096
    s_cselect_b32 s48, s26, s34
    s_cselect_b32 s49, s27, s35
    s_mov_b32 s101, 0x1c0000
    s_cselect_b32 s50, 0x400000, s101
    s_mov_b32 s101, 4096
    s_cselect_b32 s72, 0, s101
    s_sub_u32 s72, s6, s72
    s_lshl_b32 s66, s72, 10
    s_add_u32 s66, s66, s7
    s_add_u32 s6, s6, 32
    s_add_u32 m0, s74, 106496
    s_nop 0
    buffer_load_dwordx4 v4, s[48:51], s66 offen lds
    s_add_u32 s66, s66, s68
    s_waitcnt lgkmcnt(5)
    v_mfma_f32_32x32x16_bf16 v[128:143], v[48:51], v[72:75], v[128:143]
    ds_read_b64_tr_b16 v[32:33], v10 offset:0
    ds_read_b64_tr_b16 v[34:35], v10 offset:1024
    ds_read_b64_tr_b16 v[36:37], v11 offset:0
    v_mfma_f32_32x32x16_bf16 v[144:159], v[52:55], v[72:75], v[144:159]
    ds_read_b64_tr_b16 v[38:39], v11 offset:1024
    ds_read_b128 v[64:67], v6 offset:0
    s_waitcnt lgkmcnt(5)
    v_mfma_f32_32x32x16_bf16 v[128:143], v[56:59], v[76:79], v[128:143]
    ds_read_b64_tr_b16 v[40:41], v10 offset:4096
    ds_read_b64_tr_b16 v[42:43], v10 offset:5120
    ds_read_b64_tr_b16 v[44:45], v11 offset:4096
    ds_read_b64_tr_b16 v[46:47], v11 offset:5120
    v_mfma_f32_32x32x16_bf16 v[144:159], v[60:63], v[76:79], v[144:159]
    ds_read_b128 v[68:71], v7 offset:0
    s_add_u32 m0, s71, 114688
    s_nop 0
    buffer_load_dwordx4 v2, s[44:47], s65 offen lds
    s_add_u32 s65, s65, 131072
    s_cmp_lt_u32 s6, 4096
    s_cselect_b32 s48, s26, s34
    s_cselect_b32 s49, s27, s35
    s_mov_b32 s101, 0x1c0000
    s_cselect_b32 s50, 0x400000, s101
    s_mov_b32 s101, 4096
    s_cselect_b32 s72, 0, s101
    s_sub_u32 s72, s6, s72
    s_lshl_b32 s66, s72, 10
    s_add_u32 s66, s66, s7
    s_add_u32 s6, s6, 32
    s_add_u32 m0, s74, 122880
    s_nop 0
    buffer_load_dwordx4 v4, s[48:51], s66 offen lds
    s_add_u32 s66, s66, s68
    s_waitcnt vmcnt(10)
    s_barrier
    s_waitcnt lgkmcnt(5)
    v_mfma_f32_32x32x16_bf16 v[128:143], v[32:35], v[64:67], v[128:143]
    ds_read_b64_tr_b16 v[48:49], v10 offset:16384
    ds_read_b64_tr_b16 v[50:51], v10 offset:17408
    ds_read_b64_tr_b16 v[52:53], v11 offset:16384
    v_mfma_f32_32x32x16_bf16 v[144:159], v[36:39], v[64:67], v[144:159]
    ds_read_b64_tr_b16 v[54:55], v11 offset:17408
    ds_read_b128 v[72:75], v6 offset:16384
    s_waitcnt lgkmcnt(5)
    v_mfma_f32_32x32x16_bf16 v[128:143], v[40:43], v[68:71], v[128:143]
    ds_read_b64_tr_b16 v[56:57], v10 offset:20480
    ds_read_b64_tr_b16 v[58:59], v10 offset:21504
    ds_read_b64_tr_b16 v[60:61], v11 offset:20480
    ds_read_b64_tr_b16 v[62:63], v11 offset:21504
    v_mfma_f32_32x32x16_bf16 v[144:159], v[44:47], v[68:71], v[144:159]
    ds_read_b128 v[76:79], v7 offset:16384
    s_add_u32 m0, s71, 131072
    s_nop 0
    buffer_load_dwordx4 v2, s[44:47], s65 offen lds
    s_add_u32 s65, s65, 131072
    s_cmp_lt_u32 s6, 4096
    s_cselect_b32 s48, s26, s34
    s_cselect_b32 s49, s27, s35
    s_mov_b32 s101, 0x1c0000
    s_cselect_b32 s50, 0x400000, s101
    s_mov_b32 s101, 4096
    s_cselect_b32 s72, 0, s101
    s_sub_u32 s72, s6, s72
    s_lshl_b32 s66, s72, 10
    s_add_u32 s66, s66, s7
    s_add_u32 s6, s6, 32
    s_add_u32 m0, s74, 139264
    s_nop 0
    buffer_load_dwordx4 v4, s[48:51], s66 offen lds
    s_add_u32 s66, s66, s68
    s_waitcnt lgkmcnt(5)
    v_mfma_f32_32x32x16_bf16 v[128:143], v[48:51], v[72:75], v[128:143]
    ds_read_b64_tr_b16 v[32:33], v10 offset:32768
    ds_read_b64_tr_b16 v[34:35], v10 offset:33792
    ds_read_b64_tr_b16 v[36:37], v11 offset:32768
    v_mfma_f32_32x32x16_bf16 v[144:159], v[52:55], v[72:75], v[144:159]
    ds_read_b64_tr_b16 v[38:39], v11 offset:33792
    ds_read_b128 v[64:67], v6 offset:32768
    s_waitcnt lgkmcnt(5)
    v_mfma_f32_32x32x16_bf16 v[128:143], v[56:59], v[76:79], v[128:143]
    ds_read_b64_tr_b16 v[40:41], v10 offset:36864
    ds_read_b64_tr_b16 v[42:43], v10 offset:37888
    ds_read_b64_tr_b16 v[44:45], v11 offset:36864
    ds_read_b64_tr_b16 v[46:47], v11 offset:37888
    v_mfma_f32_32x32x16_bf16 v[144:159], v[60:63], v[76:79], v[144:159]
    ds_read_b128 v[68:71], v7 offset:32768
    s_add_u32 m0, s71, 147456
    s_nop 0
    buffer_load_dwordx4 v2, s[44:47], s65 offen lds
    s_add_u32 s65, s65, 131072
    s_cmp_lt_u32 s6, 4096
    s_cselect_b32 s48, s26, s34
    s_cselect_b32 s49, s27, s35
    s_mov_b32 s101, 0x1c0000
    s_cselect_b32 s50, 0x400000, s101
    s_mov_b32 s101, 4096
    s_cselect_b32 s72, 0, s101
    s_sub_u32 s72, s6, s72
    s_lshl_b32 s66, s72, 10
    s_add_u32 s66, s66, s7
    s_add_u32 s6, s6, 32
    s_add_u32 m0, s74, 155648
    s_nop 0
    buffer_load_dwordx4 v4, s[48:51], s66 offen lds
    s_add_u32 s66, s66, s68
    s_waitcnt vmcnt(10)
    s_barrier
    s_waitcnt lgkmcnt(5)
    v_mfma_f32_32x32x16_bf16 v[128:143], v[32:35], v[64:67], v[128:143]
    ds_read_b64_tr_b16 v[48:49], v10 offset:49152
    ds_read_b64_tr_b16 v[50:51], v10 offset:50176
    ds_read_b64_tr_b16 v[52:53], v11 offset:49152
    v_mfma_f32_32x32x16_bf16 v[144:159], v[36:39], v[64:67], v[144:159]
    ds_read_b64_tr_b16 v[54:55], v11 offset:50176
    ds_read_b128 v[72:75], v6 offset:49152
    s_waitcnt lgkmcnt(5)
    v_mfma_f32_32x32x16_bf16 v[128:143], v[40:43], v[68:71], v[128:143]
    ds_read_b64_tr_b16 v[56:57], v10 offset:53248
    ds_read_b64_tr_b16 v[58:59], v10 offset:54272
    ds_read_b64_tr_b16 v[60:61], v11 offset:53248
    ds_read_b64_tr_b16 v[62:63], v11 offset:54272
    v_mfma_f32_32x32x16_bf16 v[144:159], v[44:47], v[68:71], v[144:159]
    ds_read_b128 v[76:79], v7 offset:49152
    s_add_u32 m0, s71, 0
    s_nop 0
    buffer_load_dwordx4 v2, s[44:47], s65 offen lds
    s_add_u32 s65, s65, 131072
    s_cmp_lt_u32 s6, 4096
    s_cselect_b32 s48, s26, s34
    s_cselect_b32 s49, s27, s35
    s_mov_b32 s101, 0x1c0000
    s_cselect_b32 s50, 0x400000, s101
    s_mov_b32 s101, 4096
    s_cselect_b32 s72, 0, s101
    s_sub_u32 s72, s6, s72
    s_lshl_b32 s66, s72, 10
    s_add_u32 s66, s66, s7
    s_add_u32 s6, s6, 32
    s_add_u32 m0, s74, 8192
    s_nop 0
    buffer_load_dwordx4 v4, s[48:51], s66 offen lds
    s_add_u32 s66, s66, s68
    s_waitcnt lgkmcnt(5)
    v_mfma_f32_32x32x16_bf16 v[128:143], v[48:51], v[72:75], v[128:143]
    ds_read_b64_tr_b16 v[32:33], v12 offset:0
    ds_read_b64_tr_b16 v[34:35], v12 offset:1024
    ds_read_b64_tr_b16 v[36:37], v13 offset:0
    v_mfma_f32_32x32x16_bf16 v[144:159], v[52:55], v[72:75], v[144:159]
    ds_read_b64_tr_b16 v[38:39], v13 offset:1024
    ds_read_b128 v[64:67], v8 offset:0
    s_waitcnt lgkmcnt(5)
    v_mfma_f32_32x32x16_bf16 v[128:143], v[56:59], v[76:79], v[128:143]
    ds_read_b64_tr_b16 v[40:41], v12 offset:4096
    ds_read_b64_tr_b16 v[42:43], v12 offset:5120
    ds_read_b64_tr_b16 v[44:45], v13 offset:4096
    ds_read_b64_tr_b16 v[46:47], v13 offset:5120
    v_mfma_f32_32x32x16_bf16 v[144:159], v[60:63], v[76:79], v[144:159]
    ds_read_b128 v[68:71], v9 offset:0
    s_add_u32 m0, s71, 16384
    s_nop 0
    buffer_load_dwordx4 v2, s[44:47], s65 offen lds
    s_add_u32 s65, s65, 131072
    s_cmp_lt_u32 s6, 4096
    s_cselect_b32 s48, s26, s34
    s_cselect_b32 s49, s27, s35
    s_mov_b32 s101, 0x1c0000
    s_cselect_b32 s50, 0x400000, s101
    s_mov_b32 s101, 4096
    s_cselect_b32 s72, 0, s101
    s_sub_u32 s72, s6, s72
    s_lshl_b32 s66, s72, 10
    s_add_u32 s66, s66, s7
    s_add_u32 s6, s6, 32
    s_add_u32 m0, s74, 24576
    s_nop 0
    buffer_load_dwordx4 v4, s[48:51], s66 offen lds
    s_add_u32 s66, s66, s68
    s_waitcnt vmcnt(10)
    s_barrier
    s_waitcnt lgkmcnt(5)
    v_mfma_f32_32x32x16_bf16 v[128:143], v[32:35], v[64:67], v[128:143]
    ds_read_b64_tr_b16 v[48:49], v12 offset:16384
    ds_read_b64_tr_b16 v[50:51], v12 offset:17408
    ds_read_b64_tr_b16 v[52:53], v13 offset:16384
    v_mfma_f32_32x32x16_bf16 v[144:159], v[36:39], v[64:67], v[144:159]
    ds_read_b64_tr_b16 v[54:55], v13 offset:17408
    ds_read_b128 v[72:75], v8 offset:16384
    s_waitcnt lgkmcnt(5)
    v_mfma_f32_32x32x16_bf16 v[128:143], v[40:43], v[68:71], v[128:143]
    ds_read_b64_tr_b16 v[56:57], v12 offset:20480
    ds_read_b64_tr_b16 v[58:59], v12 offset:21504
    ds_read_b64_tr_b16 v[60:61], v13 offset:20480
    ds_read_b64_tr_b16 v[62:63], v13 offset:21504
    v_mfma_f32_32x32x16_bf16 v[144:159], v[44:47], v[68:71], v[144:159]
    ds_read_b128 v[76:79], v9 offset:16384
    s_add_u32 m0, s71, 32768
    s_nop 0
    buffer_load_dwordx4 v2, s[44:47], s65 offen lds
    s_add_u32 s65, s65, 131072
    s_cmp_lt_u32 s6, 4096
    s_cselect_b32 s48, s26, s34
    s_cselect_b32 s49, s27, s35
    s_mov_b32 s101, 0x1c0000
    s_cselect_b32 s50, 0x400000, s101
    s_mov_b32 s101, 4096
    s_cselect_b32 s72, 0, s101
    s_sub_u32 s72, s6, s72
    s_lshl_b32 s66, s72, 10
    s_add_u32 s66, s66, s7
    s_add_u32 s6, s6, 32
    s_add_u32 m0, s74, 40960
    s_nop 0
    buffer_load_dwordx4 v4, s[48:51], s66 offen lds
    s_add_u32 s66, s66, s68
    s_waitcnt lgkmcnt(5)
    v_mfma_f32_32x32x16_bf16 v[128:143], v[48:51], v[72:75], v[128:143]
    ds_read_b64_tr_b16 v[32:33], v12 offset:32768
    ds_read_b64_tr_b16 v[34:35], v12 offset:33792
    ds_read_b64_tr_b16 v[36:37], v13 offset:32768
    v_mfma_f32_32x32x16_bf16 v[144:159], v[52:55], v[72:75], v[144:159]
    ds_read_b64_tr_b16 v[38:39], v13 offset:33792
    ds_read_b128 v[64:67], v8 offset:32768
    s_waitcnt lgkmcnt(5)
    v_mfma_f32_32x32x16_bf16 v[128:143], v[56:59], v[76:79], v[128:143]
    ds_read_b64_tr_b16 v[40:41], v12 offset:36864
    ds_read_b64_tr_b16 v[42:43], v12 offset:37888
    ds_read_b64_tr_b16 v[44:45], v13 offset:36864
    ds_read_b64_tr_b16 v[46:47], v13 offset:37888
    v_mfma_f32_32x32x16_bf16 v[144:159], v[60:63], v[76:79], v[144:159]
    ds_read_b128 v[68:71], v9 offset:32768
    s_add_u32 m0, s71, 49152
    s_nop 0
    buffer_load_dwordx4 v2, s[44:47], s65 offen lds
    s_add_u32 s65, s65, 131072
    s_cmp_lt_u32 s6, 4096
    s_cselect_b32 s48, s26, s34
    s_cselect_b32 s49, s27, s35
    s_mov_b32 s101, 0x1c0000
    s_cselect_b32 s50, 0x400000, s101
    s_mov_b32 s101, 4096
    s_cselect_b32 s72, 0, s101
    s_sub_u32 s72, s6, s72
    s_lshl_b32 s66, s72, 10
    s_add_u32 s66, s66, s7
    s_add_u32 s6, s6, 32
    s_add_u32 m0, s74, 57344
    s_nop 0
    buffer_load_dwordx4 v4, s[48:51], s66 offen lds
    s_add_u32 s66, s66, s68
    s_waitcnt vmcnt(10)
    s_barrier
    s_waitcnt lgkmcnt(5)
    v_mfma_f32_32x32x16_bf16 v[128:143], v[32:35], v[64:67], v[128:143]
    ds_read_b64_tr_b16 v[48:49], v12 offset:49152
    ds_read_b64_tr_b16 v[50:51], v12 offset:50176
    ds_read_b64_tr_b16 v[52:53], v13 offset:49152
    v_mfma_f32_32x32x16_bf16 v[144:159], v[36:39], v[64:67], v[144:159]
    ds_read_b64_tr_b16 v[54:55], v13 offset:50176
    ds_read_b128 v[72:75], v8 offset:49152
    s_waitcnt lgkmcnt(5)
    v_mfma_f32_32x32x16_bf16 v[128:143], v[40:43], v[68:71], v[128:143]
    ds_read_b64_tr_b16 v[56:57], v12 offset:53248
    ds_read_b64_tr_b16 v[58:59], v12 offset:54272
    ds_read_b64_tr_b16 v[60:61], v13 offset:53248
    ds_read_b64_tr_b16 v[62:63], v13 offset:54272
    v_mfma_f32_32x32x16_bf16 v[144:159], v[44:47], v[68:71], v[144:159]
    ds_read_b128 v[76:79], v9 offset:49152
    s_add_u32 m0, s71, 65536
    s_nop 0
    buffer_load_dwordx4 v2, s[44:47], s65 offen lds
    s_add_u32 s65, s65, 131072
    s_cmp_lt_u32 s6, 4096
    s_cselect_b32 s48, s26, s34
    s_cselect_b32 s49, s27, s35
    s_mov_b32 s101, 0x1c0000
    s_cselect_b32 s50, 0x400000, s101
    s_mov_b32 s101, 4096
    s_cselect_b32 s72, 0, s101
    s_sub_u32 s72, s6, s72
    s_lshl_b32 s66, s72, 10
    s_add_u32 s66, s66, s7
    s_add_u32 s6, s6, 32
    s_add_u32 m0, s74, 73728
    s_nop 0
    buffer_load_dwordx4 v4, s[48:51], s66 offen lds
    s_add_u32 s66, s66, s68
    s_waitcnt lgkmcnt(5)
    v_mfma_f32_32x32x16_bf16 v[128:143], v[48:51], v[72:75], v[128:143]
    ds_read_b64_tr_b16 v[32:33], v30 offset:0
    ds_read_b64_tr_b16 v[34:35], v30 offset:1024
    ds_read_b64_tr_b16 v[36:37], v31 offset:0
    v_mfma_f32_32x32x16_bf16 v[144:159], v[52:55], v[72:75], v[144:159]
    ds_read_b64_tr_b16 v[38:39], v31 offset:1024
    ds_read_b128 v[64:67], v28 offset:0
    s_waitcnt lgkmcnt(5)
    v_mfma_f32_32x32x16_bf16 v[128:143], v[56:59], v[76:79], v[128:143]
    ds_read_b64_tr_b16 v[40:41], v30 offset:4096
    ds_read_b64_tr_b16 v[42:43], v30 offset:5120
    ds_read_b64_tr_b16 v[44:45], v31 offset:4096
    ds_read_b64_tr_b16 v[46:47], v31 offset:5120
    v_mfma_f32_32x32x16_bf16 v[144:159], v[60:63], v[76:79], v[144:159]
    ds_read_b128 v[68:71], v29 offset:0
    s_add_u32 m0, s71, 81920
    s_nop 0
    buffer_load_dwordx4 v2, s[44:47], s65 offen lds
    s_add_u32 s65, s65, 131072
    s_cmp_lt_u32 s6, 4096
    s_cselect_b32 s48, s26, s34
    s_cselect_b32 s49, s27, s35
    s_mov_b32 s101, 0x1c0000
    s_cselect_b32 s50, 0x400000, s101
    s_mov_b32 s101, 4096
    s_cselect_b32 s72, 0, s101
    s_sub_u32 s72, s6, s72
    s_lshl_b32 s66, s72, 10
    s_add_u32 s66, s66, s7
    s_add_u32 s6, s6, 32
    s_add_u32 m0, s74, 90112
    s_nop 0
    buffer_load_dwordx4 v4, s[48:51], s66 offen lds
    s_add_u32 s66, s66, s68
    s_waitcnt vmcnt(10)
    s_barrier
    s_waitcnt lgkmcnt(5)
    v_mfma_f32_32x32x16_bf16 v[128:143], v[32:35], v[64:67], v[128:143]
    ds_read_b64_tr_b16 v[48:49], v30 offset:16384
    ds_read_b64_tr_b16 v[50:51], v30 offset:17408
    ds_read_b64_tr_b16 v[52:53], v31 offset:16384
    v_mfma_f32_32x32x16_bf16 v[144:159], v[36:39], v[64:67], v[144:159]
    ds_read_b64_tr_b16 v[54:55], v31 offset:17408
    ds_read_b128 v[72:75], v28 offset:16384
    s_waitcnt lgkmcnt(5)
    v_mfma_f32_32x32x16_bf16 v[128:143], v[40:43], v[68:71], v[128:143]
    ds_read_b64_tr_b16 v[56:57], v30 offset:20480
    ds_read_b64_tr_b16 v[58:59], v30 offset:21504
    ds_read_b64_tr_b16 v[60:61], v31 offset:20480
    ds_read_b64_tr_b16 v[62:63], v31 offset:21504
    v_mfma_f32_32x32x16_bf16 v[144:159], v[44:47], v[68:71], v[144:159]
    ds_read_b128 v[76:79], v29 offset:16384
    s_add_u32 m0, s71, 98304
    s_nop 0
    buffer_load_dwordx4 v2, s[44:47], s65 offen lds
    s_add_u32 s65, s65, 131072
    s_cmp_lt_u32 s6, 4096
    s_cselect_b32 s48, s26, s34
    s_cselect_b32 s49, s27, s35
    s_mov_b32 s101, 0x1c0000
    s_cselect_b32 s50, 0x400000, s101
    s_mov_b32 s101, 4096
    s_cselect_b32 s72, 0, s101
    s_sub_u32 s72, s6, s72
    s_lshl_b32 s66, s72, 10
    s_add_u32 s66, s66, s7
    s_add_u32 s6, s6, 32
    s_add_u32 m0, s74, 106496
    s_nop 0
    buffer_load_dwordx4 v4, s[48:51], s66 offen lds
    s_add_u32 s66, s66, s68
    s_waitcnt lgkmcnt(5)
    v_mfma_f32_32x32x16_bf16 v[128:143], v[48:51], v[72:75], v[128:143]
    ds_read_b64_tr_b16 v[32:33], v10 offset:0
    ds_read_b64_tr_b16 v[34:35], v10 offset:1024
    ds_read_b64_tr_b16 v[36:37], v11 offset:0
    v_mfma_f32_32x32x16_bf16 v[144:159], v[52:55], v[72:75], v[144:159]
    ds_read_b64_tr_b16 v[38:39], v11 offset:1024
    ds_read_b128 v[64:67], v6 offset:0
    s_waitcnt lgkmcnt(5)
    v_mfma_f32_32x32x16_bf16 v[128:143], v[56:59], v[76:79], v[128:143]
    ds_read_b64_tr_b16 v[40:41], v10 offset:4096
    ds_read_b64_tr_b16 v[42:43], v10 offset:5120
    ds_read_b64_tr_b16 v[44:45], v11 offset:4096
    ds_read_b64_tr_b16 v[46:47], v11 offset:5120
    v_mfma_f32_32x32x16_bf16 v[144:159], v[60:63], v[76:79], v[144:159]
    ds_read_b128 v[68:71], v7 offset:0
    s_add_u32 m0, s71, 114688
    s_nop 0
    buffer_load_dwordx4 v2, s[44:47], s65 offen lds
    s_add_u32 s65, s65, 131072
    s_cmp_lt_u32 s6, 4096
    s_cselect_b32 s48, s26, s34
    s_cselect_b32 s49, s27, s35
    s_mov_b32 s101, 0x1c0000
    s_cselect_b32 s50, 0x400000, s101
    s_mov_b32 s101, 4096
    s_cselect_b32 s72, 0, s101
    s_sub_u32 s72, s6, s72
    s_lshl_b32 s66, s72, 10
    s_add_u32 s66, s66, s7
    s_add_u32 s6, s6, 32
    s_add_u32 m0, s74, 122880
    s_nop 0
    buffer_load_dwordx4 v4, s[48:51], s66 offen lds
    s_add_u32 s66, s66, s68
    s_waitcnt vmcnt(10)
    s_barrier
    s_waitcnt lgkmcnt(5)
    v_mfma_f32_32x32x16_bf16 v[128:143], v[32:35], v[64:67], v[128:143]
    ds_read_b64_tr_b16 v[48:49], v10 offset:16384
    ds_read_b64_tr_b16 v[50:51], v10 offset:17408
    ds_read_b64_tr_b16 v[52:53], v11 offset:16384
    v_mfma_f32_32x32x16_bf16 v[144:159], v[36:39], v[64:67], v[144:159]
    ds_read_b64_tr_b16 v[54:55], v11 offset:17408
    ds_read_b128 v[72:75], v6 offset:16384
    s_waitcnt lgkmcnt(5)
    v_mfma_f32_32x32x16_bf16 v[128:143], v[40:43], v[68:71], v[128:143]
    ds_read_b64_tr_b16 v[56:57], v10 offset:20480
    ds_read_b64_tr_b16 v[58:59], v10 offset:21504
    ds_read_b64_tr_b16 v[60:61], v11 offset:20480
    ds_read_b64_tr_b16 v[62:63], v11 offset:21504
    v_mfma_f32_32x32x16_bf16 v[144:159], v[44:47], v[68:71], v[144:159]
    ds_read_b128 v[76:79], v7 offset:16384
    s_add_u32 m0, s71, 131072
    s_nop 0
    buffer_load_dwordx4 v2, s[44:47], s65 offen lds
    s_add_u32 s65, s65, 131072
    s_cmp_lt_u32 s6, 4096
    s_cselect_b32 s48, s26, s34
    s_cselect_b32 s49, s27, s35
    s_mov_b32 s101, 0x1c0000
    s_cselect_b32 s50, 0x400000, s101
    s_mov_b32 s101, 4096
    s_cselect_b32 s72, 0, s101
    s_sub_u32 s72, s6, s72
    s_lshl_b32 s66, s72, 10
    s_add_u32 s66, s66, s7
    s_add_u32 s6, s6, 32
    s_add_u32 m0, s74, 139264
    s_nop 0
    buffer_load_dwordx4 v4, s[48:51], s66 offen lds
    s_add_u32 s66, s66, s68
    s_waitcnt lgkmcnt(5)
    v_mfma_f32_32x32x16_bf16 v[128:143], v[48:51], v[72:75], v[128:143]
    ds_read_b64_tr_b16 v[32:33], v10 offset:32768
    ds_read_b64_tr_b16 v[34:35], v10 offset:33792
    ds_read_b64_tr_b16 v[36:37], v11 offset:32768
    v_mfma_f32_32x32x16_bf16 v[144:159], v[52:55], v[72:75], v[144:159]
    ds_read_b64_tr_b16 v[38:39], v11 offset:33792
    ds_read_b128 v[64:67], v6 offset:32768
    s_waitcnt lgkmcnt(5)
    v_mfma_f32_32x32x16_bf16 v[128:143], v[56:59], v[76:79], v[128:143]
    ds_read_b64_tr_b16 v[40:41], v10 offset:36864
    ds_read_b64_tr_b16 v[42:43], v10 offset:37888
    ds_read_b64_tr_b16 v[44:45], v11 offset:36864
    ds_read_b64_tr_b16 v[46:47], v11 offset:37888
    v_mfma_f32_32x32x16_bf16 v[144:159], v[60:63], v[76:79], v[144:159]
    ds_read_b128 v[68:71], v7 offset:32768
    s_add_u32 m0, s71, 147456
    s_nop 0
    buffer_load_dwordx4 v2, s[44:47], s65 offen lds
    s_add_u32 s65, s65, 131072
    s_cmp_lt_u32 s6, 4096
    s_cselect_b32 s48, s26, s34
    s_cselect_b32 s49, s27, s35
    s_mov_b32 s101, 0x1c0000
    s_cselect_b32 s50, 0x400000, s101
    s_mov_b32 s101, 4096
    s_cselect_b32 s72, 0, s101
    s_sub_u32 s72, s6, s72
    s_lshl_b32 s66, s72, 10
    s_add_u32 s66, s66, s7
    s_add_u32 s6, s6, 32
    s_add_u32 m0, s74, 155648
    s_nop 0
    buffer_load_dwordx4 v4, s[48:51], s66 offen lds
    s_add_u32 s66, s66, s68
    s_waitcnt vmcnt(10)
    s_barrier
    s_waitcnt lgkmcnt(5)
    v_mfma_f32_32x32x16_bf16 v[128:143], v[32:35], v[64:67], v[128:143]
    ds_read_b64_tr_b16 v[48:49], v10 offset:49152
    ds_read_b64_tr_b16 v[50:51], v10 offset:50176
    ds_read_b64_tr_b16 v[52:53], v11 offset:49152
    v_mfma_f32_32x32x16_bf16 v[144:159], v[36:39], v[64:67], v[144:159]
    ds_read_b64_tr_b16 v[54:55], v11 offset:50176
    ds_read_b128 v[72:75], v6 offset:49152
    s_waitcnt lgkmcnt(5)
    v_mfma_f32_32x32x16_bf16 v[128:143], v[40:43], v[68:71], v[128:143]
    ds_read_b64_tr_b16 v[56:57], v10 offset:53248
    ds_read_b64_tr_b16 v[58:59], v10 offset:54272
    ds_read_b64_tr_b16 v[60:61], v11 offset:53248
    ds_read_b64_tr_b16 v[62:63], v11 offset:54272
    v_mfma_f32_32x32x16_bf16 v[144:159], v[44:47], v[68:71], v[144:159]
    ds_read_b128 v[76:79], v7 offset:49152
    s_add_u32 m0, s71, 0
    s_nop 0
    buffer_load_dwordx4 v2, s[44:47], s65 offen lds
    s_add_u32 s65, s65, 131072
    s_cmp_lt_u32 s6, 4096
    s_cselect_b32 s48, s26, s34
    s_cselect_b32 s49, s27, s35
    s_mov_b32 s101, 0x1c0000
    s_cselect_b32 s50, 0x400000, s101
    s_mov_b32 s101, 4096
    s_cselect_b32 s72, 0, s101
    s_sub_u32 s72, s6, s72
    s_lshl_b32 s66, s72, 10
    s_add_u32 s66, s66, s7
    s_add_u32 s6, s6, 32
    s_add_u32 m0, s74, 8192
    s_nop 0
    buffer_load_dwordx4 v4, s[48:51], s66 offen lds
    s_add_u32 s66, s66, s68
    s_waitcnt lgkmcnt(5)
    v_mfma_f32_32x32x16_bf16 v[128:143], v[48:51], v[72:75], v[128:143]
    ds_read_b64_tr_b16 v[32:33], v12 offset:0
    ds_read_b64_tr_b16 v[34:35], v12 offset:1024
    ds_read_b64_tr_b16 v[36:37], v13 offset:0
    v_mfma_f32_32x32x16_bf16 v[144:159], v[52:55], v[72:75], v[144:159]
    ds_read_b64_tr_b16 v[38:39], v13 offset:1024
    ds_read_b128 v[64:67], v8 offset:0
    s_waitcnt lgkmcnt(5)
    v_mfma_f32_32x32x16_bf16 v[128:143], v[56:59], v[76:79], v[128:143]
    ds_read_b64_tr_b16 v[40:41], v12 offset:4096
    ds_read_b64_tr_b16 v[42:43], v12 offset:5120
    ds_read_b64_tr_b16 v[44:45], v13 offset:4096
    ds_read_b64_tr_b16 v[46:47], v13 offset:5120
    v_mfma_f32_32x32x16_bf16 v[144:159], v[60:63], v[76:79], v[144:159]
    ds_read_b128 v[68:71], v9 offset:0
    s_add_u32 m0, s71, 16384
    s_nop 0
    buffer_load_dwordx4 v2, s[44:47], s65 offen lds
    s_add_u32 s65, s65, 131072
    s_cmp_lt_u32 s6, 4096
    s_cselect_b32 s48, s26, s34
    s_cselect_b32 s49, s27, s35
    s_mov_b32 s101, 0x1c0000
    s_cselect_b32 s50, 0x400000, s101
    s_mov_b32 s101, 4096
    s_cselect_b32 s72, 0, s101
    s_sub_u32 s72, s6, s72
    s_lshl_b32 s66, s72, 10
    s_add_u32 s66, s66, s7
    s_add_u32 s6, s6, 32
    s_add_u32 m0, s74, 24576
    s_nop 0
    buffer_load_dwordx4 v4, s[48:51], s66 offen lds
    s_add_u32 s66, s66, s68
    s_waitcnt vmcnt(10)
    s_barrier
    s_waitcnt lgkmcnt(5)
    v_mfma_f32_32x32x16_bf16 v[128:143], v[32:35], v[64:67], v[128:143]
    ds_read_b64_tr_b16 v[48:49], v12 offset:16384
    ds_read_b64_tr_b16 v[50:51], v12 offset:17408
    ds_read_b64_tr_b16 v[52:53], v13 offset:16384
    v_mfma_f32_32x32x16_bf16 v[144:159], v[36:39], v[64:67], v[144:159]
    ds_read_b64_tr_b16 v[54:55], v13 offset:17408
    ds_read_b128 v[72:75], v8 offset:16384
    s_waitcnt lgkmcnt(5)
    v_mfma_f32_32x32x16_bf16 v[128:143], v[40:43], v[68:71], v[128:143]
    ds_read_b64_tr_b16 v[56:57], v12 offset:20480
    ds_read_b64_tr_b16 v[58:59], v12 offset:21504
    ds_read_b64_tr_b16 v[60:61], v13 offset:20480
    ds_read_b64_tr_b16 v[62:63], v13 offset:21504
    v_mfma_f32_32x32x16_bf16 v[144:159], v[44:47], v[68:71], v[144:159]
    ds_read_b128 v[76:79], v9 offset:16384
    s_add_u32 m0, s71, 32768
    s_nop 0
    buffer_load_dwordx4 v2, s[44:47], s65 offen lds
    s_add_u32 s65, s65, 131072
    s_cmp_lt_u32 s6, 4096
    s_cselect_b32 s48, s26, s34
    s_cselect_b32 s49, s27, s35
    s_mov_b32 s101, 0x1c0000
    s_cselect_b32 s50, 0x400000, s101
    s_mov_b32 s101, 4096
    s_cselect_b32 s72, 0, s101
    s_sub_u32 s72, s6, s72
    s_lshl_b32 s66, s72, 10
    s_add_u32 s66, s66, s7
    s_add_u32 s6, s6, 32
    s_add_u32 m0, s74, 40960
    s_nop 0
    buffer_load_dwordx4 v4, s[48:51], s66 offen lds
    s_add_u32 s66, s66, s68
    s_waitcnt lgkmcnt(5)
    v_mfma_f32_32x32x16_bf16 v[128:143], v[48:51], v[72:75], v[128:143]
    ds_read_b64_tr_b16 v[32:33], v12 offset:32768
    ds_read_b64_tr_b16 v[34:35], v12 offset:33792
    ds_read_b64_tr_b16 v[36:37], v13 offset:32768
    v_mfma_f32_32x32x16_bf16 v[144:159], v[52:55], v[72:75], v[144:159]
    ds_read_b64_tr_b16 v[38:39], v13 offset:33792
    ds_read_b128 v[64:67], v8 offset:32768
    s_waitcnt lgkmcnt(5)
    v_mfma_f32_32x32x16_bf16 v[128:143], v[56:59], v[76:79], v[128:143]
    ds_read_b64_tr_b16 v[40:41], v12 offset:36864
    ds_read_b64_tr_b16 v[42:43], v12 offset:37888
    ds_read_b64_tr_b16 v[44:45], v13 offset:36864
    ds_read_b64_tr_b16 v[46:47], v13 offset:37888
    v_mfma_f32_32x32x16_bf16 v[144:159], v[60:63], v[76:79], v[144:159]
    ds_read_b128 v[68:71], v9 offset:32768
    s_add_u32 m0, s71, 49152
    s_nop 0
    buffer_load_dwordx4 v2, s[44:47], s65 offen lds
    s_add_u32 s65, s65, 131072
    s_cmp_lt_u32 s6, 4096
    s_cselect_b32 s48, s26, s34
    s_cselect_b32 s49, s27, s35
    s_mov_b32 s101, 0x1c0000
    s_cselect_b32 s50, 0x400000, s101
    s_mov_b32 s101, 4096
    s_cselect_b32 s72, 0, s101
    s_sub_u32 s72, s6, s72
    s_lshl_b32 s66, s72, 10
    s_add_u32 s66, s66, s7
    s_add_u32 s6, s6, 32
    s_add_u32 m0, s74, 57344
    s_nop 0
    buffer_load_dwordx4 v4, s[48:51], s66 offen lds
    s_add_u32 s66, s66, s68
    s_waitcnt vmcnt(10)
    s_barrier
    s_waitcnt lgkmcnt(5)
    v_mfma_f32_32x32x16_bf16 v[128:143], v[32:35], v[64:67], v[128:143]
    ds_read_b64_tr_b16 v[48:49], v12 offset:49152
    ds_read_b64_tr_b16 v[50:51], v12 offset:50176
    ds_read_b64_tr_b16 v[52:53], v13 offset:49152
    v_mfma_f32_32x32x16_bf16 v[144:159], v[36:39], v[64:67], v[144:159]
    ds_read_b64_tr_b16 v[54:55], v13 offset:50176
    ds_read_b128 v[72:75], v8 offset:49152
    s_waitcnt lgkmcnt(5)
    v_mfma_f32_32x32x16_bf16 v[128:143], v[40:43], v[68:71], v[128:143]
    ds_read_b64_tr_b16 v[56:57], v12 offset:53248
    ds_read_b64_tr_b16 v[58:59], v12 offset:54272
    ds_read_b64_tr_b16 v[60:61], v13 offset:53248
    ds_read_b64_tr_b16 v[62:63], v13 offset:54272
    v_mfma_f32_32x32x16_bf16 v[144:159], v[44:47], v[68:71], v[144:159]
    ds_read_b128 v[76:79], v9 offset:49152
    s_add_u32 m0, s71, 65536
    s_nop 0
    buffer_load_dwordx4 v2, s[44:47], s65 offen lds
    s_add_u32 s65, s65, 131072
    s_cmp_lt_u32 s6, 4096
    s_cselect_b32 s48, s26, s34
    s_cselect_b32 s49, s27, s35
    s_mov_b32 s101, 0x1c0000
    s_cselect_b32 s50, 0x400000, s101
    s_mov_b32 s101, 4096
    s_cselect_b32 s72, 0, s101
    s_sub_u32 s72, s6, s72
    s_lshl_b32 s66, s72, 10
    s_add_u32 s66, s66, s7
    s_add_u32 s6, s6, 32
    s_add_u32 m0, s74, 73728
    s_nop 0
    buffer_load_dwordx4 v4, s[48:51], s66 offen lds
    s_add_u32 s66, s66, s68
    s_waitcnt lgkmcnt(5)
    v_mfma_f32_32x32x16_bf16 v[128:143], v[48:51], v[72:75], v[128:143]
    ds_read_b64_tr_b16 v[32:33], v30 offset:0
    ds_read_b64_tr_b16 v[34:35], v30 offset:1024
    ds_read_b64_tr_b16 v[36:37], v31 offset:0
    v_mfma_f32_32x32x16_bf16 v[144:159], v[52:55], v[72:75], v[144:159]
    ds_read_b64_tr_b16 v[38:39], v31 offset:1024
    ds_read_b128 v[64:67], v28 offset:0
    s_waitcnt lgkmcnt(5)
    v_mfma_f32_32x32x16_bf16 v[128:143], v[56:59], v[76:79], v[128:143]
    ds_read_b64_tr_b16 v[40:41], v30 offset:4096
    ds_read_b64_tr_b16 v[42:43], v30 offset:5120
    ds_read_b64_tr_b16 v[44:45], v31 offset:4096
    ds_read_b64_tr_b16 v[46:47], v31 offset:5120
    v_mfma_f32_32x32x16_bf16 v[144:159], v[60:63], v[76:79], v[144:159]
    ds_read_b128 v[68:71], v29 offset:0
    s_add_u32 m0, s71, 81920
    s_nop 0
    buffer_load_dwordx4 v2, s[44:47], s65 offen lds
    s_add_u32 s65, s65, 131072
    s_cmp_lt_u32 s6, 4096
    s_cselect_b32 s48, s26, s34
    s_cselect_b32 s49, s27, s35
    s_mov_b32 s101, 0x1c0000
    s_cselect_b32 s50, 0x400000, s101
    s_mov_b32 s101, 4096
    s_cselect_b32 s72, 0, s101
    s_sub_u32 s72, s6, s72
    s_lshl_b32 s66, s72, 10
    s_add_u32 s66, s66, s7
    s_add_u32 s6, s6, 32
    s_add_u32 m0, s74, 90112
    s_nop 0
    buffer_load_dwordx4 v4, s[48:51], s66 offen lds
    s_add_u32 s66, s66, s68
    s_waitcnt vmcnt(10)
    s_barrier
    s_waitcnt lgkmcnt(5)
    v_mfma_f32_32x32x16_bf16 v[128:143], v[32:35], v[64:67], v[128:143]
    ds_read_b64_tr_b16 v[48:49], v30 offset:16384
    ds_read_b64_tr_b16 v[50:51], v30 offset:17408
    ds_read_b64_tr_b16 v[52:53], v31 offset:16384
    v_mfma_f32_32x32x16_bf16 v[144:159], v[36:39], v[64:67], v[144:159]
    ds_read_b64_tr_b16 v[54:55], v31 offset:17408
    ds_read_b128 v[72:75], v28 offset:16384
    s_waitcnt lgkmcnt(5)
    v_mfma_f32_32x32x16_bf16 v[128:143], v[40:43], v[68:71], v[128:143]
    ds_read_b64_tr_b16 v[56:57], v30 offset:20480
    ds_read_b64_tr_b16 v[58:59], v30 offset:21504
    ds_read_b64_tr_b16 v[60:61], v31 offset:20480
    ds_read_b64_tr_b16 v[62:63], v31 offset:21504
    v_mfma_f32_32x32x16_bf16 v[144:159], v[44:47], v[68:71], v[144:159]
    ds_read_b128 v[76:79], v29 offset:16384
    s_add_u32 m0, s71, 98304
    s_nop 0
    buffer_load_dwordx4 v2, s[44:47], s65 offen lds
    s_add_u32 s65, s65, 131072
    s_cmp_lt_u32 s6, 4096
    s_cselect_b32 s48, s26, s34
    s_cselect_b32 s49, s27, s35
    s_mov_b32 s101, 0x1c0000
    s_cselect_b32 s50, 0x400000, s101
    s_mov_b32 s101, 4096
    s_cselect_b32 s72, 0, s101
    s_sub_u32 s72, s6, s72
    s_lshl_b32 s66, s72, 10
    s_add_u32 s66, s66, s7
    s_add_u32 s6, s6, 32
    s_add_u32 m0, s74, 106496
    s_nop 0
    buffer_load_dwordx4 v4, s[48:51], s66 offen lds
    s_add_u32 s66, s66, s68
    s_waitcnt lgkmcnt(5)
    v_mfma_f32_32x32x16_bf16 v[128:143], v[48:51], v[72:75], v[128:143]
    ds_read_b64_tr_b16 v[32:33], v10 offset:0
    ds_read_b64_tr_b16 v[34:35], v10 offset:1024
    ds_read_b64_tr_b16 v[36:37], v11 offset:0
    v_mfma_f32_32x32x16_bf16 v[144:159], v[52:55], v[72:75], v[144:159]
    ds_read_b64_tr_b16 v[38:39], v11 offset:1024
    ds_read_b128 v[64:67], v6 offset:0
    s_waitcnt lgkmcnt(5)
    v_mfma_f32_32x32x16_bf16 v[128:143], v[56:59], v[76:79], v[128:143]
    ds_read_b64_tr_b16 v[40:41], v10 offset:4096
    ds_read_b64_tr_b16 v[42:43], v10 offset:5120
    ds_read_b64_tr_b16 v[44:45], v11 offset:4096
    ds_read_b64_tr_b16 v[46:47], v11 offset:5120
    v_mfma_f32_32x32x16_bf16 v[144:159], v[60:63], v[76:79], v[144:159]
    ds_read_b128 v[68:71], v7 offset:0
    s_add_u32 m0, s71, 114688
    s_nop 0
    buffer_load_dwordx4 v2, s[44:47], s65 offen lds
    s_add_u32 s65, s65, 131072
    s_cmp_lt_u32 s6, 4096
    s_cselect_b32 s48, s26, s34
    s_cselect_b32 s49, s27, s35
    s_mov_b32 s101, 0x1c0000
    s_cselect_b32 s50, 0x400000, s101
    s_mov_b32 s101, 4096
    s_cselect_b32 s72, 0, s101
    s_sub_u32 s72, s6, s72
    s_lshl_b32 s66, s72, 10
    s_add_u32 s66, s66, s7
    s_add_u32 s6, s6, 32
    s_add_u32 m0, s74, 122880
    s_nop 0
    buffer_load_dwordx4 v4, s[48:51], s66 offen lds
    s_add_u32 s66, s66, s68
    s_waitcnt vmcnt(10)
    s_barrier
    s_waitcnt lgkmcnt(5)
    v_mfma_f32_32x32x16_bf16 v[128:143], v[32:35], v[64:67], v[128:143]
    ds_read_b64_tr_b16 v[48:49], v10 offset:16384
    ds_read_b64_tr_b16 v[50:51], v10 offset:17408
    ds_read_b64_tr_b16 v[52:53], v11 offset:16384
    v_mfma_f32_32x32x16_bf16 v[144:159], v[36:39], v[64:67], v[144:159]
    ds_read_b64_tr_b16 v[54:55], v11 offset:17408
    ds_read_b128 v[72:75], v6 offset:16384
    s_waitcnt lgkmcnt(5)
    v_mfma_f32_32x32x16_bf16 v[128:143], v[40:43], v[68:71], v[128:143]
    ds_read_b64_tr_b16 v[56:57], v10 offset:20480
    ds_read_b64_tr_b16 v[58:59], v10 offset:21504
    ds_read_b64_tr_b16 v[60:61], v11 offset:20480
    ds_read_b64_tr_b16 v[62:63], v11 offset:21504
    v_mfma_f32_32x32x16_bf16 v[144:159], v[44:47], v[68:71], v[144:159]
    ds_read_b128 v[76:79], v7 offset:16384
    s_add_u32 m0, s71, 131072
    s_nop 0
    buffer_load_dwordx4 v2, s[44:47], s65 offen lds
    s_add_u32 s65, s65, 131072
    s_cmp_lt_u32 s6, 4096
    s_cselect_b32 s48, s26, s34
    s_cselect_b32 s49, s27, s35
    s_mov_b32 s101, 0x1c0000
    s_cselect_b32 s50, 0x400000, s101
    s_mov_b32 s101, 4096
    s_cselect_b32 s72, 0, s101
    s_sub_u32 s72, s6, s72
    s_lshl_b32 s66, s72, 10
    s_add_u32 s66, s66, s7
    s_add_u32 s6, s6, 32
    s_add_u32 m0, s74, 139264
    s_nop 0
    buffer_load_dwordx4 v4, s[48:51], s66 offen lds
    s_add_u32 s66, s66, s68
    s_waitcnt lgkmcnt(5)
    v_mfma_f32_32x32x16_bf16 v[128:143], v[48:51], v[72:75], v[128:143]
    ds_read_b64_tr_b16 v[32:33], v10 offset:32768
    ds_read_b64_tr_b16 v[34:35], v10 offset:33792
    ds_read_b64_tr_b16 v[36:37], v11 offset:32768
    v_mfma_f32_32x32x16_bf16 v[144:159], v[52:55], v[72:75], v[144:159]
    ds_read_b64_tr_b16 v[38:39], v11 offset:33792
    ds_read_b128 v[64:67], v6 offset:32768
    s_waitcnt lgkmcnt(5)
    v_mfma_f32_32x32x16_bf16 v[128:143], v[56:59], v[76:79], v[128:143]
    ds_read_b64_tr_b16 v[40:41], v10 offset:36864
    ds_read_b64_tr_b16 v[42:43], v10 offset:37888
    ds_read_b64_tr_b16 v[44:45], v11 offset:36864
    ds_read_b64_tr_b16 v[46:47], v11 offset:37888
    v_mfma_f32_32x32x16_bf16 v[144:159], v[60:63], v[76:79], v[144:159]
    ds_read_b128 v[68:71], v7 offset:32768
    s_add_u32 m0, s71, 147456
    s_nop 0
    buffer_load_dwordx4 v2, s[44:47], s65 offen lds
    s_add_u32 s65, s65, 131072
    s_cmp_lt_u32 s6, 4096
    s_cselect_b32 s48, s26, s34
    s_cselect_b32 s49, s27, s35
    s_mov_b32 s101, 0x1c0000
    s_cselect_b32 s50, 0x400000, s101
    s_mov_b32 s101, 4096
    s_cselect_b32 s72, 0, s101
    s_sub_u32 s72, s6, s72
    s_lshl_b32 s66, s72, 10
    s_add_u32 s66, s66, s7
    s_add_u32 s6, s6, 32
    s_add_u32 m0, s74, 155648
    s_nop 0
    buffer_load_dwordx4 v4, s[48:51], s66 offen lds
    s_add_u32 s66, s66, s68
    s_waitcnt vmcnt(10)
    s_barrier
    s_waitcnt lgkmcnt(5)
    v_mfma_f32_32x32x16_bf16 v[128:143], v[32:35], v[64:67], v[128:143]
    ds_read_b64_tr_b16 v[48:49], v10 offset:49152
    ds_read_b64_tr_b16 v[50:51], v10 offset:50176
    ds_read_b64_tr_b16 v[52:53], v11 offset:49152
    v_mfma_f32_32x32x16_bf16 v[144:159], v[36:39], v[64:67], v[144:159]
    ds_read_b64_tr_b16 v[54:55], v11 offset:50176
    ds_read_b128 v[72:75], v6 offset:49152
    s_waitcnt lgkmcnt(5)
    v_mfma_f32_32x32x16_bf16 v[128:143], v[40:43], v[68:71], v[128:143]
    ds_read_b64_tr_b16 v[56:57], v10 offset:53248
    ds_read_b64_tr_b16 v[58:59], v10 offset:54272
    ds_read_b64_tr_b16 v[60:61], v11 offset:53248
    ds_read_b64_tr_b16 v[62:63], v11 offset:54272
    v_mfma_f32_32x32x16_bf16 v[144:159], v[44:47], v[68:71], v[144:159]
    ds_read_b128 v[76:79], v7 offset:49152
    s_add_u32 m0, s71, 0
    s_nop 0
    buffer_load_dwordx4 v2, s[44:47], s65 offen lds
    s_add_u32 s65, s65, 131072
    s_cmp_lt_u32 s6, 4096
    s_cselect_b32 s48, s26, s34
    s_cselect_b32 s49, s27, s35
    s_mov_b32 s101, 0x1c0000
    s_cselect_b32 s50, 0x400000, s101
    s_mov_b32 s101, 4096
    s_cselect_b32 s72, 0, s101
    s_sub_u32 s72, s6, s72
    s_lshl_b32 s66, s72, 10
    s_add_u32 s66, s66, s7
    s_add_u32 s6, s6, 32
    s_add_u32 m0, s74, 8192
    s_nop 0
    buffer_load_dwordx4 v4, s[48:51], s66 offen lds
    s_add_u32 s66, s66, s68
    s_waitcnt lgkmcnt(5)
    v_mfma_f32_32x32x16_bf16 v[128:143], v[48:51], v[72:75], v[128:143]
    ds_read_b64_tr_b16 v[32:33], v12 offset:0
    ds_read_b64_tr_b16 v[34:35], v12 offset:1024
    ds_read_b64_tr_b16 v[36:37], v13 offset:0
    v_mfma_f32_32x32x16_bf16 v[144:159], v[52:55], v[72:75], v[144:159]
    ds_read_b64_tr_b16 v[38:39], v13 offset:1024
    ds_read_b128 v[64:67], v8 offset:0
    s_waitcnt lgkmcnt(5)
    v_mfma_f32_32x32x16_bf16 v[128:143], v[56:59], v[76:79], v[128:143]
    ds_read_b64_tr_b16 v[40:41], v12 offset:4096
    ds_read_b64_tr_b16 v[42:43], v12 offset:5120
    ds_read_b64_tr_b16 v[44:45], v13 offset:4096
    ds_read_b64_tr_b16 v[46:47], v13 offset:5120
    v_mfma_f32_32x32x16_bf16 v[144:159], v[60:63], v[76:79], v[144:159]
    ds_read_b128 v[68:71], v9 offset:0
    s_add_u32 m0, s71, 16384
    s_nop 0
    buffer_load_dwordx4 v2, s[44:47], s65 offen lds
    s_add_u32 s65, s65, 131072
    s_cmp_lt_u32 s6, 4096
    s_cselect_b32 s48, s26, s34
    s_cselect_b32 s49, s27, s35
    s_mov_b32 s101, 0x1c0000
    s_cselect_b32 s50, 0x400000, s101
    s_mov_b32 s101, 4096
    s_cselect_b32 s72, 0, s101
    s_sub_u32 s72, s6, s72
    s_lshl_b32 s66, s72, 10
    s_add_u32 s66, s66, s7
    s_add_u32 s6, s6, 32
    s_add_u32 m0, s74, 24576
    s_nop 0
    buffer_load_dwordx4 v4, s[48:51], s66 offen lds
    s_add_u32 s66, s66, s68
    s_waitcnt vmcnt(10)
    s_barrier
    s_waitcnt lgkmcnt(5)
    v_mfma_f32_32x32x16_bf16 v[128:143], v[32:35], v[64:67], v[128:143]
    ds_read_b64_tr_b16 v[48:49], v12 offset:16384
    ds_read_b64_tr_b16 v[50:51], v12 offset:17408
    ds_read_b64_tr_b16 v[52:53], v13 offset:16384
    v_mfma_f32_32x32x16_bf16 v[144:159], v[36:39], v[64:67], v[144:159]
    ds_read_b64_tr_b16 v[54:55], v13 offset:17408
    ds_read_b128 v[72:75], v8 offset:16384
    s_waitcnt lgkmcnt(5)
    v_mfma_f32_32x32x16_bf16 v[128:143], v[40:43], v[68:71], v[128:143]
    ds_read_b64_tr_b16 v[56:57], v12 offset:20480
    ds_read_b64_tr_b16 v[58:59], v12 offset:21504
    ds_read_b64_tr_b16 v[60:61], v13 offset:20480
    ds_read_b64_tr_b16 v[62:63], v13 offset:21504
    v_mfma_f32_32x32x16_bf16 v[144:159], v[44:47], v[68:71], v[144:159]
    ds_read_b128 v[76:79], v9 offset:16384
    s_add_u32 m0, s71, 32768
    s_nop 0
    buffer_load_dwordx4 v2, s[44:47], s65 offen lds
    s_add_u32 s65, s65, 131072
    s_cmp_lt_u32 s6, 4096
    s_cselect_b32 s48, s26, s34
    s_cselect_b32 s49, s27, s35
    s_mov_b32 s101, 0x1c0000
    s_cselect_b32 s50, 0x400000, s101
    s_mov_b32 s101, 4096
    s_cselect_b32 s72, 0, s101
    s_sub_u32 s72, s6, s72
    s_lshl_b32 s66, s72, 10
    s_add_u32 s66, s66, s7
    s_add_u32 s6, s6, 32
    s_add_u32 m0, s74, 40960
    s_nop 0
    buffer_load_dwordx4 v4, s[48:51], s66 offen lds
    s_add_u32 s66, s66, s68
    s_waitcnt lgkmcnt(5)
    v_mfma_f32_32x32x16_bf16 v[128:143], v[48:51], v[72:75], v[128:143]
    ds_read_b64_tr_b16 v[32:33], v12 offset:32768
    ds_read_b64_tr_b16 v[34:35], v12 offset:33792
    ds_read_b64_tr_b16 v[36:37], v13 offset:32768
    v_mfma_f32_32x32x16_bf16 v[144:159], v[52:55], v[72:75], v[144:159]
    ds_read_b64_tr_b16 v[38:39], v13 offset:33792
    ds_read_b128 v[64:67], v8 offset:32768
    s_waitcnt lgkmcnt(5)
    v_mfma_f32_32x32x16_bf16 v[128:143], v[56:59], v[76:79], v[128:143]
    ds_read_b64_tr_b16 v[40:41], v12 offset:36864
    ds_read_b64_tr_b16 v[42:43], v12 offset:37888
    ds_read_b64_tr_b16 v[44:45], v13 offset:36864
    ds_read_b64_tr_b16 v[46:47], v13 offset:37888
    v_mfma_f32_32x32x16_bf16 v[144:159], v[60:63], v[76:79], v[144:159]
    ds_read_b128 v[68:71], v9 offset:32768
    s_add_u32 m0, s71, 49152
    s_nop 0
    buffer_load_dwordx4 v2, s[44:47], s65 offen lds
    s_add_u32 s65, s65, 131072
    s_cmp_lt_u32 s6, 4096
    s_cselect_b32 s48, s26, s34
    s_cselect_b32 s49, s27, s35
    s_mov_b32 s101, 0x1c0000
    s_cselect_b32 s50, 0x400000, s101
    s_mov_b32 s101, 4096
    s_cselect_b32 s72, 0, s101
    s_sub_u32 s72, s6, s72
    s_lshl_b32 s66, s72, 10
    s_add_u32 s66, s66, s7
    s_add_u32 s6, s6, 32
    s_add_u32 m0, s74, 57344
    s_nop 0
    buffer_load_dwordx4 v4, s[48:51], s66 offen lds
    s_add_u32 s66, s66, s68
    s_waitcnt vmcnt(10)
    s_barrier
    s_waitcnt lgkmcnt(5)
    v_mfma_f32_32x32x16_bf16 v[128:143], v[32:35], v[64:67], v[128:143]
    ds_read_b64_tr_b16 v[48:49], v12 offset:49152
    ds_read_b64_tr_b16 v[50:51], v12 offset:50176
    ds_read_b64_tr_b16 v[52:53], v13 offset:49152
    v_mfma_f32_32x32x16_bf16 v[144:159], v[36:39], v[64:67], v[144:159]
    ds_read_b64_tr_b16 v[54:55], v13 offset:50176
    ds_read_b128 v[72:75], v8 offset:49152
    s_waitcnt lgkmcnt(5)
    v_mfma_f32_32x32x16_bf16 v[128:143], v[40:43], v[68:71], v[128:143]
    ds_read_b64_tr_b16 v[56:57], v12 offset:53248
    ds_read_b64_tr_b16 v[58:59], v12 offset:54272
    ds_read_b64_tr_b16 v[60:61], v13 offset:53248
    ds_read_b64_tr_b16 v[62:63], v13 offset:54272
    v_mfma_f32_32x32x16_bf16 v[144:159], v[44:47], v[68:71], v[144:159]
    ds_read_b128 v[76:79], v9 offset:49152
    s_add_u32 m0, s71, 65536
    s_nop 0
    buffer_load_dwordx4 v2, s[44:47], s65 offen lds
    s_add_u32 s65, s65, 131072
    s_cmp_lt_u32 s6, 4096
    s_cselect_b32 s48, s26, s34
    s_cselect_b32 s49, s27, s35
    s_mov_b32 s101, 0x1c0000
    s_cselect_b32 s50, 0x400000, s101
    s_mov_b32 s101, 4096
    s_cselect_b32 s72, 0, s101
    s_sub_u32 s72, s6, s72
    s_lshl_b32 s66, s72, 10
    s_add_u32 s66, s66, s7
    s_add_u32 s6, s6, 32
    s_add_u32 m0, s74, 73728
    s_nop 0
    buffer_load_dwordx4 v4, s[48:51], s66 offen lds
    s_add_u32 s66, s66, s68
    s_waitcnt lgkmcnt(5)
    v_mfma_f32_32x32x16_bf16 v[128:143], v[48:51], v[72:75], v[128:143]
    ds_read_b64_tr_b16 v[32:33], v30 offset:0
    ds_read_b64_tr_b16 v[34:35], v30 offset:1024
    ds_read_b64_tr_b16 v[36:37], v31 offset:0
    v_mfma_f32_32x32x16_bf16 v[144:159], v[52:55], v[72:75], v[144:159]
    ds_read_b64_tr_b16 v[38:39], v31 offset:1024
    ds_read_b128 v[64:67], v28 offset:0
    s_waitcnt lgkmcnt(5)
    v_mfma_f32_32x32x16_bf16 v[128:143], v[56:59], v[76:79], v[128:143]
    ds_read_b64_tr_b16 v[40:41], v30 offset:4096
    ds_read_b64_tr_b16 v[42:43], v30 offset:5120
    ds_read_b64_tr_b16 v[44:45], v31 offset:4096
    ds_read_b64_tr_b16 v[46:47], v31 offset:5120
    v_mfma_f32_32x32x16_bf16 v[144:159], v[60:63], v[76:79], v[144:159]
    ds_read_b128 v[68:71], v29 offset:0
    s_add_u32 m0, s71, 81920
    s_nop 0
    buffer_load_dwordx4 v2, s[44:47], s65 offen lds
    s_add_u32 s65, s65, 131072
    s_cmp_lt_u32 s6, 4096
    s_cselect_b32 s48, s26, s34
    s_cselect_b32 s49, s27, s35
    s_mov_b32 s101, 0x1c0000
    s_cselect_b32 s50, 0x400000, s101
    s_mov_b32 s101, 4096
    s_cselect_b32 s72, 0, s101
    s_sub_u32 s72, s6, s72
    s_lshl_b32 s66, s72, 10
    s_add_u32 s66, s66, s7
    s_add_u32 s6, s6, 32
    s_add_u32 m0, s74, 90112
    s_nop 0
    buffer_load_dwordx4 v4, s[48:51], s66 offen lds
    s_add_u32 s66, s66, s68
    s_waitcnt vmcnt(10)
    s_barrier
    s_waitcnt lgkmcnt(5)
    v_mfma_f32_32x32x16_bf16 v[128:143], v[32:35], v[64:67], v[128:143]
    ds_read_b64_tr_b16 v[48:49], v30 offset:16384
    ds_read_b64_tr_b16 v[50:51], v30 offset:17408
    ds_read_b64_tr_b16 v[52:53], v31 offset:16384
    v_mfma_f32_32x32x16_bf16 v[144:159], v[36:39], v[64:67], v[144:159]
    ds_read_b64_tr_b16 v[54:55], v31 offset:17408
    ds_read_b128 v[72:75], v28 offset:16384
    s_waitcnt lgkmcnt(5)
    v_mfma_f32_32x32x16_bf16 v[128:143], v[40:43], v[68:71], v[128:143]
    ds_read_b64_tr_b16 v[56:57], v30 offset:20480
    ds_read_b64_tr_b16 v[58:59], v30 offset:21504
    ds_read_b64_tr_b16 v[60:61], v31 offset:20480
    v_mfma_f32_32x32x16_bf16 v[144:159], v[44:47], v[68:71], v[144:159]
    ds_read_b64_tr_b16 v[62:63], v31 offset:21504
    ds_read_b128 v[76:79], v29 offset:16384
    s_waitcnt lgkmcnt(5)
    v_mfma_f32_32x32x16_bf16 v[128:143], v[48:51], v[72:75], v[128:143]
    ds_read_b64_tr_b16 v[32:33], v10 offset:0
    ds_read_b64_tr_b16 v[34:35], v10 offset:1024
    ds_read_b64_tr_b16 v[36:37], v11 offset:0
    v_mfma_f32_32x32x16_bf16 v[144:159], v[52:55], v[72:75], v[144:159]
    ds_read_b64_tr_b16 v[38:39], v11 offset:1024
    ds_read_b128 v[64:67], v6 offset:0
    s_waitcnt lgkmcnt(5)
    v_mfma_f32_32x32x16_bf16 v[128:143], v[56:59], v[76:79], v[128:143]
    ds_read_b64_tr_b16 v[40:41], v10 offset:4096
    ds_read_b64_tr_b16 v[42:43], v10 offset:5120
    ds_read_b64_tr_b16 v[44:45], v11 offset:4096
    v_mfma_f32_32x32x16_bf16 v[144:159], v[60:63], v[76:79], v[144:159]
    ds_read_b64_tr_b16 v[46:47], v11 offset:5120
    ds_read_b128 v[68:71], v7 offset:0
    s_waitcnt vmcnt(6)
    s_barrier
    s_waitcnt lgkmcnt(5)
    v_mfma_f32_32x32x16_bf16 v[128:143], v[32:35], v[64:67], v[128:143]
    ds_read_b64_tr_b16 v[48:49], v10 offset:16384
    ds_read_b64_tr_b16 v[50:51], v10 offset:17408
    ds_read_b64_tr_b16 v[52:53], v11 offset:16384
    v_mfma_f32_32x32x16_bf16 v[144:159], v[36:39], v[64:67], v[144:159]
    ds_read_b64_tr_b16 v[54:55], v11 offset:17408
    ds_read_b128 v[72:75], v6 offset:16384
    s_waitcnt lgkmcnt(5)
    v_mfma_f32_32x32x16_bf16 v[128:143], v[40:43], v[68:71], v[128:143]
    ds_read_b64_tr_b16 v[56:57], v10 offset:20480
    ds_read_b64_tr_b16 v[58:59], v10 offset:21504
    ds_read_b64_tr_b16 v[60:61], v11 offset:20480
    v_mfma_f32_32x32x16_bf16 v[144:159], v[44:47], v[68:71], v[144:159]
    ds_read_b64_tr_b16 v[62:63], v11 offset:21504
    ds_read_b128 v[76:79], v7 offset:16384
    s_waitcnt lgkmcnt(5)
    v_mfma_f32_32x32x16_bf16 v[128:143], v[48:51], v[72:75], v[128:143]
    ds_read_b64_tr_b16 v[32:33], v10 offset:32768
    ds_read_b64_tr_b16 v[34:35], v10 offset:33792
    ds_read_b64_tr_b16 v[36:37], v11 offset:32768
    v_mfma_f32_32x32x16_bf16 v[144:159], v[52:55], v[72:75], v[144:159]
    ds_read_b64_tr_b16 v[38:39], v11 offset:33792
    ds_read_b128 v[64:67], v6 offset:32768
    s_waitcnt lgkmcnt(5)
    v_mfma_f32_32x32x16_bf16 v[128:143], v[56:59], v[76:79], v[128:143]
    ds_read_b64_tr_b16 v[40:41], v10 offset:36864
    ds_read_b64_tr_b16 v[42:43], v10 offset:37888
    ds_read_b64_tr_b16 v[44:45], v11 offset:36864
    v_mfma_f32_32x32x16_bf16 v[144:159], v[60:63], v[76:79], v[144:159]
    ds_read_b64_tr_b16 v[46:47], v11 offset:37888
    ds_read_b128 v[68:71], v7 offset:32768
    s_waitcnt vmcnt(2)
    s_barrier
    s_waitcnt lgkmcnt(5)
    v_mfma_f32_32x32x16_bf16 v[128:143], v[32:35], v[64:67], v[128:143]
    ds_read_b64_tr_b16 v[48:49], v10 offset:49152
    ds_read_b64_tr_b16 v[50:51], v10 offset:50176
    ds_read_b64_tr_b16 v[52:53], v11 offset:49152
    v_mfma_f32_32x32x16_bf16 v[144:159], v[36:39], v[64:67], v[144:159]
    ds_read_b64_tr_b16 v[54:55], v11 offset:50176
    ds_read_b128 v[72:75], v6 offset:49152
    s_waitcnt lgkmcnt(5)
    v_mfma_f32_32x32x16_bf16 v[128:143], v[40:43], v[68:71], v[128:143]
    ds_read_b64_tr_b16 v[56:57], v10 offset:53248
    ds_read_b64_tr_b16 v[58:59], v10 offset:54272
    ds_read_b64_tr_b16 v[60:61], v11 offset:53248
    v_mfma_f32_32x32x16_bf16 v[144:159], v[44:47], v[68:71], v[144:159]
    ds_read_b64_tr_b16 v[62:63], v11 offset:54272
    ds_read_b128 v[76:79], v7 offset:49152
    s_waitcnt lgkmcnt(5)
    v_mfma_f32_32x32x16_bf16 v[128:143], v[48:51], v[72:75], v[128:143]
    ds_read_b64_tr_b16 v[32:33], v12 offset:0
    ds_read_b64_tr_b16 v[34:35], v12 offset:1024
    ds_read_b64_tr_b16 v[36:37], v13 offset:0
    v_mfma_f32_32x32x16_bf16 v[144:159], v[52:55], v[72:75], v[144:159]
    ds_read_b64_tr_b16 v[38:39], v13 offset:1024
    ds_read_b128 v[64:67], v8 offset:0
    s_waitcnt lgkmcnt(5)
    v_mfma_f32_32x32x16_bf16 v[128:143], v[56:59], v[76:79], v[128:143]
    ds_read_b64_tr_b16 v[40:41], v12 offset:4096
    ds_read_b64_tr_b16 v[42:43], v12 offset:5120
    ds_read_b64_tr_b16 v[44:45], v13 offset:4096
    v_mfma_f32_32x32x16_bf16 v[144:159], v[60:63], v[76:79], v[144:159]
    ds_read_b64_tr_b16 v[46:47], v13 offset:5120
    ds_read_b128 v[68:71], v9 offset:0
    s_waitcnt vmcnt(0)
    s_barrier
    s_waitcnt lgkmcnt(5)
    v_mfma_f32_32x32x16_bf16 v[128:143], v[32:35], v[64:67], v[128:143]
    ds_read_b64_tr_b16 v[48:49], v12 offset:16384
    ds_read_b64_tr_b16 v[50:51], v12 offset:17408
    ds_read_b64_tr_b16 v[52:53], v13 offset:16384
    v_mfma_f32_32x32x16_bf16 v[144:159], v[36:39], v[64:67], v[144:159]
    ds_read_b64_tr_b16 v[54:55], v13 offset:17408
    ds_read_b128 v[72:75], v8 offset:16384
    s_waitcnt lgkmcnt(5)
    v_mfma_f32_32x32x16_bf16 v[128:143], v[40:43], v[68:71], v[128:143]
    ds_read_b64_tr_b16 v[56:57], v12 offset:20480
    ds_read_b64_tr_b16 v[58:59], v12 offset:21504
    ds_read_b64_tr_b16 v[60:61], v13 offset:20480
    v_mfma_f32_32x32x16_bf16 v[144:159], v[44:47], v[68:71], v[144:159]
    ds_read_b64_tr_b16 v[62:63], v13 offset:21504
    ds_read_b128 v[76:79], v9 offset:16384
    s_waitcnt lgkmcnt(5)
    v_mfma_f32_32x32x16_bf16 v[128:143], v[48:51], v[72:75], v[128:143]
    v_mfma_f32_32x32x16_bf16 v[144:159], v[52:55], v[72:75], v[144:159]
    s_waitcnt lgkmcnt(0)
    v_mfma_f32_32x32x16_bf16 v[128:143], v[56:59], v[76:79], v[128:143]
    v_mfma_f32_32x32x16_bf16 v[144:159], v[60:63], v[76:79], v[144:159]
    s_lshl_b32 s75, s3, 21
    s_lshl_b32 s72, s4, 17
    s_add_u32 s75, s75, s72
    s_lshl_b32 s72, s70, 15
    s_add_u32 s75, s75, s72
    s_lshl_b32 s72, s5, 8
    s_add_u32 s75, s75, s72
    s_lshl_b32 s72, s69, 7
    s_add_u32 s75, s75, s72
    s_lshl_b32 s72, s64, 12
    s_add_u32 s72, s72, 131072
    v_and_b32 v15, 31, v1
    v_lshrrev_b32 v16, 5, v1
    v_and_b32 v17, 7, v1
    v_xor_b32 v16, v16, v17
    v_lshlrev_b32 v15, 7, v15
    v_lshl_add_u32 v22, v16, 4, v15
    v_add_u32 v22, s72, v22
    v_xor_b32 v23, 32, v22
    v_xor_b32 v24, 64, v22
    v_xor_b32 v25, 96, v22
    v_lshrrev_b32 v15, 3, v1
    v_xor_b32 v16, v15, v17
    v_lshlrev_b32 v18, 7, v15
    v_lshl_add_u32 v26, v16, 4, v18
    v_add_u32 v26, s72, v26
    s_mov_b32 s72, 1024
    v_mul_lo_u32 v14, v15, s72
    v_lshl_add_u32 v14, v17, 4, v14
    v_cvt_pk_bf16_f32 v128, v128, v129
    v_cvt_pk_bf16_f32 v129, v130, v131
    v_cvt_pk_bf16_f32 v130, v132, v133
    v_cvt_pk_bf16_f32 v131, v134, v135
    v_cvt_pk_bf16_f32 v132, v136, v137
    v_cvt_pk_bf16_f32 v133, v138, v139
    v_cvt_pk_bf16_f32 v134, v140, v141
    v_cvt_pk_bf16_f32 v135, v142, v143
    v_permlane32_swap_b32 v128, v130
    v_permlane32_swap_b32 v129, v131
    ds_write_b128 v22, v[128:131]
    v_permlane32_swap_b32 v132, v134
    v_permlane32_swap_b32 v133, v135
    ds_write_b128 v23, v[132:135]
    v_cvt_pk_bf16_f32 v144, v144, v145
    v_cvt_pk_bf16_f32 v145, v146, v147
    v_cvt_pk_bf16_f32 v146, v148, v149
    v_cvt_pk_bf16_f32 v147, v150, v151
    v_cvt_pk_bf16_f32 v148, v152, v153
    v_cvt_pk_bf16_f32 v149, v154, v155
    v_cvt_pk_bf16_f32 v150, v156, v157
    v_cvt_pk_bf16_f32 v151, v158, v159
    v_permlane32_swap_b32 v144, v146
    v_permlane32_swap_b32 v145, v147
    ds_write_b128 v24, v[144:147]
    v_permlane32_swap_b32 v148, v150
    v_permlane32_swap_b32 v149, v151
    ds_write_b128 v25, v[148:151]
    ds_read_b128 v[136:139], v26 offset:0
    ds_read_b128 v[140:143], v26 offset:1024
    ds_read_b128 v[152:155], v26 offset:2048
    ds_read_b128 v[156:159], v26 offset:3072
    s_waitcnt lgkmcnt(0)
    s_add_u32 s76, s75, 0
    buffer_store_dwordx4 v[136:139], v14, s[52:55], s76 offen sc1
    s_add_u32 s76, s75, 8192
    buffer_store_dwordx4 v[140:143], v14, s[52:55], s76 offen sc1
    s_add_u32 s76, s75, 16384
    buffer_store_dwordx4 v[152:155], v14, s[52:55], s76 offen sc1
    s_add_u32 s76, s75, 24576
    buffer_store_dwordx4 v[156:159], v14, s[52:55], s76 offen sc1
K4_PEND:
K4_END:
    s_endpgm
.text
.globl k5_red_kernel
.p2align 8
.type k5_red_kernel,@function
k5_red_kernel:
    s_cmp_ge_u32 s2, 512
    s_cbranch_scc1 K5_END
    s_load_dwordx16 s[16:31], s[0:1], 0
    s_load_dwordx8 s[32:39], s[0:1], 64
    s_load_dwordx4 s[40:43], s[0:1], 96
    s_lshl_b32 s3, s2, 8
    v_add_u32 v1, s3, v0
    v_lshlrev_b32 v2, 4, v1
    v_lshlrev_b32 v3, 5, v1
    v_and_b32 v4, 63, v1
    v_lshlrev_b32 v4, 4, v4
    s_waitcnt lgkmcnt(0)
    s_add_u32 s44, s42, 0x6000000
    s_addc_u32 s45, s43, 0
    s_and_b32 s45, s45, 0xffff
    s_mov_b32 s46, 0x800000
    s_mov_b32 s47, 0x20000
    s_mov_b32 s48, s16
    s_and_b32 s49, s17, 0xffff
    s_mov_b32 s50, 0x200000
    s_mov_b32 s51, 0x20000
    s_mov_b32 s52, s38
    s_and_b32 s53, s39, 0xffff
    s_mov_b32 s54, 0x200000
    s_mov_b32 s55, 0x20000
    s_mov_b32 s56, s36
    s_and_b32 s57, s37, 0xffff
    s_mov_b32 s58, 0x400
    s_mov_b32 s59, 0x20000
    buffer_load_dwordx4 v[8:11], v2, s[48:51], 0 offen
    buffer_load_dwordx4 v[12:15], v4, s[56:59], 0 offen
    s_mov_b32 s4, 0x0
    buffer_load_dwordx4 v[16:19], v2, s[44:47], s4 offen
    s_mov_b32 s4, 0x200000
    buffer_load_dwordx4 v[20:23], v2, s[44:47], s4 offen
    s_mov_b32 s4, 0x400000
    buffer_load_dwordx4 v[24:27], v2, s[44:47], s4 offen
    s_mov_b32 s4, 0x600000
    buffer_load_dwordx4 v[28:31], v2, s[44:47], s4 offen
    s_waitcnt vmcnt(4)
    v_lshlrev_b32 v96, 16, v8
    v_and_b32 v97, 0xffff0000, v8
    v_lshlrev_b32 v104, 16, v12
    v_and_b32 v105, 0xffff0000, v12
    v_lshlrev_b32 v98, 16, v9
    v_and_b32 v99, 0xffff0000, v9
    v_lshlrev_b32 v106, 16, v13
    v_and_b32 v107, 0xffff0000, v13
    v_lshlrev_b32 v100, 16, v10
    v_and_b32 v101, 0xffff0000, v10
    v_lshlrev_b32 v108, 16, v14
    v_and_b32 v109, 0xffff0000, v14
    v_lshlrev_b32 v102, 16, v11
    v_and_b32 v103, 0xffff0000, v11
    v_lshlrev_b32 v110, 16, v15
    v_and_b32 v111, 0xffff0000, v15
    v_add_f32 v96, v96, v104
    v_add_f32 v97, v97, v105
    v_add_f32 v98, v98, v106
    v_add_f32 v99, v99, v107
    v_add_f32 v100, v100, v108
    v_add_f32 v101, v101, v109
    v_add_f32 v102, v102, v110
    v_add_f32 v103, v103, v111
    s_waitcnt vmcnt(3)
    v_lshlrev_b32 v104, 16, v16
    v_and_b32 v105, 0xffff0000, v16
    v_add_f32 v96, v96, v104
    v_add_f32 v97, v97, v105
    v_lshlrev_b32 v104, 16, v17
    v_and_b32 v105, 0xffff0000, v17
    v_add_f32 v98, v98, v104
    v_add_f32 v99, v99, v105
    v_lshlrev_b32 v104, 16, v18
    v_and_b32 v105, 0xffff0000, v18
    v_add_f32 v100, v100, v104
    v_add_f32 v101, v101, v105
    v_lshlrev_b32 v104, 16, v19
    v_and_b32 v105, 0xffff0000, v19
    v_add_f32 v102, v102, v104
    v_add_f32 v103, v103, v105
    s_waitcnt vmcnt(2)
    v_lshlrev_b32 v104, 16, v20
    v_and_b32 v105, 0xffff0000, v20
    v_add_f32 v96, v96, v104
    v_add_f32 v97, v97, v105
    v_lshlrev_b32 v104, 16, v21
    v_and_b32 v105, 0xffff0000, v21
    v_add_f32 v98, v98, v104
    v_add_f32 v99, v99, v105
    v_lshlrev_b32 v104, 16, v22
    v_and_b32 v105, 0xffff0000, v22
    v_add_f32 v100, v100, v104
    v_add_f32 v101, v101, v105
    v_lshlrev_b32 v104, 16, v23
    v_and_b32 v105, 0xffff0000, v23
    v_add_f32 v102, v102, v104
    v_add_f32 v103, v103, v105
    s_waitcnt vmcnt(1)
    v_lshlrev_b32 v104, 16, v24
    v_and_b32 v105, 0xffff0000, v24
    v_add_f32 v96, v96, v104
    v_add_f32 v97, v97, v105
    v_lshlrev_b32 v104, 16, v25
    v_and_b32 v105, 0xffff0000, v25
    v_add_f32 v98, v98, v104
    v_add_f32 v99, v99, v105
    v_lshlrev_b32 v104, 16, v26
    v_and_b32 v105, 0xffff0000, v26
    v_add_f32 v100, v100, v104
    v_add_f32 v101, v101, v105
    v_lshlrev_b32 v104, 16, v27
    v_and_b32 v105, 0xffff0000, v27
    v_add_f32 v102, v102, v104
    v_add_f32 v103, v103, v105
    s_waitcnt vmcnt(0)
    v_lshlrev_b32 v104, 16, v28
    v_and_b32 v105, 0xffff0000, v28
    v_add_f32 v96, v96, v104
    v_add_f32 v97, v97, v105
    v_lshlrev_b32 v104, 16, v29
    v_and_b32 v105, 0xffff0000, v29
    v_add_f32 v98, v98, v104
    v_add_f32 v99, v99, v105
    v_lshlrev_b32 v104, 16, v30
    v_and_b32 v105, 0xffff0000, v30
    v_add_f32 v100, v100, v104
    v_add_f32 v101, v101, v105
    v_lshlrev_b32 v104, 16, v31
    v_and_b32 v105, 0xffff0000, v31
    v_add_f32 v102, v102, v104
    v_add_f32 v103, v103, v105
    v_cvt_pk_bf16_f32 v8, v96, v97
    v_cvt_pk_bf16_f32 v9, v98, v99
    v_cvt_pk_bf16_f32 v10, v100, v101
    v_cvt_pk_bf16_f32 v11, v102, v103
    buffer_store_dwordx4 v[8:11], v2, s[52:55], 0 offen sc1
K5_END:
    s_endpgm
.section .rodata,"a"
.p2align 6
.amdhsa_kernel k1_kv_kernel
  .amdhsa_next_free_vgpr 256
  .amdhsa_next_free_sgpr 102
  .amdhsa_accum_offset 256
  .amdhsa_group_segment_fixed_size 0
  .amdhsa_kernarg_size 112
  .amdhsa_user_sgpr_count 2
  .amdhsa_user_sgpr_kernarg_segment_ptr 1
  .amdhsa_system_sgpr_workgroup_id_x 1
.end_amdhsa_kernel
.section .rodata,"a"
.p2align 6
.amdhsa_kernel k3_attn_kernel
  .amdhsa_next_free_vgpr 256
  .amdhsa_next_free_sgpr 102
  .amdhsa_accum_offset 256
  .amdhsa_group_segment_fixed_size 0
  .amdhsa_kernarg_size 112
  .amdhsa_user_sgpr_count 2
  .amdhsa_user_sgpr_kernarg_segment_ptr 1
  .amdhsa_system_sgpr_workgroup_id_x 1
.end_amdhsa_kernel
.section .rodata,"a"
.p2align 6
.amdhsa_kernel k4_out_kernel
  .amdhsa_next_free_vgpr 160
  .amdhsa_next_free_sgpr 102
  .amdhsa_accum_offset 160
  .amdhsa_group_segment_fixed_size 0
  .amdhsa_kernarg_size 112
  .amdhsa_user_sgpr_count 2
  .amdhsa_user_sgpr_kernarg_segment_ptr 1
  .amdhsa_system_sgpr_workgroup_id_x 1
.end_amdhsa_kernel
.section .rodata,"a"
.p2align 6
.amdhsa_kernel k5_red_kernel
  .amdhsa_next_free_vgpr 112
  .amdhsa_next_free_sgpr 102
  .amdhsa_accum_offset 112
  .amdhsa_group_segment_fixed_size 0
  .amdhsa_kernarg_size 112
  .amdhsa_user_sgpr_count 2
  .amdhsa_user_sgpr_kernarg_segment_ptr 1
  .amdhsa_system_sgpr_workgroup_id_x 1
.end_amdhsa_kernel
```
